```python
import torch

def _softmax(x, axis=-1):
    return torch.softmax(x, dim=axis)
def _gelu(x):
    return torch.nn.functional.gelu(x, approximate="tanh")
def _silu(x):
    return torch.nn.functional.silu(x)
def _sigmoid(x):
    return torch.sigmoid(x)
def _layernorm(x, axis=-1, eps=1e-5):
    m = x.mean(dim=axis, keepdim=True)
    v = x.var(dim=axis, keepdim=True, unbiased=False)
    return (x - m) / torch.sqrt(v + eps)
def _scatter_add(tgt, idx, src, axis=0):
    return tgt.clone().index_add_(axis, idx, src)
def _segment_sum(src, seg, n):
    out = torch.zeros((n,) + src.shape[1:], dtype=src.dtype)
    return out.index_add_(0, seg, src)
def _pad(x, pw):
    flat = tuple(v for pair in reversed(pw) for v in pair)
    return torch.nn.functional.pad(x, flat)

kernel_name = 'parallel_sum__mha_block__glu_gated_geglu__prompt'

def setup_inputs():

    _w = (lambda a: (lambda t: t.to(torch.bfloat16) if t.is_floating_point() else t)(torch.as_tensor(a)))
    def _A_setup():
        B, S, D, H = 1, 2048, 640, 32
        return {
            "x": _w((lambda *s: torch.randn(*s, dtype=torch.bfloat16) * 0.05)(B, S, D)),
            "wqkv": _w((lambda *s: torch.randn(*s, dtype=torch.bfloat16) * 0.05)(D, 3 * D)),
            "wo": _w((lambda *s: torch.randn(*s, dtype=torch.bfloat16) * 0.05)(D, D)),
        }
    _A_in = _A_setup()

    def _B_setup():
        B, S, Dm, Df = 1, 2048, 640, 1728
        return {
            "x": _w((lambda *s: torch.randn(*s, dtype=torch.bfloat16) * 0.05)(B, S, Dm)),
            "w_gate": _w((lambda *s: torch.randn(*s, dtype=torch.bfloat16) * 0.8)(Dm, Df) * (Dm ** -0.5)),
            "w_up": _w((lambda *s: torch.randn(*s, dtype=torch.bfloat16) * 0.8)(Dm, Df) * (Dm ** -0.5)),
            "w_down": _w((lambda *s: torch.randn(*s, dtype=torch.bfloat16) * 0.8)(Df, Dm) * (Df ** -0.5)),
        }
    _B_in = _B_setup()

    return {
        "A_x": _A_in["x"],
        "A_wqkv": _A_in["wqkv"],
        "A_wo": _A_in["wo"],
        "B_x": _B_in["x"],
        "B_w_gate": _B_in["w_gate"],
        "B_w_up": _B_in["w_up"],
        "B_w_down": _B_in["w_down"],
    }

def reference(A_x, A_wqkv, A_wo, B_x, B_w_gate, B_w_up, B_w_down):
    def _A_ref(x, wqkv, wo):
        B, S, D = x.shape
        H = 32
        Dh = D // H
        qkv = (lambda x, *d: x.permute(*d))((x @ wqkv).reshape(B, S, 3, H, Dh), 2, 0, 3, 1, 4)
        q, k, v = qkv[0], qkv[1], qkv[2]
        scores = torch.einsum("bhqd,bhkd->bhqk", q, k) * (Dh ** -0.5)
        p = _softmax(scores, axis=-1)
        o = torch.einsum("bhqk,bhkd->bhqd", p, v)
        return (lambda x, *d: x.permute(*d))(o, 0, 2, 1, 3).reshape(B, S, D) @ wo

    def _B_ref(x, w_gate, w_up, w_down):
        g = torch.einsum("bsd,df->bsf", x, w_gate)
        u = torch.einsum("bsd,df->bsf", x, w_up)
        h = _gelu(g) * u
        return torch.einsum("bsf,fd->bsd", h, w_down)

    x = A_x
    xn = _layernorm(x, axis=-1)
    return x + _A_ref(xn, A_wqkv, A_wo) + _B_ref(xn, B_w_gate, B_w_up, B_w_down)
```

```asm
; @launch kernel=ln_kernel grid=(512,1,1) block=(256,1,1) lds=0
; @launch kernel=gemm1_kernel grid=(240,1,1) block=(768,1,1) lds=143360
; @launch kernel=attn_kernel grid=(496,1,1) block=(512,1,1) lds=73728
; @launch kernel=gemm2_kernel grid=(160,1,1) block=(256,1,1) lds=49152
.amdgcn_target "amdgcn-amd-amdhsa--gfx950"
.text
.globl ln_kernel
.p2align 8
.type ln_kernel,@function
ln_kernel:
    s_cmp_ge_u32 s2, 512
    s_cbranch_scc1 LN_done
    s_load_dwordx2 s[4:5], s[0:1], 0
    s_load_dwordx2 s[6:7], s[0:1], 72
    v_lshrrev_b32 v1, 6, v0
    v_and_b32 v2, 63, v0
    s_lshl_b32 s3, s2, 2
    v_add_u32 v1, s3, v1
    s_movk_i32 s8, 1280
    v_mul_lo_u32 v1, v1, s8
    v_lshl_add_u32 v1, v2, 2, v1
    s_waitcnt lgkmcnt(0)
    s_mov_b32 s12, s4
    s_mov_b32 s13, s5
    s_mov_b32 s14, 2621440
    s_mov_b32 s15, 0x00020000
    s_add_u32 s16, s6, 0
    s_addc_u32 s17, s7, 0
    s_mov_b32 s18, 2621440
    s_mov_b32 s19, 0x00020000
    buffer_load_dword v4, v1, s[12:15], 0 offen offset:0
    buffer_load_dword v5, v1, s[12:15], 0 offen offset:256
    buffer_load_dword v6, v1, s[12:15], 0 offen offset:512
    buffer_load_dword v7, v1, s[12:15], 0 offen offset:768
    buffer_load_dword v8, v1, s[12:15], 0 offen offset:1024
    s_waitcnt vmcnt(0)
    v_lshlrev_b32 v10, 16, v4
    v_and_b32 v11, 0xffff0000, v4
    v_lshlrev_b32 v12, 16, v5
    v_and_b32 v13, 0xffff0000, v5
    v_lshlrev_b32 v14, 16, v6
    v_and_b32 v15, 0xffff0000, v6
    v_lshlrev_b32 v16, 16, v7
    v_and_b32 v17, 0xffff0000, v7
    v_lshlrev_b32 v18, 16, v8
    v_and_b32 v19, 0xffff0000, v8
    v_add_f32 v20, v10, v11
    v_add_f32 v20, v20, v12
    v_add_f32 v20, v20, v13
    v_add_f32 v20, v20, v14
    v_add_f32 v20, v20, v15
    v_add_f32 v20, v20, v16
    v_add_f32 v20, v20, v17
    v_add_f32 v20, v20, v18
    v_add_f32 v20, v20, v19
    ds_swizzle_b32 v21, v20 offset:1055
    s_waitcnt lgkmcnt(0)
    v_add_f32 v20, v20, v21
    ds_swizzle_b32 v21, v20 offset:2079
    s_waitcnt lgkmcnt(0)
    v_add_f32 v20, v20, v21
    ds_swizzle_b32 v21, v20 offset:4127
    s_waitcnt lgkmcnt(0)
    v_add_f32 v20, v20, v21
    ds_swizzle_b32 v21, v20 offset:8223
    s_waitcnt lgkmcnt(0)
    v_add_f32 v20, v20, v21
    ds_swizzle_b32 v21, v20 offset:16415
    s_waitcnt lgkmcnt(0)
    v_add_f32 v20, v20, v21
    s_nop 1
    v_readlane_b32 s20, v20, 0
    v_readlane_b32 s21, v20, 32
    s_nop 3
    v_mov_b32 v20, s20
    v_add_f32 v20, s21, v20
    s_mov_b32 s22, 0x3acccccd
    v_mul_f32 v20, s22, v20
    v_sub_f32 v22, v10, v20
    v_mul_f32 v23, v22, v22
    v_sub_f32 v22, v11, v20
    v_fmac_f32 v23, v22, v22
    v_sub_f32 v22, v12, v20
    v_fmac_f32 v23, v22, v22
    v_sub_f32 v22, v13, v20
    v_fmac_f32 v23, v22, v22
    v_sub_f32 v22, v14, v20
    v_fmac_f32 v23, v22, v22
    v_sub_f32 v22, v15, v20
    v_fmac_f32 v23, v22, v22
    v_sub_f32 v22, v16, v20
    v_fmac_f32 v23, v22, v22
    v_sub_f32 v22, v17, v20
    v_fmac_f32 v23, v22, v22
    v_sub_f32 v22, v18, v20
    v_fmac_f32 v23, v22, v22
    v_sub_f32 v22, v19, v20
    v_fmac_f32 v23, v22, v22
    ds_swizzle_b32 v21, v23 offset:1055
    s_waitcnt lgkmcnt(0)
    v_add_f32 v23, v23, v21
    ds_swizzle_b32 v21, v23 offset:2079
    s_waitcnt lgkmcnt(0)
    v_add_f32 v23, v23, v21
    ds_swizzle_b32 v21, v23 offset:4127
    s_waitcnt lgkmcnt(0)
    v_add_f32 v23, v23, v21
    ds_swizzle_b32 v21, v23 offset:8223
    s_waitcnt lgkmcnt(0)
    v_add_f32 v23, v23, v21
    ds_swizzle_b32 v21, v23 offset:16415
    s_waitcnt lgkmcnt(0)
    v_add_f32 v23, v23, v21
    s_nop 1
    v_readlane_b32 s20, v23, 0
    v_readlane_b32 s21, v23, 32
    s_nop 3
    v_mov_b32 v23, s20
    v_add_f32 v23, s21, v23
    v_mul_f32 v23, s22, v23
    v_cvt_pk_bf16_f32 v20, v20, v20
    v_lshlrev_b32 v20, 16, v20
    v_cvt_pk_bf16_f32 v23, v23, v23
    v_lshlrev_b32 v23, 16, v23
    v_add_f32 v23, 0x3727c5ac, v23
    v_cvt_pk_bf16_f32 v23, v23, v23
    v_lshlrev_b32 v23, 16, v23
    v_sqrt_f32 v23, v23
    s_nop 0
    v_cvt_pk_bf16_f32 v23, v23, v23
    v_lshlrev_b32 v23, 16, v23
    v_rcp_f32 v23, v23
    s_nop 0
    v_sub_f32 v10, v10, v20
    v_sub_f32 v11, v11, v20
    v_sub_f32 v12, v12, v20
    v_sub_f32 v13, v13, v20
    v_sub_f32 v14, v14, v20
    v_sub_f32 v15, v15, v20
    v_sub_f32 v16, v16, v20
    v_sub_f32 v17, v17, v20
    v_sub_f32 v18, v18, v20
    v_sub_f32 v19, v19, v20
    v_cvt_pk_bf16_f32 v4, v10, v11
    v_cvt_pk_bf16_f32 v5, v12, v13
    v_cvt_pk_bf16_f32 v6, v14, v15
    v_cvt_pk_bf16_f32 v7, v16, v17
    v_cvt_pk_bf16_f32 v8, v18, v19
    v_lshlrev_b32 v10, 16, v4
    v_and_b32 v11, 0xffff0000, v4
    v_lshlrev_b32 v12, 16, v5
    v_and_b32 v13, 0xffff0000, v5
    v_lshlrev_b32 v14, 16, v6
    v_and_b32 v15, 0xffff0000, v6
    v_lshlrev_b32 v16, 16, v7
    v_and_b32 v17, 0xffff0000, v7
    v_lshlrev_b32 v18, 16, v8
    v_and_b32 v19, 0xffff0000, v8
    v_mul_f32 v10, v10, v23
    v_mul_f32 v11, v11, v23
    v_mul_f32 v12, v12, v23
    v_mul_f32 v13, v13, v23
    v_mul_f32 v14, v14, v23
    v_mul_f32 v15, v15, v23
    v_mul_f32 v16, v16, v23
    v_mul_f32 v17, v17, v23
    v_mul_f32 v18, v18, v23
    v_mul_f32 v19, v19, v23
    v_cvt_pk_bf16_f32 v4, v10, v11
    v_cvt_pk_bf16_f32 v5, v12, v13
    v_cvt_pk_bf16_f32 v6, v14, v15
    v_cvt_pk_bf16_f32 v7, v16, v17
    v_cvt_pk_bf16_f32 v8, v18, v19
    buffer_store_dword v4, v1, s[16:19], 0 offen offset:0
    buffer_store_dword v5, v1, s[16:19], 0 offen offset:256
    buffer_store_dword v6, v1, s[16:19], 0 offen offset:512
    buffer_store_dword v7, v1, s[16:19], 0 offen offset:768
    buffer_store_dword v8, v1, s[16:19], 0 offen offset:1024
LN_done:
    s_endpgm
.globl gemm1_kernel
.p2align 8
.type gemm1_kernel,@function
gemm1_kernel:
    s_cmp_ge_u32 s2, 240
    s_cbranch_scc1 G1_done
    s_load_dwordx2 s[4:5], s[0:1], 8
    s_load_dwordx4 s[8:11], s[0:1], 32
    s_load_dwordx2 s[6:7], s[0:1], 72
    s_and_b32 s34, s2, 7
    s_mul_i32 s34, s34, 30
    s_lshr_b32 s35, s2, 3
    s_add_u32 s35, s35, s34
    s_and_b32 s34, s35, 7
    s_lshr_b32 s35, s35, 3
    s_lshl_b32 s36, s34, 8
    s_cmp_ge_u32 s35, 12
    s_cbranch_scc1 G1_glu
    s_mul_i32 s37, s35, 320
    v_mov_b32 v138, v0
    v_and_b32 v140, 63, v0
    v_lshrrev_b32 v141, 6, v0
    s_nop 0
    v_readfirstlane_b32 s30, v141
    s_waitcnt lgkmcnt(0)
    s_lshl_b32 s33, s30, 4
    s_add_u32 s33, s33, s36
    v_lshrrev_b32 v142, 2, v140
    v_add_u32 v142, s33, v142
    v_mul_u32_u24 v142, 1280, v142
    v_and_b32 v143, 3, v140
    v_bfe_u32 v144, v140, 4, 2
    v_xor_b32 v143, v143, v144
    v_lshl_add_u32 v142, v143, 4, v142
    v_mov_b32 v133, s7
    v_add_co_u32 v132, vcc, s6, v142
    s_nop 1
    v_addc_co_u32 v133, vcc, 0, v133, vcc
    s_lshl_b32 s24, s30, 10
    s_mov_b32 s40, 64
    s_mov_b32 s41, 0
    s_mov_b32 s44, 122880
    s_mov_b32 s45, 0
    s_cmp_lt_u32 s30, 4
    s_cbranch_scc0 G1_x1_1
    s_add_u32 s25, s30, 12
    s_lshl_b32 s33, s25, 4
    s_add_u32 s33, s33, s36
    v_lshrrev_b32 v142, 2, v140
    v_add_u32 v142, s33, v142
    v_mul_u32_u24 v142, 1280, v142
    v_and_b32 v143, 3, v140
    v_bfe_u32 v144, v140, 4, 2
    v_xor_b32 v143, v143, v144
    v_lshl_add_u32 v142, v143, 4, v142
    v_mov_b32 v135, s7
    v_add_co_u32 v134, vcc, s6, v142
    s_nop 1
    v_addc_co_u32 v135, vcc, 0, v135, vcc
    s_lshl_b32 s25, s25, 10
    s_mov_b32 s42, 64
    s_branch G1_x2_2
G1_x1_1:
    s_sub_u32 s25, s30, 4
    s_lshl_b32 s33, s25, 6
    v_add_u32 v145, s33, v140
    s_movk_i32 s33, 3277
    v_mul_lo_u32 v142, v145, s33
    v_lshrrev_b32 v142, 16, v142
    v_mul_u32_u24 v143, 20, v142
    v_sub_u32 v145, v145, v143
    v_mul_u32_u24 v142, 3840, v142
    v_lshl_add_u32 v142, v145, 4, v142
    v_add_u32 v142, s37, v142
    v_mov_b32 v135, s5
    v_add_co_u32 v134, vcc, s4, v142
    s_nop 1
    v_addc_co_u32 v135, vcc, 0, v135, vcc
    s_lshl_b32 s25, s25, 10
    s_add_u32 s25, s25, 16384
    s_mov_b32 s42, 122880
G1_x2_2:
    s_mov_b32 s43, 0
    s_add_u32 s26, s30, 8
    s_min_u32 s26, s26, 9
    s_lshl_b32 s33, s26, 6
    v_add_u32 v145, s33, v140
    s_movk_i32 s33, 3277
    v_mul_lo_u32 v142, v145, s33
    v_lshrrev_b32 v142, 16, v142
    v_mul_u32_u24 v143, 20, v142
    v_sub_u32 v145, v145, v143
    v_mul_u32_u24 v142, 3840, v142
    v_lshl_add_u32 v142, v145, 4, v142
    v_add_u32 v142, s37, v142
    v_mov_b32 v137, s5
    v_add_co_u32 v136, vcc, s4, v142
    s_nop 1
    v_addc_co_u32 v137, vcc, 0, v137, vcc
    s_lshl_b32 s26, s26, 10
    s_add_u32 s26, s26, 16384
    s_add_u32 m0, s24, 0
    s_nop 0
    global_load_lds_dwordx4 v[132:133], off
    v_lshl_add_u64 v[132:133], v[132:133], 0, s[40:41]
    s_add_u32 m0, s25, 0
    s_nop 0
    global_load_lds_dwordx4 v[134:135], off
    v_lshl_add_u64 v[134:135], v[134:135], 0, s[42:43]
    s_add_u32 m0, s26, 0
    s_nop 0
    global_load_lds_dwordx4 v[136:137], off
    v_lshl_add_u64 v[136:137], v[136:137], 0, s[44:45]
    s_add_u32 m0, s24, 26624
    s_nop 0
    global_load_lds_dwordx4 v[132:133], off
    v_lshl_add_u64 v[132:133], v[132:133], 0, s[40:41]
    s_add_u32 m0, s25, 26624
    s_nop 0
    global_load_lds_dwordx4 v[134:135], off
    v_lshl_add_u64 v[134:135], v[134:135], 0, s[42:43]
    s_add_u32 m0, s26, 26624
    s_nop 0
    global_load_lds_dwordx4 v[136:137], off
    v_lshl_add_u64 v[136:137], v[136:137], 0, s[44:45]
    s_add_u32 m0, s24, 53248
    s_nop 0
    global_load_lds_dwordx4 v[132:133], off
    v_lshl_add_u64 v[132:133], v[132:133], 0, s[40:41]
    s_add_u32 m0, s25, 53248
    s_nop 0
    global_load_lds_dwordx4 v[134:135], off
    v_lshl_add_u64 v[134:135], v[134:135], 0, s[42:43]
    s_add_u32 m0, s26, 53248
    s_nop 0
    global_load_lds_dwordx4 v[136:137], off
    v_lshl_add_u64 v[136:137], v[136:137], 0, s[44:45]
    s_add_u32 m0, s24, 79872
    s_nop 0
    global_load_lds_dwordx4 v[132:133], off
    v_lshl_add_u64 v[132:133], v[132:133], 0, s[40:41]
    s_add_u32 m0, s25, 79872
    s_nop 0
    global_load_lds_dwordx4 v[134:135], off
    v_lshl_add_u64 v[134:135], v[134:135], 0, s[42:43]
    s_add_u32 m0, s26, 79872
    s_nop 0
    global_load_lds_dwordx4 v[136:137], off
    v_lshl_add_u64 v[136:137], v[136:137], 0, s[44:45]
    s_and_b32 s31, s30, 7
    s_mov_b32 s32, 0
    v_and_b32 v142, 31, v140
    s_mul_i32 s33, s31, 32
    v_add_u32 v142, s33, v142
    v_lshrrev_b32 v143, 5, v140
    v_bfe_u32 v144, v140, 2, 2
    v_xor_b32 v143, v143, v144
    v_lshlrev_b32 v143, 4, v143
    v_lshl_add_u32 v128, v142, 6, v143
    v_xor_b32 v129, 32, v128
    v_lshrrev_b32 v142, 5, v140
    v_lshlrev_b32 v142, 3, v142
    v_bfe_u32 v143, v140, 2, 2
    v_add_u32 v142, v142, v143
    v_mul_u32_u24 v142, 320, v142
    v_bfe_u32 v143, v140, 4, 1
    v_lshl_add_u32 v142, v143, 5, v142
    v_and_b32 v143, 3, v140
    v_lshl_add_u32 v142, v143, 3, v142
    v_add_u32 v130, 16384, v142
    v_mov_b32 v0, 0
    v_mov_b32 v1, 0
    v_mov_b32 v2, 0
    v_mov_b32 v3, 0
    v_mov_b32 v4, 0
    v_mov_b32 v5, 0
    v_mov_b32 v6, 0
    v_mov_b32 v7, 0
    v_mov_b32 v8, 0
    v_mov_b32 v9, 0
    v_mov_b32 v10, 0
    v_mov_b32 v11, 0
    v_mov_b32 v12, 0
    v_mov_b32 v13, 0
    v_mov_b32 v14, 0
    v_mov_b32 v15, 0
    v_mov_b32 v16, 0
    v_mov_b32 v17, 0
    v_mov_b32 v18, 0
    v_mov_b32 v19, 0
    v_mov_b32 v20, 0
    v_mov_b32 v21, 0
    v_mov_b32 v22, 0
    v_mov_b32 v23, 0
    v_mov_b32 v24, 0
    v_mov_b32 v25, 0
    v_mov_b32 v26, 0
    v_mov_b32 v27, 0
    v_mov_b32 v28, 0
    v_mov_b32 v29, 0
    v_mov_b32 v30, 0
    v_mov_b32 v31, 0
    v_mov_b32 v32, 0
    v_mov_b32 v33, 0
    v_mov_b32 v34, 0
    v_mov_b32 v35, 0
    v_mov_b32 v36, 0
    v_mov_b32 v37, 0
    v_mov_b32 v38, 0
    v_mov_b32 v39, 0
    v_mov_b32 v40, 0
    v_mov_b32 v41, 0
    v_mov_b32 v42, 0
    v_mov_b32 v43, 0
    v_mov_b32 v44, 0
    v_mov_b32 v45, 0
    v_mov_b32 v46, 0
    v_mov_b32 v47, 0
    v_mov_b32 v48, 0
    v_mov_b32 v49, 0
    v_mov_b32 v50, 0
    v_mov_b32 v51, 0
    v_mov_b32 v52, 0
    v_mov_b32 v53, 0
    v_mov_b32 v54, 0
    v_mov_b32 v55, 0
    v_mov_b32 v56, 0
    v_mov_b32 v57, 0
    v_mov_b32 v58, 0
    v_mov_b32 v59, 0
    v_mov_b32 v60, 0
    v_mov_b32 v61, 0
    v_mov_b32 v62, 0
    v_mov_b32 v63, 0
    v_mov_b32 v64, 0
    v_mov_b32 v65, 0
    v_mov_b32 v66, 0
    v_mov_b32 v67, 0
    v_mov_b32 v68, 0
    v_mov_b32 v69, 0
    v_mov_b32 v70, 0
    v_mov_b32 v71, 0
    v_mov_b32 v72, 0
    v_mov_b32 v73, 0
    v_mov_b32 v74, 0
    v_mov_b32 v75, 0
    v_mov_b32 v76, 0
    v_mov_b32 v77, 0
    v_mov_b32 v78, 0
    v_mov_b32 v79, 0
    s_cmp_ge_u32 s30, 8
    s_cbranch_scc1 G1_helper
    s_cmp_ge_u32 s35, 8
    s_cbranch_scc1 G1_v
    s_waitcnt vmcnt(9)
    s_barrier
    ds_read_b128 v[80:83], v128 offset:0
    ds_read_b64_tr_b16 v[88:89], v130 offset:0
    ds_read_b64_tr_b16 v[90:91], v130 offset:1280
    ds_read_b64_tr_b16 v[92:93], v130 offset:64
    ds_read_b64_tr_b16 v[94:95], v130 offset:1344
    ds_read_b64_tr_b16 v[96:97], v130 offset:128
    ds_read_b64_tr_b16 v[98:99], v130 offset:1408
    ds_read_b64_tr_b16 v[100:101], v130 offset:192
    ds_read_b64_tr_b16 v[102:103], v130 offset:1472
    ds_read_b64_tr_b16 v[104:105], v130 offset:256
    ds_read_b64_tr_b16 v[106:107], v130 offset:1536
    ds_read_b128 v[84:87], v129 offset:0
    ds_read_b64_tr_b16 v[108:109], v130 offset:5120
    ds_read_b64_tr_b16 v[110:111], v130 offset:6400
    ds_read_b64_tr_b16 v[112:113], v130 offset:5184
    ds_read_b64_tr_b16 v[114:115], v130 offset:6464
    ds_read_b64_tr_b16 v[116:117], v130 offset:5248
    ds_read_b64_tr_b16 v[118:119], v130 offset:6528
    ds_read_b64_tr_b16 v[120:121], v130 offset:5312
    ds_read_b64_tr_b16 v[122:123], v130 offset:6592
    ds_read_b64_tr_b16 v[124:125], v130 offset:5376
    ds_read_b64_tr_b16 v[126:127], v130 offset:6656
    s_add_u32 m0, s24, 106496
    s_nop 0
    global_load_lds_dwordx4 v[132:133], off
    v_lshl_add_u64 v[132:133], v[132:133], 0, s[40:41]
    s_add_u32 m0, s25, 106496
    s_nop 0
    global_load_lds_dwordx4 v[134:135], off
    v_lshl_add_u64 v[134:135], v[134:135], 0, s[42:43]
    s_add_u32 m0, s26, 106496
    s_nop 0
    global_load_lds_dwordx4 v[136:137], off
    v_lshl_add_u64 v[136:137], v[136:137], 0, s[44:45]
    s_waitcnt lgkmcnt(11)
    v_mfma_f32_32x32x16_bf16 v[0:15], v[88:91], v[80:83], v[0:15]
    v_mfma_f32_32x32x16_bf16 v[16:31], v[92:95], v[80:83], v[16:31]
    v_mfma_f32_32x32x16_bf16 v[32:47], v[96:99], v[80:83], v[32:47]
    v_mfma_f32_32x32x16_bf16 v[48:63], v[100:103], v[80:83], v[48:63]
    v_mfma_f32_32x32x16_bf16 v[64:79], v[104:107], v[80:83], v[64:79]
    s_waitcnt lgkmcnt(0)
    v_mfma_f32_32x32x16_bf16 v[0:15], v[108:111], v[84:87], v[0:15]
    v_mfma_f32_32x32x16_bf16 v[16:31], v[112:115], v[84:87], v[16:31]
    v_mfma_f32_32x32x16_bf16 v[32:47], v[116:119], v[84:87], v[32:47]
    v_mfma_f32_32x32x16_bf16 v[48:63], v[120:123], v[84:87], v[48:63]
    v_mfma_f32_32x32x16_bf16 v[64:79], v[124:127], v[84:87], v[64:79]
    s_waitcnt vmcnt(9)
    s_barrier
    ds_read_b128 v[80:83], v128 offset:26624
    ds_read_b64_tr_b16 v[88:89], v130 offset:26624
    ds_read_b64_tr_b16 v[90:91], v130 offset:27904
    ds_read_b64_tr_b16 v[92:93], v130 offset:26688
    ds_read_b64_tr_b16 v[94:95], v130 offset:27968
    ds_read_b64_tr_b16 v[96:97], v130 offset:26752
    ds_read_b64_tr_b16 v[98:99], v130 offset:28032
    ds_read_b64_tr_b16 v[100:101], v130 offset:26816
    ds_read_b64_tr_b16 v[102:103], v130 offset:28096
    ds_read_b64_tr_b16 v[104:105], v130 offset:26880
    ds_read_b64_tr_b16 v[106:107], v130 offset:28160
    ds_read_b128 v[84:87], v129 offset:26624
    ds_read_b64_tr_b16 v[108:109], v130 offset:31744
    ds_read_b64_tr_b16 v[110:111], v130 offset:33024
    ds_read_b64_tr_b16 v[112:113], v130 offset:31808
    ds_read_b64_tr_b16 v[114:115], v130 offset:33088
    ds_read_b64_tr_b16 v[116:117], v130 offset:31872
    ds_read_b64_tr_b16 v[118:119], v130 offset:33152
    ds_read_b64_tr_b16 v[120:121], v130 offset:31936
    ds_read_b64_tr_b16 v[122:123], v130 offset:33216
    ds_read_b64_tr_b16 v[124:125], v130 offset:32000
    ds_read_b64_tr_b16 v[126:127], v130 offset:33280
    s_add_u32 m0, s24, 0
    s_nop 0
    global_load_lds_dwordx4 v[132:133], off
    v_lshl_add_u64 v[132:133], v[132:133], 0, s[40:41]
    s_add_u32 m0, s25, 0
    s_nop 0
    global_load_lds_dwordx4 v[134:135], off
    v_lshl_add_u64 v[134:135], v[134:135], 0, s[42:43]
    s_add_u32 m0, s26, 0
    s_nop 0
    global_load_lds_dwordx4 v[136:137], off
    v_lshl_add_u64 v[136:137], v[136:137], 0, s[44:45]
    s_waitcnt lgkmcnt(11)
    v_mfma_f32_32x32x16_bf16 v[0:15], v[88:91], v[80:83], v[0:15]
    v_mfma_f32_32x32x16_bf16 v[16:31], v[92:95], v[80:83], v[16:31]
    v_mfma_f32_32x32x16_bf16 v[32:47], v[96:99], v[80:83], v[32:47]
    v_mfma_f32_32x32x16_bf16 v[48:63], v[100:103], v[80:83], v[48:63]
    v_mfma_f32_32x32x16_bf16 v[64:79], v[104:107], v[80:83], v[64:79]
    s_waitcnt lgkmcnt(0)
    v_mfma_f32_32x32x16_bf16 v[0:15], v[108:111], v[84:87], v[0:15]
    v_mfma_f32_32x32x16_bf16 v[16:31], v[112:115], v[84:87], v[16:31]
    v_mfma_f32_32x32x16_bf16 v[32:47], v[116:119], v[84:87], v[32:47]
    v_mfma_f32_32x32x16_bf16 v[48:63], v[120:123], v[84:87], v[48:63]
    v_mfma_f32_32x32x16_bf16 v[64:79], v[124:127], v[84:87], v[64:79]
    v_add_u32 v156, 53248, v128
    v_add_u32 v158, 53248, v130
    v_add_u32 v157, 53248, v129
    v_add_u32 v159, 53248, v131
    s_waitcnt vmcnt(9)
    s_barrier
    ds_read_b128 v[80:83], v156 offset:0
    ds_read_b64_tr_b16 v[88:89], v158 offset:0
    ds_read_b64_tr_b16 v[90:91], v158 offset:1280
    ds_read_b64_tr_b16 v[92:93], v158 offset:64
    ds_read_b64_tr_b16 v[94:95], v158 offset:1344
    ds_read_b64_tr_b16 v[96:97], v158 offset:128
    ds_read_b64_tr_b16 v[98:99], v158 offset:1408
    ds_read_b64_tr_b16 v[100:101], v158 offset:192
    ds_read_b64_tr_b16 v[102:103], v158 offset:1472
    ds_read_b64_tr_b16 v[104:105], v158 offset:256
    ds_read_b64_tr_b16 v[106:107], v158 offset:1536
    ds_read_b128 v[84:87], v157 offset:0
    ds_read_b64_tr_b16 v[108:109], v158 offset:5120
    ds_read_b64_tr_b16 v[110:111], v158 offset:6400
    ds_read_b64_tr_b16 v[112:113], v158 offset:5184
    ds_read_b64_tr_b16 v[114:115], v158 offset:6464
    ds_read_b64_tr_b16 v[116:117], v158 offset:5248
    ds_read_b64_tr_b16 v[118:119], v158 offset:6528
    ds_read_b64_tr_b16 v[120:121], v158 offset:5312
    ds_read_b64_tr_b16 v[122:123], v158 offset:6592
    ds_read_b64_tr_b16 v[124:125], v158 offset:5376
    ds_read_b64_tr_b16 v[126:127], v158 offset:6656
    s_add_u32 m0, s24, 26624
    s_nop 0
    global_load_lds_dwordx4 v[132:133], off
    v_lshl_add_u64 v[132:133], v[132:133], 0, s[40:41]
    s_add_u32 m0, s25, 26624
    s_nop 0
    global_load_lds_dwordx4 v[134:135], off
    v_lshl_add_u64 v[134:135], v[134:135], 0, s[42:43]
    s_add_u32 m0, s26, 26624
    s_nop 0
    global_load_lds_dwordx4 v[136:137], off
    v_lshl_add_u64 v[136:137], v[136:137], 0, s[44:45]
    s_waitcnt lgkmcnt(11)
    v_mfma_f32_32x32x16_bf16 v[0:15], v[88:91], v[80:83], v[0:15]
    v_mfma_f32_32x32x16_bf16 v[16:31], v[92:95], v[80:83], v[16:31]
    v_mfma_f32_32x32x16_bf16 v[32:47], v[96:99], v[80:83], v[32:47]
    v_mfma_f32_32x32x16_bf16 v[48:63], v[100:103], v[80:83], v[48:63]
    v_mfma_f32_32x32x16_bf16 v[64:79], v[104:107], v[80:83], v[64:79]
    s_waitcnt lgkmcnt(0)
    v_mfma_f32_32x32x16_bf16 v[0:15], v[108:111], v[84:87], v[0:15]
    v_mfma_f32_32x32x16_bf16 v[16:31], v[112:115], v[84:87], v[16:31]
    v_mfma_f32_32x32x16_bf16 v[32:47], v[116:119], v[84:87], v[32:47]
    v_mfma_f32_32x32x16_bf16 v[48:63], v[120:123], v[84:87], v[48:63]
    v_mfma_f32_32x32x16_bf16 v[64:79], v[124:127], v[84:87], v[64:79]
    v_add_u32 v156, 53248, v128
    v_add_u32 v158, 53248, v130
    v_add_u32 v157, 53248, v129
    v_add_u32 v159, 53248, v131
    s_waitcnt vmcnt(9)
    s_barrier
    ds_read_b128 v[80:83], v156 offset:26624
    ds_read_b64_tr_b16 v[88:89], v158 offset:26624
    ds_read_b64_tr_b16 v[90:91], v158 offset:27904
    ds_read_b64_tr_b16 v[92:93], v158 offset:26688
    ds_read_b64_tr_b16 v[94:95], v158 offset:27968
    ds_read_b64_tr_b16 v[96:97], v158 offset:26752
    ds_read_b64_tr_b16 v[98:99], v158 offset:28032
    ds_read_b64_tr_b16 v[100:101], v158 offset:26816
    ds_read_b64_tr_b16 v[102:103], v158 offset:28096
    ds_read_b64_tr_b16 v[104:105], v158 offset:26880
    ds_read_b64_tr_b16 v[106:107], v158 offset:28160
    ds_read_b128 v[84:87], v157 offset:26624
    ds_read_b64_tr_b16 v[108:109], v158 offset:31744
    ds_read_b64_tr_b16 v[110:111], v158 offset:33024
    ds_read_b64_tr_b16 v[112:113], v158 offset:31808
    ds_read_b64_tr_b16 v[114:115], v158 offset:33088
    ds_read_b64_tr_b16 v[116:117], v158 offset:31872
    ds_read_b64_tr_b16 v[118:119], v158 offset:33152
    ds_read_b64_tr_b16 v[120:121], v158 offset:31936
    ds_read_b64_tr_b16 v[122:123], v158 offset:33216
    ds_read_b64_tr_b16 v[124:125], v158 offset:32000
    ds_read_b64_tr_b16 v[126:127], v158 offset:33280
    s_add_u32 m0, s24, 53248
    s_nop 0
    global_load_lds_dwordx4 v[132:133], off
    v_lshl_add_u64 v[132:133], v[132:133], 0, s[40:41]
    s_add_u32 m0, s25, 53248
    s_nop 0
    global_load_lds_dwordx4 v[134:135], off
    v_lshl_add_u64 v[134:135], v[134:135], 0, s[42:43]
    s_add_u32 m0, s26, 53248
    s_nop 0
    global_load_lds_dwordx4 v[136:137], off
    v_lshl_add_u64 v[136:137], v[136:137], 0, s[44:45]
    s_waitcnt lgkmcnt(11)
    v_mfma_f32_32x32x16_bf16 v[0:15], v[88:91], v[80:83], v[0:15]
    v_mfma_f32_32x32x16_bf16 v[16:31], v[92:95], v[80:83], v[16:31]
    v_mfma_f32_32x32x16_bf16 v[32:47], v[96:99], v[80:83], v[32:47]
    v_mfma_f32_32x32x16_bf16 v[48:63], v[100:103], v[80:83], v[48:63]
    v_mfma_f32_32x32x16_bf16 v[64:79], v[104:107], v[80:83], v[64:79]
    s_waitcnt lgkmcnt(0)
    v_mfma_f32_32x32x16_bf16 v[0:15], v[108:111], v[84:87], v[0:15]
    v_mfma_f32_32x32x16_bf16 v[16:31], v[112:115], v[84:87], v[16:31]
    v_mfma_f32_32x32x16_bf16 v[32:47], v[116:119], v[84:87], v[32:47]
    v_mfma_f32_32x32x16_bf16 v[48:63], v[120:123], v[84:87], v[48:63]
    v_mfma_f32_32x32x16_bf16 v[64:79], v[124:127], v[84:87], v[64:79]
    v_add_u32 v156, 106496, v128
    v_add_u32 v158, 106496, v130
    v_add_u32 v157, 106496, v129
    v_add_u32 v159, 106496, v131
    s_waitcnt vmcnt(9)
    s_barrier
    ds_read_b128 v[80:83], v156 offset:0
    ds_read_b64_tr_b16 v[88:89], v158 offset:0
    ds_read_b64_tr_b16 v[90:91], v158 offset:1280
    ds_read_b64_tr_b16 v[92:93], v158 offset:64
    ds_read_b64_tr_b16 v[94:95], v158 offset:1344
    ds_read_b64_tr_b16 v[96:97], v158 offset:128
    ds_read_b64_tr_b16 v[98:99], v158 offset:1408
    ds_read_b64_tr_b16 v[100:101], v158 offset:192
    ds_read_b64_tr_b16 v[102:103], v158 offset:1472
    ds_read_b64_tr_b16 v[104:105], v158 offset:256
    ds_read_b64_tr_b16 v[106:107], v158 offset:1536
    ds_read_b128 v[84:87], v157 offset:0
    ds_read_b64_tr_b16 v[108:109], v158 offset:5120
    ds_read_b64_tr_b16 v[110:111], v158 offset:6400
    ds_read_b64_tr_b16 v[112:113], v158 offset:5184
    ds_read_b64_tr_b16 v[114:115], v158 offset:6464
    ds_read_b64_tr_b16 v[116:117], v158 offset:5248
    ds_read_b64_tr_b16 v[118:119], v158 offset:6528
    ds_read_b64_tr_b16 v[120:121], v158 offset:5312
    ds_read_b64_tr_b16 v[122:123], v158 offset:6592
    ds_read_b64_tr_b16 v[124:125], v158 offset:5376
    ds_read_b64_tr_b16 v[126:127], v158 offset:6656
    s_add_u32 m0, s24, 79872
    s_nop 0
    global_load_lds_dwordx4 v[132:133], off
    v_lshl_add_u64 v[132:133], v[132:133], 0, s[40:41]
    s_add_u32 m0, s25, 79872
    s_nop 0
    global_load_lds_dwordx4 v[134:135], off
    v_lshl_add_u64 v[134:135], v[134:135], 0, s[42:43]
    s_add_u32 m0, s26, 79872
    s_nop 0
    global_load_lds_dwordx4 v[136:137], off
    v_lshl_add_u64 v[136:137], v[136:137], 0, s[44:45]
    s_waitcnt lgkmcnt(11)
    v_mfma_f32_32x32x16_bf16 v[0:15], v[88:91], v[80:83], v[0:15]
    v_mfma_f32_32x32x16_bf16 v[16:31], v[92:95], v[80:83], v[16:31]
    v_mfma_f32_32x32x16_bf16 v[32:47], v[96:99], v[80:83], v[32:47]
    v_mfma_f32_32x32x16_bf16 v[48:63], v[100:103], v[80:83], v[48:63]
    v_mfma_f32_32x32x16_bf16 v[64:79], v[104:107], v[80:83], v[64:79]
    s_waitcnt lgkmcnt(0)
    v_mfma_f32_32x32x16_bf16 v[0:15], v[108:111], v[84:87], v[0:15]
    v_mfma_f32_32x32x16_bf16 v[16:31], v[112:115], v[84:87], v[16:31]
    v_mfma_f32_32x32x16_bf16 v[32:47], v[116:119], v[84:87], v[32:47]
    v_mfma_f32_32x32x16_bf16 v[48:63], v[120:123], v[84:87], v[48:63]
    v_mfma_f32_32x32x16_bf16 v[64:79], v[124:127], v[84:87], v[64:79]
    s_waitcnt vmcnt(9)
    s_barrier
    ds_read_b128 v[80:83], v128 offset:0
    ds_read_b64_tr_b16 v[88:89], v130 offset:0
    ds_read_b64_tr_b16 v[90:91], v130 offset:1280
    ds_read_b64_tr_b16 v[92:93], v130 offset:64
    ds_read_b64_tr_b16 v[94:95], v130 offset:1344
    ds_read_b64_tr_b16 v[96:97], v130 offset:128
    ds_read_b64_tr_b16 v[98:99], v130 offset:1408
    ds_read_b64_tr_b16 v[100:101], v130 offset:192
    ds_read_b64_tr_b16 v[102:103], v130 offset:1472
    ds_read_b64_tr_b16 v[104:105], v130 offset:256
    ds_read_b64_tr_b16 v[106:107], v130 offset:1536
    ds_read_b128 v[84:87], v129 offset:0
    ds_read_b64_tr_b16 v[108:109], v130 offset:5120
    ds_read_b64_tr_b16 v[110:111], v130 offset:6400
    ds_read_b64_tr_b16 v[112:113], v130 offset:5184
    ds_read_b64_tr_b16 v[114:115], v130 offset:6464
    ds_read_b64_tr_b16 v[116:117], v130 offset:5248
    ds_read_b64_tr_b16 v[118:119], v130 offset:6528
    ds_read_b64_tr_b16 v[120:121], v130 offset:5312
    ds_read_b64_tr_b16 v[122:123], v130 offset:6592
    ds_read_b64_tr_b16 v[124:125], v130 offset:5376
    ds_read_b64_tr_b16 v[126:127], v130 offset:6656
    s_add_u32 m0, s24, 106496
    s_nop 0
    global_load_lds_dwordx4 v[132:133], off
    v_lshl_add_u64 v[132:133], v[132:133], 0, s[40:41]
    s_add_u32 m0, s25, 106496
    s_nop 0
    global_load_lds_dwordx4 v[134:135], off
    v_lshl_add_u64 v[134:135], v[134:135], 0, s[42:43]
    s_add_u32 m0, s26, 106496
    s_nop 0
    global_load_lds_dwordx4 v[136:137], off
    v_lshl_add_u64 v[136:137], v[136:137], 0, s[44:45]
    s_waitcnt lgkmcnt(11)
    v_mfma_f32_32x32x16_bf16 v[0:15], v[88:91], v[80:83], v[0:15]
    v_mfma_f32_32x32x16_bf16 v[16:31], v[92:95], v[80:83], v[16:31]
    v_mfma_f32_32x32x16_bf16 v[32:47], v[96:99], v[80:83], v[32:47]
    v_mfma_f32_32x32x16_bf16 v[48:63], v[100:103], v[80:83], v[48:63]
    v_mfma_f32_32x32x16_bf16 v[64:79], v[104:107], v[80:83], v[64:79]
    s_waitcnt lgkmcnt(0)
    v_mfma_f32_32x32x16_bf16 v[0:15], v[108:111], v[84:87], v[0:15]
    v_mfma_f32_32x32x16_bf16 v[16:31], v[112:115], v[84:87], v[16:31]
    v_mfma_f32_32x32x16_bf16 v[32:47], v[116:119], v[84:87], v[32:47]
    v_mfma_f32_32x32x16_bf16 v[48:63], v[120:123], v[84:87], v[48:63]
    v_mfma_f32_32x32x16_bf16 v[64:79], v[124:127], v[84:87], v[64:79]
    s_waitcnt vmcnt(9)
    s_barrier
    ds_read_b128 v[80:83], v128 offset:26624
    ds_read_b64_tr_b16 v[88:89], v130 offset:26624
    ds_read_b64_tr_b16 v[90:91], v130 offset:27904
    ds_read_b64_tr_b16 v[92:93], v130 offset:26688
    ds_read_b64_tr_b16 v[94:95], v130 offset:27968
    ds_read_b64_tr_b16 v[96:97], v130 offset:26752
    ds_read_b64_tr_b16 v[98:99], v130 offset:28032
    ds_read_b64_tr_b16 v[100:101], v130 offset:26816
    ds_read_b64_tr_b16 v[102:103], v130 offset:28096
    ds_read_b64_tr_b16 v[104:105], v130 offset:26880
    ds_read_b64_tr_b16 v[106:107], v130 offset:28160
    ds_read_b128 v[84:87], v129 offset:26624
    ds_read_b64_tr_b16 v[108:109], v130 offset:31744
    ds_read_b64_tr_b16 v[110:111], v130 offset:33024
    ds_read_b64_tr_b16 v[112:113], v130 offset:31808
    ds_read_b64_tr_b16 v[114:115], v130 offset:33088
    ds_read_b64_tr_b16 v[116:117], v130 offset:31872
    ds_read_b64_tr_b16 v[118:119], v130 offset:33152
    ds_read_b64_tr_b16 v[120:121], v130 offset:31936
    ds_read_b64_tr_b16 v[122:123], v130 offset:33216
    ds_read_b64_tr_b16 v[124:125], v130 offset:32000
    ds_read_b64_tr_b16 v[126:127], v130 offset:33280
    s_add_u32 m0, s24, 0
    s_nop 0
    global_load_lds_dwordx4 v[132:133], off
    v_lshl_add_u64 v[132:133], v[132:133], 0, s[40:41]
    s_add_u32 m0, s25, 0
    s_nop 0
    global_load_lds_dwordx4 v[134:135], off
    v_lshl_add_u64 v[134:135], v[134:135], 0, s[42:43]
    s_add_u32 m0, s26, 0
    s_nop 0
    global_load_lds_dwordx4 v[136:137], off
    v_lshl_add_u64 v[136:137], v[136:137], 0, s[44:45]
    s_waitcnt lgkmcnt(11)
    v_mfma_f32_32x32x16_bf16 v[0:15], v[88:91], v[80:83], v[0:15]
    v_mfma_f32_32x32x16_bf16 v[16:31], v[92:95], v[80:83], v[16:31]
    v_mfma_f32_32x32x16_bf16 v[32:47], v[96:99], v[80:83], v[32:47]
    v_mfma_f32_32x32x16_bf16 v[48:63], v[100:103], v[80:83], v[48:63]
    v_mfma_f32_32x32x16_bf16 v[64:79], v[104:107], v[80:83], v[64:79]
    s_waitcnt lgkmcnt(0)
    v_mfma_f32_32x32x16_bf16 v[0:15], v[108:111], v[84:87], v[0:15]
    v_mfma_f32_32x32x16_bf16 v[16:31], v[112:115], v[84:87], v[16:31]
    v_mfma_f32_32x32x16_bf16 v[32:47], v[116:119], v[84:87], v[32:47]
    v_mfma_f32_32x32x16_bf16 v[48:63], v[120:123], v[84:87], v[48:63]
    v_mfma_f32_32x32x16_bf16 v[64:79], v[124:127], v[84:87], v[64:79]
    v_add_u32 v156, 53248, v128
    v_add_u32 v158, 53248, v130
    v_add_u32 v157, 53248, v129
    v_add_u32 v159, 53248, v131
    s_waitcnt vmcnt(9)
    s_barrier
    ds_read_b128 v[80:83], v156 offset:0
    ds_read_b64_tr_b16 v[88:89], v158 offset:0
    ds_read_b64_tr_b16 v[90:91], v158 offset:1280
    ds_read_b64_tr_b16 v[92:93], v158 offset:64
    ds_read_b64_tr_b16 v[94:95], v158 offset:1344
    ds_read_b64_tr_b16 v[96:97], v158 offset:128
    ds_read_b64_tr_b16 v[98:99], v158 offset:1408
    ds_read_b64_tr_b16 v[100:101], v158 offset:192
    ds_read_b64_tr_b16 v[102:103], v158 offset:1472
    ds_read_b64_tr_b16 v[104:105], v158 offset:256
    ds_read_b64_tr_b16 v[106:107], v158 offset:1536
    ds_read_b128 v[84:87], v157 offset:0
    ds_read_b64_tr_b16 v[108:109], v158 offset:5120
    ds_read_b64_tr_b16 v[110:111], v158 offset:6400
    ds_read_b64_tr_b16 v[112:113], v158 offset:5184
    ds_read_b64_tr_b16 v[114:115], v158 offset:6464
    ds_read_b64_tr_b16 v[116:117], v158 offset:5248
    ds_read_b64_tr_b16 v[118:119], v158 offset:6528
    ds_read_b64_tr_b16 v[120:121], v158 offset:5312
    ds_read_b64_tr_b16 v[122:123], v158 offset:6592
    ds_read_b64_tr_b16 v[124:125], v158 offset:5376
    ds_read_b64_tr_b16 v[126:127], v158 offset:6656
    s_add_u32 m0, s24, 26624
    s_nop 0
    global_load_lds_dwordx4 v[132:133], off
    v_lshl_add_u64 v[132:133], v[132:133], 0, s[40:41]
    s_add_u32 m0, s25, 26624
    s_nop 0
    global_load_lds_dwordx4 v[134:135], off
    v_lshl_add_u64 v[134:135], v[134:135], 0, s[42:43]
    s_add_u32 m0, s26, 26624
    s_nop 0
    global_load_lds_dwordx4 v[136:137], off
    v_lshl_add_u64 v[136:137], v[136:137], 0, s[44:45]
    s_waitcnt lgkmcnt(11)
    v_mfma_f32_32x32x16_bf16 v[0:15], v[88:91], v[80:83], v[0:15]
    v_mfma_f32_32x32x16_bf16 v[16:31], v[92:95], v[80:83], v[16:31]
    v_mfma_f32_32x32x16_bf16 v[32:47], v[96:99], v[80:83], v[32:47]
    v_mfma_f32_32x32x16_bf16 v[48:63], v[100:103], v[80:83], v[48:63]
    v_mfma_f32_32x32x16_bf16 v[64:79], v[104:107], v[80:83], v[64:79]
    s_waitcnt lgkmcnt(0)
    v_mfma_f32_32x32x16_bf16 v[0:15], v[108:111], v[84:87], v[0:15]
    v_mfma_f32_32x32x16_bf16 v[16:31], v[112:115], v[84:87], v[16:31]
    v_mfma_f32_32x32x16_bf16 v[32:47], v[116:119], v[84:87], v[32:47]
    v_mfma_f32_32x32x16_bf16 v[48:63], v[120:123], v[84:87], v[48:63]
    v_mfma_f32_32x32x16_bf16 v[64:79], v[124:127], v[84:87], v[64:79]
    v_add_u32 v156, 53248, v128
    v_add_u32 v158, 53248, v130
    v_add_u32 v157, 53248, v129
    v_add_u32 v159, 53248, v131
    s_waitcnt vmcnt(9)
    s_barrier
    ds_read_b128 v[80:83], v156 offset:26624
    ds_read_b64_tr_b16 v[88:89], v158 offset:26624
    ds_read_b64_tr_b16 v[90:91], v158 offset:27904
    ds_read_b64_tr_b16 v[92:93], v158 offset:26688
    ds_read_b64_tr_b16 v[94:95], v158 offset:27968
    ds_read_b64_tr_b16 v[96:97], v158 offset:26752
    ds_read_b64_tr_b16 v[98:99], v158 offset:28032
    ds_read_b64_tr_b16 v[100:101], v158 offset:26816
    ds_read_b64_tr_b16 v[102:103], v158 offset:28096
    ds_read_b64_tr_b16 v[104:105], v158 offset:26880
    ds_read_b64_tr_b16 v[106:107], v158 offset:28160
    ds_read_b128 v[84:87], v157 offset:26624
    ds_read_b64_tr_b16 v[108:109], v158 offset:31744
    ds_read_b64_tr_b16 v[110:111], v158 offset:33024
    ds_read_b64_tr_b16 v[112:113], v158 offset:31808
    ds_read_b64_tr_b16 v[114:115], v158 offset:33088
    ds_read_b64_tr_b16 v[116:117], v158 offset:31872
    ds_read_b64_tr_b16 v[118:119], v158 offset:33152
    ds_read_b64_tr_b16 v[120:121], v158 offset:31936
    ds_read_b64_tr_b16 v[122:123], v158 offset:33216
    ds_read_b64_tr_b16 v[124:125], v158 offset:32000
    ds_read_b64_tr_b16 v[126:127], v158 offset:33280
    s_add_u32 m0, s24, 53248
    s_nop 0
    global_load_lds_dwordx4 v[132:133], off
    v_lshl_add_u64 v[132:133], v[132:133], 0, s[40:41]
    s_add_u32 m0, s25, 53248
    s_nop 0
    global_load_lds_dwordx4 v[134:135], off
    v_lshl_add_u64 v[134:135], v[134:135], 0, s[42:43]
    s_add_u32 m0, s26, 53248
    s_nop 0
    global_load_lds_dwordx4 v[136:137], off
    v_lshl_add_u64 v[136:137], v[136:137], 0, s[44:45]
    s_waitcnt lgkmcnt(11)
    v_mfma_f32_32x32x16_bf16 v[0:15], v[88:91], v[80:83], v[0:15]
    v_mfma_f32_32x32x16_bf16 v[16:31], v[92:95], v[80:83], v[16:31]
    v_mfma_f32_32x32x16_bf16 v[32:47], v[96:99], v[80:83], v[32:47]
    v_mfma_f32_32x32x16_bf16 v[48:63], v[100:103], v[80:83], v[48:63]
    v_mfma_f32_32x32x16_bf16 v[64:79], v[104:107], v[80:83], v[64:79]
    s_waitcnt lgkmcnt(0)
    v_mfma_f32_32x32x16_bf16 v[0:15], v[108:111], v[84:87], v[0:15]
    v_mfma_f32_32x32x16_bf16 v[16:31], v[112:115], v[84:87], v[16:31]
    v_mfma_f32_32x32x16_bf16 v[32:47], v[116:119], v[84:87], v[32:47]
    v_mfma_f32_32x32x16_bf16 v[48:63], v[120:123], v[84:87], v[48:63]
    v_mfma_f32_32x32x16_bf16 v[64:79], v[124:127], v[84:87], v[64:79]
    v_add_u32 v156, 106496, v128
    v_add_u32 v158, 106496, v130
    v_add_u32 v157, 106496, v129
    v_add_u32 v159, 106496, v131
    s_waitcnt vmcnt(9)
    s_barrier
    ds_read_b128 v[80:83], v156 offset:0
    ds_read_b64_tr_b16 v[88:89], v158 offset:0
    ds_read_b64_tr_b16 v[90:91], v158 offset:1280
    ds_read_b64_tr_b16 v[92:93], v158 offset:64
    ds_read_b64_tr_b16 v[94:95], v158 offset:1344
    ds_read_b64_tr_b16 v[96:97], v158 offset:128
    ds_read_b64_tr_b16 v[98:99], v158 offset:1408
    ds_read_b64_tr_b16 v[100:101], v158 offset:192
    ds_read_b64_tr_b16 v[102:103], v158 offset:1472
    ds_read_b64_tr_b16 v[104:105], v158 offset:256
    ds_read_b64_tr_b16 v[106:107], v158 offset:1536
    ds_read_b128 v[84:87], v157 offset:0
    ds_read_b64_tr_b16 v[108:109], v158 offset:5120
    ds_read_b64_tr_b16 v[110:111], v158 offset:6400
    ds_read_b64_tr_b16 v[112:113], v158 offset:5184
    ds_read_b64_tr_b16 v[114:115], v158 offset:6464
    ds_read_b64_tr_b16 v[116:117], v158 offset:5248
    ds_read_b64_tr_b16 v[118:119], v158 offset:6528
    ds_read_b64_tr_b16 v[120:121], v158 offset:5312
    ds_read_b64_tr_b16 v[122:123], v158 offset:6592
    ds_read_b64_tr_b16 v[124:125], v158 offset:5376
    ds_read_b64_tr_b16 v[126:127], v158 offset:6656
    s_add_u32 m0, s24, 79872
    s_nop 0
    global_load_lds_dwordx4 v[132:133], off
    v_lshl_add_u64 v[132:133], v[132:133], 0, s[40:41]
    s_add_u32 m0, s25, 79872
    s_nop 0
    global_load_lds_dwordx4 v[134:135], off
    v_lshl_add_u64 v[134:135], v[134:135], 0, s[42:43]
    s_add_u32 m0, s26, 79872
    s_nop 0
    global_load_lds_dwordx4 v[136:137], off
    v_lshl_add_u64 v[136:137], v[136:137], 0, s[44:45]
    s_waitcnt lgkmcnt(11)
    v_mfma_f32_32x32x16_bf16 v[0:15], v[88:91], v[80:83], v[0:15]
    v_mfma_f32_32x32x16_bf16 v[16:31], v[92:95], v[80:83], v[16:31]
    v_mfma_f32_32x32x16_bf16 v[32:47], v[96:99], v[80:83], v[32:47]
    v_mfma_f32_32x32x16_bf16 v[48:63], v[100:103], v[80:83], v[48:63]
    v_mfma_f32_32x32x16_bf16 v[64:79], v[104:107], v[80:83], v[64:79]
    s_waitcnt lgkmcnt(0)
    v_mfma_f32_32x32x16_bf16 v[0:15], v[108:111], v[84:87], v[0:15]
    v_mfma_f32_32x32x16_bf16 v[16:31], v[112:115], v[84:87], v[16:31]
    v_mfma_f32_32x32x16_bf16 v[32:47], v[116:119], v[84:87], v[32:47]
    v_mfma_f32_32x32x16_bf16 v[48:63], v[120:123], v[84:87], v[48:63]
    v_mfma_f32_32x32x16_bf16 v[64:79], v[124:127], v[84:87], v[64:79]
    s_waitcnt vmcnt(9)
    s_barrier
    ds_read_b128 v[80:83], v128 offset:0
    ds_read_b64_tr_b16 v[88:89], v130 offset:0
    ds_read_b64_tr_b16 v[90:91], v130 offset:1280
    ds_read_b64_tr_b16 v[92:93], v130 offset:64
    ds_read_b64_tr_b16 v[94:95], v130 offset:1344
    ds_read_b64_tr_b16 v[96:97], v130 offset:128
    ds_read_b64_tr_b16 v[98:99], v130 offset:1408
    ds_read_b64_tr_b16 v[100:101], v130 offset:192
    ds_read_b64_tr_b16 v[102:103], v130 offset:1472
    ds_read_b64_tr_b16 v[104:105], v130 offset:256
    ds_read_b64_tr_b16 v[106:107], v130 offset:1536
    ds_read_b128 v[84:87], v129 offset:0
    ds_read_b64_tr_b16 v[108:109], v130 offset:5120
    ds_read_b64_tr_b16 v[110:111], v130 offset:6400
    ds_read_b64_tr_b16 v[112:113], v130 offset:5184
    ds_read_b64_tr_b16 v[114:115], v130 offset:6464
    ds_read_b64_tr_b16 v[116:117], v130 offset:5248
    ds_read_b64_tr_b16 v[118:119], v130 offset:6528
    ds_read_b64_tr_b16 v[120:121], v130 offset:5312
    ds_read_b64_tr_b16 v[122:123], v130 offset:6592
    ds_read_b64_tr_b16 v[124:125], v130 offset:5376
    ds_read_b64_tr_b16 v[126:127], v130 offset:6656
    s_add_u32 m0, s24, 106496
    s_nop 0
    global_load_lds_dwordx4 v[132:133], off
    v_lshl_add_u64 v[132:133], v[132:133], 0, s[40:41]
    s_add_u32 m0, s25, 106496
    s_nop 0
    global_load_lds_dwordx4 v[134:135], off
    v_lshl_add_u64 v[134:135], v[134:135], 0, s[42:43]
    s_add_u32 m0, s26, 106496
    s_nop 0
    global_load_lds_dwordx4 v[136:137], off
    v_lshl_add_u64 v[136:137], v[136:137], 0, s[44:45]
    s_waitcnt lgkmcnt(11)
    v_mfma_f32_32x32x16_bf16 v[0:15], v[88:91], v[80:83], v[0:15]
    v_mfma_f32_32x32x16_bf16 v[16:31], v[92:95], v[80:83], v[16:31]
    v_mfma_f32_32x32x16_bf16 v[32:47], v[96:99], v[80:83], v[32:47]
    v_mfma_f32_32x32x16_bf16 v[48:63], v[100:103], v[80:83], v[48:63]
    v_mfma_f32_32x32x16_bf16 v[64:79], v[104:107], v[80:83], v[64:79]
    s_waitcnt lgkmcnt(0)
    v_mfma_f32_32x32x16_bf16 v[0:15], v[108:111], v[84:87], v[0:15]
    v_mfma_f32_32x32x16_bf16 v[16:31], v[112:115], v[84:87], v[16:31]
    v_mfma_f32_32x32x16_bf16 v[32:47], v[116:119], v[84:87], v[32:47]
    v_mfma_f32_32x32x16_bf16 v[48:63], v[120:123], v[84:87], v[48:63]
    v_mfma_f32_32x32x16_bf16 v[64:79], v[124:127], v[84:87], v[64:79]
    s_waitcnt vmcnt(9)
    s_barrier
    ds_read_b128 v[80:83], v128 offset:26624
    ds_read_b64_tr_b16 v[88:89], v130 offset:26624
    ds_read_b64_tr_b16 v[90:91], v130 offset:27904
    ds_read_b64_tr_b16 v[92:93], v130 offset:26688
    ds_read_b64_tr_b16 v[94:95], v130 offset:27968
    ds_read_b64_tr_b16 v[96:97], v130 offset:26752
    ds_read_b64_tr_b16 v[98:99], v130 offset:28032
    ds_read_b64_tr_b16 v[100:101], v130 offset:26816
    ds_read_b64_tr_b16 v[102:103], v130 offset:28096
    ds_read_b64_tr_b16 v[104:105], v130 offset:26880
    ds_read_b64_tr_b16 v[106:107], v130 offset:28160
    ds_read_b128 v[84:87], v129 offset:26624
    ds_read_b64_tr_b16 v[108:109], v130 offset:31744
    ds_read_b64_tr_b16 v[110:111], v130 offset:33024
    ds_read_b64_tr_b16 v[112:113], v130 offset:31808
    ds_read_b64_tr_b16 v[114:115], v130 offset:33088
    ds_read_b64_tr_b16 v[116:117], v130 offset:31872
    ds_read_b64_tr_b16 v[118:119], v130 offset:33152
    ds_read_b64_tr_b16 v[120:121], v130 offset:31936
    ds_read_b64_tr_b16 v[122:123], v130 offset:33216
    ds_read_b64_tr_b16 v[124:125], v130 offset:32000
    ds_read_b64_tr_b16 v[126:127], v130 offset:33280
    s_add_u32 m0, s24, 0
    s_nop 0
    global_load_lds_dwordx4 v[132:133], off
    v_lshl_add_u64 v[132:133], v[132:133], 0, s[40:41]
    s_add_u32 m0, s25, 0
    s_nop 0
    global_load_lds_dwordx4 v[134:135], off
    v_lshl_add_u64 v[134:135], v[134:135], 0, s[42:43]
    s_add_u32 m0, s26, 0
    s_nop 0
    global_load_lds_dwordx4 v[136:137], off
    v_lshl_add_u64 v[136:137], v[136:137], 0, s[44:45]
    s_waitcnt lgkmcnt(11)
    v_mfma_f32_32x32x16_bf16 v[0:15], v[88:91], v[80:83], v[0:15]
    v_mfma_f32_32x32x16_bf16 v[16:31], v[92:95], v[80:83], v[16:31]
    v_mfma_f32_32x32x16_bf16 v[32:47], v[96:99], v[80:83], v[32:47]
    v_mfma_f32_32x32x16_bf16 v[48:63], v[100:103], v[80:83], v[48:63]
    v_mfma_f32_32x32x16_bf16 v[64:79], v[104:107], v[80:83], v[64:79]
    s_waitcnt lgkmcnt(0)
    v_mfma_f32_32x32x16_bf16 v[0:15], v[108:111], v[84:87], v[0:15]
    v_mfma_f32_32x32x16_bf16 v[16:31], v[112:115], v[84:87], v[16:31]
    v_mfma_f32_32x32x16_bf16 v[32:47], v[116:119], v[84:87], v[32:47]
    v_mfma_f32_32x32x16_bf16 v[48:63], v[120:123], v[84:87], v[48:63]
    v_mfma_f32_32x32x16_bf16 v[64:79], v[124:127], v[84:87], v[64:79]
    v_add_u32 v156, 53248, v128
    v_add_u32 v158, 53248, v130
    v_add_u32 v157, 53248, v129
    v_add_u32 v159, 53248, v131
    s_waitcnt vmcnt(9)
    s_barrier
    ds_read_b128 v[80:83], v156 offset:0
    ds_read_b64_tr_b16 v[88:89], v158 offset:0
    ds_read_b64_tr_b16 v[90:91], v158 offset:1280
    ds_read_b64_tr_b16 v[92:93], v158 offset:64
    ds_read_b64_tr_b16 v[94:95], v158 offset:1344
    ds_read_b64_tr_b16 v[96:97], v158 offset:128
    ds_read_b64_tr_b16 v[98:99], v158 offset:1408
    ds_read_b64_tr_b16 v[100:101], v158 offset:192
    ds_read_b64_tr_b16 v[102:103], v158 offset:1472
    ds_read_b64_tr_b16 v[104:105], v158 offset:256
    ds_read_b64_tr_b16 v[106:107], v158 offset:1536
    ds_read_b128 v[84:87], v157 offset:0
    ds_read_b64_tr_b16 v[108:109], v158 offset:5120
    ds_read_b64_tr_b16 v[110:111], v158 offset:6400
    ds_read_b64_tr_b16 v[112:113], v158 offset:5184
    ds_read_b64_tr_b16 v[114:115], v158 offset:6464
    ds_read_b64_tr_b16 v[116:117], v158 offset:5248
    ds_read_b64_tr_b16 v[118:119], v158 offset:6528
    ds_read_b64_tr_b16 v[120:121], v158 offset:5312
    ds_read_b64_tr_b16 v[122:123], v158 offset:6592
    ds_read_b64_tr_b16 v[124:125], v158 offset:5376
    ds_read_b64_tr_b16 v[126:127], v158 offset:6656
    s_add_u32 m0, s24, 26624
    s_nop 0
    global_load_lds_dwordx4 v[132:133], off
    v_lshl_add_u64 v[132:133], v[132:133], 0, s[40:41]
    s_add_u32 m0, s25, 26624
    s_nop 0
    global_load_lds_dwordx4 v[134:135], off
    v_lshl_add_u64 v[134:135], v[134:135], 0, s[42:43]
    s_add_u32 m0, s26, 26624
    s_nop 0
    global_load_lds_dwordx4 v[136:137], off
    v_lshl_add_u64 v[136:137], v[136:137], 0, s[44:45]
    s_waitcnt lgkmcnt(11)
    v_mfma_f32_32x32x16_bf16 v[0:15], v[88:91], v[80:83], v[0:15]
    v_mfma_f32_32x32x16_bf16 v[16:31], v[92:95], v[80:83], v[16:31]
    v_mfma_f32_32x32x16_bf16 v[32:47], v[96:99], v[80:83], v[32:47]
    v_mfma_f32_32x32x16_bf16 v[48:63], v[100:103], v[80:83], v[48:63]
    v_mfma_f32_32x32x16_bf16 v[64:79], v[104:107], v[80:83], v[64:79]
    s_waitcnt lgkmcnt(0)
    v_mfma_f32_32x32x16_bf16 v[0:15], v[108:111], v[84:87], v[0:15]
    v_mfma_f32_32x32x16_bf16 v[16:31], v[112:115], v[84:87], v[16:31]
    v_mfma_f32_32x32x16_bf16 v[32:47], v[116:119], v[84:87], v[32:47]
    v_mfma_f32_32x32x16_bf16 v[48:63], v[120:123], v[84:87], v[48:63]
    v_mfma_f32_32x32x16_bf16 v[64:79], v[124:127], v[84:87], v[64:79]
    v_add_u32 v156, 53248, v128
    v_add_u32 v158, 53248, v130
    v_add_u32 v157, 53248, v129
    v_add_u32 v159, 53248, v131
    s_waitcnt vmcnt(9)
    s_barrier
    ds_read_b128 v[80:83], v156 offset:26624
    ds_read_b64_tr_b16 v[88:89], v158 offset:26624
    ds_read_b64_tr_b16 v[90:91], v158 offset:27904
    ds_read_b64_tr_b16 v[92:93], v158 offset:26688
    ds_read_b64_tr_b16 v[94:95], v158 offset:27968
    ds_read_b64_tr_b16 v[96:97], v158 offset:26752
    ds_read_b64_tr_b16 v[98:99], v158 offset:28032
    ds_read_b64_tr_b16 v[100:101], v158 offset:26816
    ds_read_b64_tr_b16 v[102:103], v158 offset:28096
    ds_read_b64_tr_b16 v[104:105], v158 offset:26880
    ds_read_b64_tr_b16 v[106:107], v158 offset:28160
    ds_read_b128 v[84:87], v157 offset:26624
    ds_read_b64_tr_b16 v[108:109], v158 offset:31744
    ds_read_b64_tr_b16 v[110:111], v158 offset:33024
    ds_read_b64_tr_b16 v[112:113], v158 offset:31808
    ds_read_b64_tr_b16 v[114:115], v158 offset:33088
    ds_read_b64_tr_b16 v[116:117], v158 offset:31872
    ds_read_b64_tr_b16 v[118:119], v158 offset:33152
    ds_read_b64_tr_b16 v[120:121], v158 offset:31936
    ds_read_b64_tr_b16 v[122:123], v158 offset:33216
    ds_read_b64_tr_b16 v[124:125], v158 offset:32000
    ds_read_b64_tr_b16 v[126:127], v158 offset:33280
    s_add_u32 m0, s24, 53248
    s_nop 0
    global_load_lds_dwordx4 v[132:133], off
    v_lshl_add_u64 v[132:133], v[132:133], 0, s[40:41]
    s_add_u32 m0, s25, 53248
    s_nop 0
    global_load_lds_dwordx4 v[134:135], off
    v_lshl_add_u64 v[134:135], v[134:135], 0, s[42:43]
    s_add_u32 m0, s26, 53248
    s_nop 0
    global_load_lds_dwordx4 v[136:137], off
    v_lshl_add_u64 v[136:137], v[136:137], 0, s[44:45]
    s_waitcnt lgkmcnt(11)
    v_mfma_f32_32x32x16_bf16 v[0:15], v[88:91], v[80:83], v[0:15]
    v_mfma_f32_32x32x16_bf16 v[16:31], v[92:95], v[80:83], v[16:31]
    v_mfma_f32_32x32x16_bf16 v[32:47], v[96:99], v[80:83], v[32:47]
    v_mfma_f32_32x32x16_bf16 v[48:63], v[100:103], v[80:83], v[48:63]
    v_mfma_f32_32x32x16_bf16 v[64:79], v[104:107], v[80:83], v[64:79]
    s_waitcnt lgkmcnt(0)
    v_mfma_f32_32x32x16_bf16 v[0:15], v[108:111], v[84:87], v[0:15]
    v_mfma_f32_32x32x16_bf16 v[16:31], v[112:115], v[84:87], v[16:31]
    v_mfma_f32_32x32x16_bf16 v[32:47], v[116:119], v[84:87], v[32:47]
    v_mfma_f32_32x32x16_bf16 v[48:63], v[120:123], v[84:87], v[48:63]
    v_mfma_f32_32x32x16_bf16 v[64:79], v[124:127], v[84:87], v[64:79]
    v_add_u32 v156, 106496, v128
    v_add_u32 v158, 106496, v130
    v_add_u32 v157, 106496, v129
    v_add_u32 v159, 106496, v131
    s_waitcnt vmcnt(9)
    s_barrier
    ds_read_b128 v[80:83], v156 offset:0
    ds_read_b64_tr_b16 v[88:89], v158 offset:0
    ds_read_b64_tr_b16 v[90:91], v158 offset:1280
    ds_read_b64_tr_b16 v[92:93], v158 offset:64
    ds_read_b64_tr_b16 v[94:95], v158 offset:1344
    ds_read_b64_tr_b16 v[96:97], v158 offset:128
    ds_read_b64_tr_b16 v[98:99], v158 offset:1408
    ds_read_b64_tr_b16 v[100:101], v158 offset:192
    ds_read_b64_tr_b16 v[102:103], v158 offset:1472
    ds_read_b64_tr_b16 v[104:105], v158 offset:256
    ds_read_b64_tr_b16 v[106:107], v158 offset:1536
    ds_read_b128 v[84:87], v157 offset:0
    ds_read_b64_tr_b16 v[108:109], v158 offset:5120
    ds_read_b64_tr_b16 v[110:111], v158 offset:6400
    ds_read_b64_tr_b16 v[112:113], v158 offset:5184
    ds_read_b64_tr_b16 v[114:115], v158 offset:6464
    ds_read_b64_tr_b16 v[116:117], v158 offset:5248
    ds_read_b64_tr_b16 v[118:119], v158 offset:6528
    ds_read_b64_tr_b16 v[120:121], v158 offset:5312
    ds_read_b64_tr_b16 v[122:123], v158 offset:6592
    ds_read_b64_tr_b16 v[124:125], v158 offset:5376
    ds_read_b64_tr_b16 v[126:127], v158 offset:6656
    s_add_u32 m0, s24, 79872
    s_nop 0
    global_load_lds_dwordx4 v[132:133], off
    v_lshl_add_u64 v[132:133], v[132:133], 0, s[40:41]
    s_add_u32 m0, s25, 79872
    s_nop 0
    global_load_lds_dwordx4 v[134:135], off
    v_lshl_add_u64 v[134:135], v[134:135], 0, s[42:43]
    s_add_u32 m0, s26, 79872
    s_nop 0
    global_load_lds_dwordx4 v[136:137], off
    v_lshl_add_u64 v[136:137], v[136:137], 0, s[44:45]
    s_waitcnt lgkmcnt(11)
    v_mfma_f32_32x32x16_bf16 v[0:15], v[88:91], v[80:83], v[0:15]
    v_mfma_f32_32x32x16_bf16 v[16:31], v[92:95], v[80:83], v[16:31]
    v_mfma_f32_32x32x16_bf16 v[32:47], v[96:99], v[80:83], v[32:47]
    v_mfma_f32_32x32x16_bf16 v[48:63], v[100:103], v[80:83], v[48:63]
    v_mfma_f32_32x32x16_bf16 v[64:79], v[104:107], v[80:83], v[64:79]
    s_waitcnt lgkmcnt(0)
    v_mfma_f32_32x32x16_bf16 v[0:15], v[108:111], v[84:87], v[0:15]
    v_mfma_f32_32x32x16_bf16 v[16:31], v[112:115], v[84:87], v[16:31]
    v_mfma_f32_32x32x16_bf16 v[32:47], v[116:119], v[84:87], v[32:47]
    v_mfma_f32_32x32x16_bf16 v[48:63], v[120:123], v[84:87], v[48:63]
    v_mfma_f32_32x32x16_bf16 v[64:79], v[124:127], v[84:87], v[64:79]
    s_waitcnt vmcnt(9)
    s_barrier
    ds_read_b128 v[80:83], v128 offset:0
    ds_read_b64_tr_b16 v[88:89], v130 offset:0
    ds_read_b64_tr_b16 v[90:91], v130 offset:1280
    ds_read_b64_tr_b16 v[92:93], v130 offset:64
    ds_read_b64_tr_b16 v[94:95], v130 offset:1344
    ds_read_b64_tr_b16 v[96:97], v130 offset:128
    ds_read_b64_tr_b16 v[98:99], v130 offset:1408
    ds_read_b64_tr_b16 v[100:101], v130 offset:192
    ds_read_b64_tr_b16 v[102:103], v130 offset:1472
    ds_read_b64_tr_b16 v[104:105], v130 offset:256
    ds_read_b64_tr_b16 v[106:107], v130 offset:1536
    ds_read_b128 v[84:87], v129 offset:0
    ds_read_b64_tr_b16 v[108:109], v130 offset:5120
    ds_read_b64_tr_b16 v[110:111], v130 offset:6400
    ds_read_b64_tr_b16 v[112:113], v130 offset:5184
    ds_read_b64_tr_b16 v[114:115], v130 offset:6464
    ds_read_b64_tr_b16 v[116:117], v130 offset:5248
    ds_read_b64_tr_b16 v[118:119], v130 offset:6528
    ds_read_b64_tr_b16 v[120:121], v130 offset:5312
    ds_read_b64_tr_b16 v[122:123], v130 offset:6592
    ds_read_b64_tr_b16 v[124:125], v130 offset:5376
    ds_read_b64_tr_b16 v[126:127], v130 offset:6656
    s_add_u32 m0, s24, 106496
    s_nop 0
    global_load_lds_dwordx4 v[132:133], off
    v_lshl_add_u64 v[132:133], v[132:133], 0, s[40:41]
    s_add_u32 m0, s25, 106496
    s_nop 0
    global_load_lds_dwordx4 v[134:135], off
    v_lshl_add_u64 v[134:135], v[134:135], 0, s[42:43]
    s_add_u32 m0, s26, 106496
    s_nop 0
    global_load_lds_dwordx4 v[136:137], off
    v_lshl_add_u64 v[136:137], v[136:137], 0, s[44:45]
    s_waitcnt lgkmcnt(11)
    v_mfma_f32_32x32x16_bf16 v[0:15], v[88:91], v[80:83], v[0:15]
    v_mfma_f32_32x32x16_bf16 v[16:31], v[92:95], v[80:83], v[16:31]
    v_mfma_f32_32x32x16_bf16 v[32:47], v[96:99], v[80:83], v[32:47]
    v_mfma_f32_32x32x16_bf16 v[48:63], v[100:103], v[80:83], v[48:63]
    v_mfma_f32_32x32x16_bf16 v[64:79], v[104:107], v[80:83], v[64:79]
    s_waitcnt lgkmcnt(0)
    v_mfma_f32_32x32x16_bf16 v[0:15], v[108:111], v[84:87], v[0:15]
    v_mfma_f32_32x32x16_bf16 v[16:31], v[112:115], v[84:87], v[16:31]
    v_mfma_f32_32x32x16_bf16 v[32:47], v[116:119], v[84:87], v[32:47]
    v_mfma_f32_32x32x16_bf16 v[48:63], v[120:123], v[84:87], v[48:63]
    v_mfma_f32_32x32x16_bf16 v[64:79], v[124:127], v[84:87], v[64:79]
    s_waitcnt vmcnt(9)
    s_barrier
    ds_read_b128 v[80:83], v128 offset:26624
    ds_read_b64_tr_b16 v[88:89], v130 offset:26624
    ds_read_b64_tr_b16 v[90:91], v130 offset:27904
    ds_read_b64_tr_b16 v[92:93], v130 offset:26688
    ds_read_b64_tr_b16 v[94:95], v130 offset:27968
    ds_read_b64_tr_b16 v[96:97], v130 offset:26752
    ds_read_b64_tr_b16 v[98:99], v130 offset:28032
    ds_read_b64_tr_b16 v[100:101], v130 offset:26816
    ds_read_b64_tr_b16 v[102:103], v130 offset:28096
    ds_read_b64_tr_b16 v[104:105], v130 offset:26880
    ds_read_b64_tr_b16 v[106:107], v130 offset:28160
    ds_read_b128 v[84:87], v129 offset:26624
    ds_read_b64_tr_b16 v[108:109], v130 offset:31744
    ds_read_b64_tr_b16 v[110:111], v130 offset:33024
    ds_read_b64_tr_b16 v[112:113], v130 offset:31808
    ds_read_b64_tr_b16 v[114:115], v130 offset:33088
    ds_read_b64_tr_b16 v[116:117], v130 offset:31872
    ds_read_b64_tr_b16 v[118:119], v130 offset:33152
    ds_read_b64_tr_b16 v[120:121], v130 offset:31936
    ds_read_b64_tr_b16 v[122:123], v130 offset:33216
    ds_read_b64_tr_b16 v[124:125], v130 offset:32000
    ds_read_b64_tr_b16 v[126:127], v130 offset:33280
    s_waitcnt lgkmcnt(11)
    v_mfma_f32_32x32x16_bf16 v[0:15], v[88:91], v[80:83], v[0:15]
    v_mfma_f32_32x32x16_bf16 v[16:31], v[92:95], v[80:83], v[16:31]
    v_mfma_f32_32x32x16_bf16 v[32:47], v[96:99], v[80:83], v[32:47]
    v_mfma_f32_32x32x16_bf16 v[48:63], v[100:103], v[80:83], v[48:63]
    v_mfma_f32_32x32x16_bf16 v[64:79], v[104:107], v[80:83], v[64:79]
    s_waitcnt lgkmcnt(0)
    v_mfma_f32_32x32x16_bf16 v[0:15], v[108:111], v[84:87], v[0:15]
    v_mfma_f32_32x32x16_bf16 v[16:31], v[112:115], v[84:87], v[16:31]
    v_mfma_f32_32x32x16_bf16 v[32:47], v[116:119], v[84:87], v[32:47]
    v_mfma_f32_32x32x16_bf16 v[48:63], v[120:123], v[84:87], v[48:63]
    v_mfma_f32_32x32x16_bf16 v[64:79], v[124:127], v[84:87], v[64:79]
    v_add_u32 v156, 53248, v128
    v_add_u32 v158, 53248, v130
    v_add_u32 v157, 53248, v129
    v_add_u32 v159, 53248, v131
    s_waitcnt vmcnt(6)
    s_barrier
    ds_read_b128 v[80:83], v156 offset:0
    ds_read_b64_tr_b16 v[88:89], v158 offset:0
    ds_read_b64_tr_b16 v[90:91], v158 offset:1280
    ds_read_b64_tr_b16 v[92:93], v158 offset:64
    ds_read_b64_tr_b16 v[94:95], v158 offset:1344
    ds_read_b64_tr_b16 v[96:97], v158 offset:128
    ds_read_b64_tr_b16 v[98:99], v158 offset:1408
    ds_read_b64_tr_b16 v[100:101], v158 offset:192
    ds_read_b64_tr_b16 v[102:103], v158 offset:1472
    ds_read_b64_tr_b16 v[104:105], v158 offset:256
    ds_read_b64_tr_b16 v[106:107], v158 offset:1536
    ds_read_b128 v[84:87], v157 offset:0
    ds_read_b64_tr_b16 v[108:109], v158 offset:5120
    ds_read_b64_tr_b16 v[110:111], v158 offset:6400
    ds_read_b64_tr_b16 v[112:113], v158 offset:5184
    ds_read_b64_tr_b16 v[114:115], v158 offset:6464
    ds_read_b64_tr_b16 v[116:117], v158 offset:5248
    ds_read_b64_tr_b16 v[118:119], v158 offset:6528
    ds_read_b64_tr_b16 v[120:121], v158 offset:5312
    ds_read_b64_tr_b16 v[122:123], v158 offset:6592
    ds_read_b64_tr_b16 v[124:125], v158 offset:5376
    ds_read_b64_tr_b16 v[126:127], v158 offset:6656
    s_waitcnt lgkmcnt(11)
    v_mfma_f32_32x32x16_bf16 v[0:15], v[88:91], v[80:83], v[0:15]
    v_mfma_f32_32x32x16_bf16 v[16:31], v[92:95], v[80:83], v[16:31]
    v_mfma_f32_32x32x16_bf16 v[32:47], v[96:99], v[80:83], v[32:47]
    v_mfma_f32_32x32x16_bf16 v[48:63], v[100:103], v[80:83], v[48:63]
    v_mfma_f32_32x32x16_bf16 v[64:79], v[104:107], v[80:83], v[64:79]
    s_waitcnt lgkmcnt(0)
    v_mfma_f32_32x32x16_bf16 v[0:15], v[108:111], v[84:87], v[0:15]
    v_mfma_f32_32x32x16_bf16 v[16:31], v[112:115], v[84:87], v[16:31]
    v_mfma_f32_32x32x16_bf16 v[32:47], v[116:119], v[84:87], v[32:47]
    v_mfma_f32_32x32x16_bf16 v[48:63], v[120:123], v[84:87], v[48:63]
    v_mfma_f32_32x32x16_bf16 v[64:79], v[124:127], v[84:87], v[64:79]
    v_add_u32 v156, 53248, v128
    v_add_u32 v158, 53248, v130
    v_add_u32 v157, 53248, v129
    v_add_u32 v159, 53248, v131
    s_waitcnt vmcnt(3)
    s_barrier
    ds_read_b128 v[80:83], v156 offset:26624
    ds_read_b64_tr_b16 v[88:89], v158 offset:26624
    ds_read_b64_tr_b16 v[90:91], v158 offset:27904
    ds_read_b64_tr_b16 v[92:93], v158 offset:26688
    ds_read_b64_tr_b16 v[94:95], v158 offset:27968
    ds_read_b64_tr_b16 v[96:97], v158 offset:26752
    ds_read_b64_tr_b16 v[98:99], v158 offset:28032
    ds_read_b64_tr_b16 v[100:101], v158 offset:26816
    ds_read_b64_tr_b16 v[102:103], v158 offset:28096
    ds_read_b64_tr_b16 v[104:105], v158 offset:26880
    ds_read_b64_tr_b16 v[106:107], v158 offset:28160
    ds_read_b128 v[84:87], v157 offset:26624
    ds_read_b64_tr_b16 v[108:109], v158 offset:31744
    ds_read_b64_tr_b16 v[110:111], v158 offset:33024
    ds_read_b64_tr_b16 v[112:113], v158 offset:31808
    ds_read_b64_tr_b16 v[114:115], v158 offset:33088
    ds_read_b64_tr_b16 v[116:117], v158 offset:31872
    ds_read_b64_tr_b16 v[118:119], v158 offset:33152
    ds_read_b64_tr_b16 v[120:121], v158 offset:31936
    ds_read_b64_tr_b16 v[122:123], v158 offset:33216
    ds_read_b64_tr_b16 v[124:125], v158 offset:32000
    ds_read_b64_tr_b16 v[126:127], v158 offset:33280
    s_waitcnt lgkmcnt(11)
    v_mfma_f32_32x32x16_bf16 v[0:15], v[88:91], v[80:83], v[0:15]
    v_mfma_f32_32x32x16_bf16 v[16:31], v[92:95], v[80:83], v[16:31]
    v_mfma_f32_32x32x16_bf16 v[32:47], v[96:99], v[80:83], v[32:47]
    v_mfma_f32_32x32x16_bf16 v[48:63], v[100:103], v[80:83], v[48:63]
    v_mfma_f32_32x32x16_bf16 v[64:79], v[104:107], v[80:83], v[64:79]
    s_waitcnt lgkmcnt(0)
    v_mfma_f32_32x32x16_bf16 v[0:15], v[108:111], v[84:87], v[0:15]
    v_mfma_f32_32x32x16_bf16 v[16:31], v[112:115], v[84:87], v[16:31]
    v_mfma_f32_32x32x16_bf16 v[32:47], v[116:119], v[84:87], v[32:47]
    v_mfma_f32_32x32x16_bf16 v[48:63], v[120:123], v[84:87], v[48:63]
    v_mfma_f32_32x32x16_bf16 v[64:79], v[124:127], v[84:87], v[64:79]
    v_add_u32 v156, 106496, v128
    v_add_u32 v158, 106496, v130
    v_add_u32 v157, 106496, v129
    v_add_u32 v159, 106496, v131
    s_waitcnt vmcnt(0)
    s_barrier
    ds_read_b128 v[80:83], v156 offset:0
    ds_read_b64_tr_b16 v[88:89], v158 offset:0
    ds_read_b64_tr_b16 v[90:91], v158 offset:1280
    ds_read_b64_tr_b16 v[92:93], v158 offset:64
    ds_read_b64_tr_b16 v[94:95], v158 offset:1344
    ds_read_b64_tr_b16 v[96:97], v158 offset:128
    ds_read_b64_tr_b16 v[98:99], v158 offset:1408
    ds_read_b64_tr_b16 v[100:101], v158 offset:192
    ds_read_b64_tr_b16 v[102:103], v158 offset:1472
    ds_read_b64_tr_b16 v[104:105], v158 offset:256
    ds_read_b64_tr_b16 v[106:107], v158 offset:1536
    ds_read_b128 v[84:87], v157 offset:0
    ds_read_b64_tr_b16 v[108:109], v158 offset:5120
    ds_read_b64_tr_b16 v[110:111], v158 offset:6400
    ds_read_b64_tr_b16 v[112:113], v158 offset:5184
    ds_read_b64_tr_b16 v[114:115], v158 offset:6464
    ds_read_b64_tr_b16 v[116:117], v158 offset:5248
    ds_read_b64_tr_b16 v[118:119], v158 offset:6528
    ds_read_b64_tr_b16 v[120:121], v158 offset:5312
    ds_read_b64_tr_b16 v[122:123], v158 offset:6592
    ds_read_b64_tr_b16 v[124:125], v158 offset:5376
    ds_read_b64_tr_b16 v[126:127], v158 offset:6656
    s_waitcnt lgkmcnt(11)
    v_mfma_f32_32x32x16_bf16 v[0:15], v[88:91], v[80:83], v[0:15]
    v_mfma_f32_32x32x16_bf16 v[16:31], v[92:95], v[80:83], v[16:31]
    v_mfma_f32_32x32x16_bf16 v[32:47], v[96:99], v[80:83], v[32:47]
    v_mfma_f32_32x32x16_bf16 v[48:63], v[100:103], v[80:83], v[48:63]
    v_mfma_f32_32x32x16_bf16 v[64:79], v[104:107], v[80:83], v[64:79]
    s_waitcnt lgkmcnt(0)
    v_mfma_f32_32x32x16_bf16 v[0:15], v[108:111], v[84:87], v[0:15]
    v_mfma_f32_32x32x16_bf16 v[16:31], v[112:115], v[84:87], v[16:31]
    v_mfma_f32_32x32x16_bf16 v[32:47], v[116:119], v[84:87], v[32:47]
    v_mfma_f32_32x32x16_bf16 v[48:63], v[120:123], v[84:87], v[48:63]
    v_mfma_f32_32x32x16_bf16 v[64:79], v[124:127], v[84:87], v[64:79]
    s_barrier
    s_nop 15
    s_cmp_ge_u32 s35, 4
    s_mov_b32 s38, 4194304
    s_cselect_b32 s38, 8388608, s38
    s_mov_b32 s39, 0x3ea52b5c
    s_cselect_b32 s39, 1.0, s39
    s_cselect_b32 s48, 3, 0
    s_cselect_b32 s49, 0x3f803f80, 0
    s_cselect_b32 s50, 0x3f80, 0
    v_and_b32 v142, 31, v140
    s_lshl_b32 s37, s30, 5
    v_add_u32 v142, s37, v142
    v_bfe_u32 v143, v142, 2, 2
    v_and_b32 v143, s48, v143
    v_lshlrev_b32 v142, 6, v142
    v_xor_b32 v144, 0, v143
    v_lshl_add_u32 v80, v144, 4, v142
    v_add_u32 v84, 0x10000, v80
    v_xor_b32 v144, 1, v143
    v_lshl_add_u32 v81, v144, 4, v142
    v_add_u32 v85, 0x10000, v81
    v_xor_b32 v144, 2, v143
    v_lshl_add_u32 v82, v144, 4, v142
    v_add_u32 v86, 0x10000, v82
    v_xor_b32 v144, 3, v143
    v_lshl_add_u32 v83, v144, 4, v142
    v_add_u32 v87, 0x10000, v83
    v_mov_b32 v148, s49
    v_mov_b32 v149, s50
    v_mov_b32 v152, 0
    v_mov_b32 v153, 0
    v_mov_b32 v154, 0
    v_mov_b32 v155, 0
    s_mov_b64 s[52:53], exec
    s_mov_b32 s54, -1
    s_mov_b32 s55, 0
    s_mov_b32 s56, 0
    s_mov_b32 s57, -1
    v_mul_f32 v0, s39, v0
    v_mul_f32 v1, s39, v1
    v_mul_f32 v2, s39, v2
    v_mul_f32 v3, s39, v3
    v_cvt_pk_bf16_f32 v146, v0, v1
    v_cvt_pk_bf16_f32 v147, v2, v3
    s_mov_b64 exec, s[54:55]
    ds_write_b64 v80, v[146:147] offset:0
    s_mov_b64 exec, s[56:57]
    ds_write_b64 v80, v[146:147] offset:8
    s_mov_b64 exec, s[52:53]
    v_mul_f32 v4, s39, v4
    v_mul_f32 v5, s39, v5
    v_mul_f32 v6, s39, v6
    v_mul_f32 v7, s39, v7
    v_cvt_pk_bf16_f32 v146, v4, v5
    v_cvt_pk_bf16_f32 v147, v6, v7
    s_mov_b64 exec, s[54:55]
    ds_write_b64 v81, v[146:147] offset:0
    s_mov_b64 exec, s[56:57]
    ds_write_b64 v81, v[146:147] offset:8
    s_mov_b64 exec, s[52:53]
    v_mul_f32 v8, s39, v8
    v_mul_f32 v9, s39, v9
    v_mul_f32 v10, s39, v10
    v_mul_f32 v11, s39, v11
    v_cvt_pk_bf16_f32 v146, v8, v9
    v_cvt_pk_bf16_f32 v147, v10, v11
    s_mov_b64 exec, s[54:55]
    ds_write_b128 v82, v[146:149] offset:0
    ds_write_b128 v83, v[152:155] offset:0
    s_mov_b64 exec, s[56:57]
    ds_write_b64 v80, v[146:147] offset:16384
    s_mov_b64 exec, s[52:53]
    v_mul_f32 v12, s39, v12
    v_mul_f32 v13, s39, v13
    v_mul_f32 v14, s39, v14
    v_mul_f32 v15, s39, v15
    v_cvt_pk_bf16_f32 v146, v12, v13
    v_cvt_pk_bf16_f32 v147, v14, v15
    s_mov_b64 exec, s[54:55]
    ds_write_b64 v80, v[146:147] offset:16392
    s_mov_b64 exec, s[56:57]
    ds_write_b64 v81, v[146:147] offset:16384
    s_mov_b64 exec, s[52:53]
    v_mul_f32 v16, s39, v16
    v_mul_f32 v17, s39, v17
    v_mul_f32 v18, s39, v18
    v_mul_f32 v19, s39, v19
    v_cvt_pk_bf16_f32 v146, v16, v17
    v_cvt_pk_bf16_f32 v147, v18, v19
    s_mov_b64 exec, s[54:55]
    ds_write_b64 v81, v[146:147] offset:16392
    s_mov_b64 exec, s[56:57]
    ds_write_b128 v82, v[146:149] offset:16384
    ds_write_b128 v83, v[152:155] offset:16384
    s_mov_b64 exec, s[52:53]
    v_mul_f32 v20, s39, v20
    v_mul_f32 v21, s39, v21
    v_mul_f32 v22, s39, v22
    v_mul_f32 v23, s39, v23
    v_cvt_pk_bf16_f32 v146, v20, v21
    v_cvt_pk_bf16_f32 v147, v22, v23
    s_mov_b64 exec, s[54:55]
    ds_write_b64 v80, v[146:147] offset:32768
    s_mov_b64 exec, s[56:57]
    ds_write_b64 v80, v[146:147] offset:32776
    s_mov_b64 exec, s[52:53]
    v_mul_f32 v24, s39, v24
    v_mul_f32 v25, s39, v25
    v_mul_f32 v26, s39, v26
    v_mul_f32 v27, s39, v27
    v_cvt_pk_bf16_f32 v146, v24, v25
    v_cvt_pk_bf16_f32 v147, v26, v27
    s_mov_b64 exec, s[54:55]
    ds_write_b64 v81, v[146:147] offset:32768
    s_mov_b64 exec, s[56:57]
    ds_write_b64 v81, v[146:147] offset:32776
    s_mov_b64 exec, s[52:53]
    v_mul_f32 v28, s39, v28
    v_mul_f32 v29, s39, v29
    v_mul_f32 v30, s39, v30
    v_mul_f32 v31, s39, v31
    v_cvt_pk_bf16_f32 v146, v28, v29
    v_cvt_pk_bf16_f32 v147, v30, v31
    s_mov_b64 exec, s[54:55]
    ds_write_b128 v82, v[146:149] offset:32768
    ds_write_b128 v83, v[152:155] offset:32768
    s_mov_b64 exec, s[56:57]
    ds_write_b64 v80, v[146:147] offset:49152
    s_mov_b64 exec, s[52:53]
    v_mul_f32 v32, s39, v32
    v_mul_f32 v33, s39, v33
    v_mul_f32 v34, s39, v34
    v_mul_f32 v35, s39, v35
    v_cvt_pk_bf16_f32 v146, v32, v33
    v_cvt_pk_bf16_f32 v147, v34, v35
    s_mov_b64 exec, s[54:55]
    ds_write_b64 v80, v[146:147] offset:49160
    s_mov_b64 exec, s[56:57]
    ds_write_b64 v81, v[146:147] offset:49152
    s_mov_b64 exec, s[52:53]
    v_mul_f32 v36, s39, v36
    v_mul_f32 v37, s39, v37
    v_mul_f32 v38, s39, v38
    v_mul_f32 v39, s39, v39
    v_cvt_pk_bf16_f32 v146, v36, v37
    v_cvt_pk_bf16_f32 v147, v38, v39
    s_mov_b64 exec, s[54:55]
    ds_write_b64 v81, v[146:147] offset:49160
    s_mov_b64 exec, s[56:57]
    ds_write_b128 v82, v[146:149] offset:49152
    ds_write_b128 v83, v[152:155] offset:49152
    s_mov_b64 exec, s[52:53]
    v_mul_f32 v40, s39, v40
    v_mul_f32 v41, s39, v41
    v_mul_f32 v42, s39, v42
    v_mul_f32 v43, s39, v43
    v_cvt_pk_bf16_f32 v146, v40, v41
    v_cvt_pk_bf16_f32 v147, v42, v43
    s_mov_b64 exec, s[54:55]
    ds_write_b64 v84, v[146:147] offset:0
    s_mov_b64 exec, s[56:57]
    ds_write_b64 v84, v[146:147] offset:8
    s_mov_b64 exec, s[52:53]
    v_mul_f32 v44, s39, v44
    v_mul_f32 v45, s39, v45
    v_mul_f32 v46, s39, v46
    v_mul_f32 v47, s39, v47
    v_cvt_pk_bf16_f32 v146, v44, v45
    v_cvt_pk_bf16_f32 v147, v46, v47
    s_mov_b64 exec, s[54:55]
    ds_write_b64 v85, v[146:147] offset:0
    s_mov_b64 exec, s[56:57]
    ds_write_b64 v85, v[146:147] offset:8
    s_mov_b64 exec, s[52:53]
    v_mul_f32 v48, s39, v48
    v_mul_f32 v49, s39, v49
    v_mul_f32 v50, s39, v50
    v_mul_f32 v51, s39, v51
    v_cvt_pk_bf16_f32 v146, v48, v49
    v_cvt_pk_bf16_f32 v147, v50, v51
    s_mov_b64 exec, s[54:55]
    ds_write_b128 v86, v[146:149] offset:0
    ds_write_b128 v87, v[152:155] offset:0
    s_mov_b64 exec, s[56:57]
    ds_write_b64 v84, v[146:147] offset:16384
    s_mov_b64 exec, s[52:53]
    v_mul_f32 v52, s39, v52
    v_mul_f32 v53, s39, v53
    v_mul_f32 v54, s39, v54
    v_mul_f32 v55, s39, v55
    v_cvt_pk_bf16_f32 v146, v52, v53
    v_cvt_pk_bf16_f32 v147, v54, v55
    s_mov_b64 exec, s[54:55]
    ds_write_b64 v84, v[146:147] offset:16392
    s_mov_b64 exec, s[56:57]
    ds_write_b64 v85, v[146:147] offset:16384
    s_mov_b64 exec, s[52:53]
    v_mul_f32 v56, s39, v56
    v_mul_f32 v57, s39, v57
    v_mul_f32 v58, s39, v58
    v_mul_f32 v59, s39, v59
    v_cvt_pk_bf16_f32 v146, v56, v57
    v_cvt_pk_bf16_f32 v147, v58, v59
    s_mov_b64 exec, s[54:55]
    ds_write_b64 v85, v[146:147] offset:16392
    s_mov_b64 exec, s[56:57]
    ds_write_b128 v86, v[146:149] offset:16384
    ds_write_b128 v87, v[152:155] offset:16384
    s_mov_b64 exec, s[52:53]
    v_mul_f32 v60, s39, v60
    v_mul_f32 v61, s39, v61
    v_mul_f32 v62, s39, v62
    v_mul_f32 v63, s39, v63
    v_cvt_pk_bf16_f32 v146, v60, v61
    v_cvt_pk_bf16_f32 v147, v62, v63
    s_mov_b64 exec, s[54:55]
    ds_write_b64 v84, v[146:147] offset:32768
    s_mov_b64 exec, s[56:57]
    ds_write_b64 v84, v[146:147] offset:32776
    s_mov_b64 exec, s[52:53]
    v_mul_f32 v64, s39, v64
    v_mul_f32 v65, s39, v65
    v_mul_f32 v66, s39, v66
    v_mul_f32 v67, s39, v67
    v_cvt_pk_bf16_f32 v146, v64, v65
    v_cvt_pk_bf16_f32 v147, v66, v67
    s_mov_b64 exec, s[54:55]
    ds_write_b64 v85, v[146:147] offset:32768
    s_mov_b64 exec, s[56:57]
    ds_write_b64 v85, v[146:147] offset:32776
    s_mov_b64 exec, s[52:53]
    v_mul_f32 v68, s39, v68
    v_mul_f32 v69, s39, v69
    v_mul_f32 v70, s39, v70
    v_mul_f32 v71, s39, v71
    v_cvt_pk_bf16_f32 v146, v68, v69
    v_cvt_pk_bf16_f32 v147, v70, v71
    s_mov_b64 exec, s[54:55]
    ds_write_b128 v86, v[146:149] offset:32768
    ds_write_b128 v87, v[152:155] offset:32768
    s_mov_b64 exec, s[56:57]
    ds_write_b64 v84, v[146:147] offset:49152
    s_mov_b64 exec, s[52:53]
    v_mul_f32 v72, s39, v72
    v_mul_f32 v73, s39, v73
    v_mul_f32 v74, s39, v74
    v_mul_f32 v75, s39, v75
    v_cvt_pk_bf16_f32 v146, v72, v73
    v_cvt_pk_bf16_f32 v147, v74, v75
    s_mov_b64 exec, s[54:55]
    ds_write_b64 v84, v[146:147] offset:49160
    s_mov_b64 exec, s[56:57]
    ds_write_b64 v85, v[146:147] offset:49152
    s_mov_b64 exec, s[52:53]
    v_mul_f32 v76, s39, v76
    v_mul_f32 v77, s39, v77
    v_mul_f32 v78, s39, v78
    v_mul_f32 v79, s39, v79
    v_cvt_pk_bf16_f32 v146, v76, v77
    v_cvt_pk_bf16_f32 v147, v78, v79
    s_mov_b64 exec, s[54:55]
    ds_write_b64 v85, v[146:147] offset:49160
    s_mov_b64 exec, s[56:57]
    ds_write_b128 v86, v[146:149] offset:49152
    ds_write_b128 v87, v[152:155] offset:49152
    s_mov_b64 exec, s[52:53]
    s_branch G1_copyout
G1_helper:
    s_waitcnt vmcnt(9)
    s_barrier
    s_add_u32 m0, s24, 106496
    s_nop 0
    global_load_lds_dwordx4 v[132:133], off
    v_lshl_add_u64 v[132:133], v[132:133], 0, s[40:41]
    s_add_u32 m0, s25, 106496
    s_nop 0
    global_load_lds_dwordx4 v[134:135], off
    v_lshl_add_u64 v[134:135], v[134:135], 0, s[42:43]
    s_add_u32 m0, s26, 106496
    s_nop 0
    global_load_lds_dwordx4 v[136:137], off
    v_lshl_add_u64 v[136:137], v[136:137], 0, s[44:45]
    s_waitcnt vmcnt(9)
    s_barrier
    s_add_u32 m0, s24, 0
    s_nop 0
    global_load_lds_dwordx4 v[132:133], off
    v_lshl_add_u64 v[132:133], v[132:133], 0, s[40:41]
    s_add_u32 m0, s25, 0
    s_nop 0
    global_load_lds_dwordx4 v[134:135], off
    v_lshl_add_u64 v[134:135], v[134:135], 0, s[42:43]
    s_add_u32 m0, s26, 0
    s_nop 0
    global_load_lds_dwordx4 v[136:137], off
    v_lshl_add_u64 v[136:137], v[136:137], 0, s[44:45]
    s_waitcnt vmcnt(9)
    s_barrier
    s_add_u32 m0, s24, 26624
    s_nop 0
    global_load_lds_dwordx4 v[132:133], off
    v_lshl_add_u64 v[132:133], v[132:133], 0, s[40:41]
    s_add_u32 m0, s25, 26624
    s_nop 0
    global_load_lds_dwordx4 v[134:135], off
    v_lshl_add_u64 v[134:135], v[134:135], 0, s[42:43]
    s_add_u32 m0, s26, 26624
    s_nop 0
    global_load_lds_dwordx4 v[136:137], off
    v_lshl_add_u64 v[136:137], v[136:137], 0, s[44:45]
    s_waitcnt vmcnt(9)
    s_barrier
    s_add_u32 m0, s24, 53248
    s_nop 0
    global_load_lds_dwordx4 v[132:133], off
    v_lshl_add_u64 v[132:133], v[132:133], 0, s[40:41]
    s_add_u32 m0, s25, 53248
    s_nop 0
    global_load_lds_dwordx4 v[134:135], off
    v_lshl_add_u64 v[134:135], v[134:135], 0, s[42:43]
    s_add_u32 m0, s26, 53248
    s_nop 0
    global_load_lds_dwordx4 v[136:137], off
    v_lshl_add_u64 v[136:137], v[136:137], 0, s[44:45]
    s_waitcnt vmcnt(9)
    s_barrier
    s_add_u32 m0, s24, 79872
    s_nop 0
    global_load_lds_dwordx4 v[132:133], off
    v_lshl_add_u64 v[132:133], v[132:133], 0, s[40:41]
    s_add_u32 m0, s25, 79872
    s_nop 0
    global_load_lds_dwordx4 v[134:135], off
    v_lshl_add_u64 v[134:135], v[134:135], 0, s[42:43]
    s_add_u32 m0, s26, 79872
    s_nop 0
    global_load_lds_dwordx4 v[136:137], off
    v_lshl_add_u64 v[136:137], v[136:137], 0, s[44:45]
    s_waitcnt vmcnt(9)
    s_barrier
    s_add_u32 m0, s24, 106496
    s_nop 0
    global_load_lds_dwordx4 v[132:133], off
    v_lshl_add_u64 v[132:133], v[132:133], 0, s[40:41]
    s_add_u32 m0, s25, 106496
    s_nop 0
    global_load_lds_dwordx4 v[134:135], off
    v_lshl_add_u64 v[134:135], v[134:135], 0, s[42:43]
    s_add_u32 m0, s26, 106496
    s_nop 0
    global_load_lds_dwordx4 v[136:137], off
    v_lshl_add_u64 v[136:137], v[136:137], 0, s[44:45]
    s_waitcnt vmcnt(9)
    s_barrier
    s_add_u32 m0, s24, 0
    s_nop 0
    global_load_lds_dwordx4 v[132:133], off
    v_lshl_add_u64 v[132:133], v[132:133], 0, s[40:41]
    s_add_u32 m0, s25, 0
    s_nop 0
    global_load_lds_dwordx4 v[134:135], off
    v_lshl_add_u64 v[134:135], v[134:135], 0, s[42:43]
    s_add_u32 m0, s26, 0
    s_nop 0
    global_load_lds_dwordx4 v[136:137], off
    v_lshl_add_u64 v[136:137], v[136:137], 0, s[44:45]
    s_waitcnt vmcnt(9)
    s_barrier
    s_add_u32 m0, s24, 26624
    s_nop 0
    global_load_lds_dwordx4 v[132:133], off
    v_lshl_add_u64 v[132:133], v[132:133], 0, s[40:41]
    s_add_u32 m0, s25, 26624
    s_nop 0
    global_load_lds_dwordx4 v[134:135], off
    v_lshl_add_u64 v[134:135], v[134:135], 0, s[42:43]
    s_add_u32 m0, s26, 26624
    s_nop 0
    global_load_lds_dwordx4 v[136:137], off
    v_lshl_add_u64 v[136:137], v[136:137], 0, s[44:45]
    s_waitcnt vmcnt(9)
    s_barrier
    s_add_u32 m0, s24, 53248
    s_nop 0
    global_load_lds_dwordx4 v[132:133], off
    v_lshl_add_u64 v[132:133], v[132:133], 0, s[40:41]
    s_add_u32 m0, s25, 53248
    s_nop 0
    global_load_lds_dwordx4 v[134:135], off
    v_lshl_add_u64 v[134:135], v[134:135], 0, s[42:43]
    s_add_u32 m0, s26, 53248
    s_nop 0
    global_load_lds_dwordx4 v[136:137], off
    v_lshl_add_u64 v[136:137], v[136:137], 0, s[44:45]
    s_waitcnt vmcnt(9)
    s_barrier
    s_add_u32 m0, s24, 79872
    s_nop 0
    global_load_lds_dwordx4 v[132:133], off
    v_lshl_add_u64 v[132:133], v[132:133], 0, s[40:41]
    s_add_u32 m0, s25, 79872
    s_nop 0
    global_load_lds_dwordx4 v[134:135], off
    v_lshl_add_u64 v[134:135], v[134:135], 0, s[42:43]
    s_add_u32 m0, s26, 79872
    s_nop 0
    global_load_lds_dwordx4 v[136:137], off
    v_lshl_add_u64 v[136:137], v[136:137], 0, s[44:45]
    s_waitcnt vmcnt(9)
    s_barrier
    s_add_u32 m0, s24, 106496
    s_nop 0
    global_load_lds_dwordx4 v[132:133], off
    v_lshl_add_u64 v[132:133], v[132:133], 0, s[40:41]
    s_add_u32 m0, s25, 106496
    s_nop 0
    global_load_lds_dwordx4 v[134:135], off
    v_lshl_add_u64 v[134:135], v[134:135], 0, s[42:43]
    s_add_u32 m0, s26, 106496
    s_nop 0
    global_load_lds_dwordx4 v[136:137], off
    v_lshl_add_u64 v[136:137], v[136:137], 0, s[44:45]
    s_waitcnt vmcnt(9)
    s_barrier
    s_add_u32 m0, s24, 0
    s_nop 0
    global_load_lds_dwordx4 v[132:133], off
    v_lshl_add_u64 v[132:133], v[132:133], 0, s[40:41]
    s_add_u32 m0, s25, 0
    s_nop 0
    global_load_lds_dwordx4 v[134:135], off
    v_lshl_add_u64 v[134:135], v[134:135], 0, s[42:43]
    s_add_u32 m0, s26, 0
    s_nop 0
    global_load_lds_dwordx4 v[136:137], off
    v_lshl_add_u64 v[136:137], v[136:137], 0, s[44:45]
    s_waitcnt vmcnt(9)
    s_barrier
    s_add_u32 m0, s24, 26624
    s_nop 0
    global_load_lds_dwordx4 v[132:133], off
    v_lshl_add_u64 v[132:133], v[132:133], 0, s[40:41]
    s_add_u32 m0, s25, 26624
    s_nop 0
    global_load_lds_dwordx4 v[134:135], off
    v_lshl_add_u64 v[134:135], v[134:135], 0, s[42:43]
    s_add_u32 m0, s26, 26624
    s_nop 0
    global_load_lds_dwordx4 v[136:137], off
    v_lshl_add_u64 v[136:137], v[136:137], 0, s[44:45]
    s_waitcnt vmcnt(9)
    s_barrier
    s_add_u32 m0, s24, 53248
    s_nop 0
    global_load_lds_dwordx4 v[132:133], off
    v_lshl_add_u64 v[132:133], v[132:133], 0, s[40:41]
    s_add_u32 m0, s25, 53248
    s_nop 0
    global_load_lds_dwordx4 v[134:135], off
    v_lshl_add_u64 v[134:135], v[134:135], 0, s[42:43]
    s_add_u32 m0, s26, 53248
    s_nop 0
    global_load_lds_dwordx4 v[136:137], off
    v_lshl_add_u64 v[136:137], v[136:137], 0, s[44:45]
    s_waitcnt vmcnt(9)
    s_barrier
    s_add_u32 m0, s24, 79872
    s_nop 0
    global_load_lds_dwordx4 v[132:133], off
    v_lshl_add_u64 v[132:133], v[132:133], 0, s[40:41]
    s_add_u32 m0, s25, 79872
    s_nop 0
    global_load_lds_dwordx4 v[134:135], off
    v_lshl_add_u64 v[134:135], v[134:135], 0, s[42:43]
    s_add_u32 m0, s26, 79872
    s_nop 0
    global_load_lds_dwordx4 v[136:137], off
    v_lshl_add_u64 v[136:137], v[136:137], 0, s[44:45]
    s_waitcnt vmcnt(9)
    s_barrier
    s_add_u32 m0, s24, 106496
    s_nop 0
    global_load_lds_dwordx4 v[132:133], off
    v_lshl_add_u64 v[132:133], v[132:133], 0, s[40:41]
    s_add_u32 m0, s25, 106496
    s_nop 0
    global_load_lds_dwordx4 v[134:135], off
    v_lshl_add_u64 v[134:135], v[134:135], 0, s[42:43]
    s_add_u32 m0, s26, 106496
    s_nop 0
    global_load_lds_dwordx4 v[136:137], off
    v_lshl_add_u64 v[136:137], v[136:137], 0, s[44:45]
    s_waitcnt vmcnt(9)
    s_barrier
    s_waitcnt vmcnt(6)
    s_barrier
    s_waitcnt vmcnt(3)
    s_barrier
    s_waitcnt vmcnt(0)
    s_barrier
    s_barrier
    s_nop 15
    s_barrier
    s_branch G1_done
G1_v:
    s_waitcnt vmcnt(9)
    s_barrier
    ds_read_b128 v[80:83], v128 offset:0
    ds_read_b64_tr_b16 v[88:89], v130 offset:0
    ds_read_b64_tr_b16 v[90:91], v130 offset:1280
    ds_read_b64_tr_b16 v[92:93], v130 offset:64
    ds_read_b64_tr_b16 v[94:95], v130 offset:1344
    ds_read_b64_tr_b16 v[96:97], v130 offset:128
    ds_read_b64_tr_b16 v[98:99], v130 offset:1408
    ds_read_b64_tr_b16 v[100:101], v130 offset:192
    ds_read_b64_tr_b16 v[102:103], v130 offset:1472
    ds_read_b64_tr_b16 v[104:105], v130 offset:256
    ds_read_b64_tr_b16 v[106:107], v130 offset:1536
    ds_read_b128 v[84:87], v129 offset:0
    ds_read_b64_tr_b16 v[108:109], v130 offset:5120
    ds_read_b64_tr_b16 v[110:111], v130 offset:6400
    ds_read_b64_tr_b16 v[112:113], v130 offset:5184
    ds_read_b64_tr_b16 v[114:115], v130 offset:6464
    ds_read_b64_tr_b16 v[116:117], v130 offset:5248
    ds_read_b64_tr_b16 v[118:119], v130 offset:6528
    ds_read_b64_tr_b16 v[120:121], v130 offset:5312
    ds_read_b64_tr_b16 v[122:123], v130 offset:6592
    ds_read_b64_tr_b16 v[124:125], v130 offset:5376
    ds_read_b64_tr_b16 v[126:127], v130 offset:6656
    s_add_u32 m0, s24, 106496
    s_nop 0
    global_load_lds_dwordx4 v[132:133], off
    v_lshl_add_u64 v[132:133], v[132:133], 0, s[40:41]
    s_add_u32 m0, s25, 106496
    s_nop 0
    global_load_lds_dwordx4 v[134:135], off
    v_lshl_add_u64 v[134:135], v[134:135], 0, s[42:43]
    s_add_u32 m0, s26, 106496
    s_nop 0
    global_load_lds_dwordx4 v[136:137], off
    v_lshl_add_u64 v[136:137], v[136:137], 0, s[44:45]
    s_waitcnt lgkmcnt(11)
    v_mfma_f32_32x32x16_bf16 v[0:15], v[80:83], v[88:91], v[0:15]
    v_mfma_f32_32x32x16_bf16 v[16:31], v[80:83], v[92:95], v[16:31]
    v_mfma_f32_32x32x16_bf16 v[32:47], v[80:83], v[96:99], v[32:47]
    v_mfma_f32_32x32x16_bf16 v[48:63], v[80:83], v[100:103], v[48:63]
    v_mfma_f32_32x32x16_bf16 v[64:79], v[80:83], v[104:107], v[64:79]
    s_waitcnt lgkmcnt(0)
    v_mfma_f32_32x32x16_bf16 v[0:15], v[84:87], v[108:111], v[0:15]
    v_mfma_f32_32x32x16_bf16 v[16:31], v[84:87], v[112:115], v[16:31]
    v_mfma_f32_32x32x16_bf16 v[32:47], v[84:87], v[116:119], v[32:47]
    v_mfma_f32_32x32x16_bf16 v[48:63], v[84:87], v[120:123], v[48:63]
    v_mfma_f32_32x32x16_bf16 v[64:79], v[84:87], v[124:127], v[64:79]
    s_waitcnt vmcnt(9)
    s_barrier
    ds_read_b128 v[80:83], v128 offset:26624
    ds_read_b64_tr_b16 v[88:89], v130 offset:26624
    ds_read_b64_tr_b16 v[90:91], v130 offset:27904
    ds_read_b64_tr_b16 v[92:93], v130 offset:26688
    ds_read_b64_tr_b16 v[94:95], v130 offset:27968
    ds_read_b64_tr_b16 v[96:97], v130 offset:26752
    ds_read_b64_tr_b16 v[98:99], v130 offset:28032
    ds_read_b64_tr_b16 v[100:101], v130 offset:26816
    ds_read_b64_tr_b16 v[102:103], v130 offset:28096
    ds_read_b64_tr_b16 v[104:105], v130 offset:26880
    ds_read_b64_tr_b16 v[106:107], v130 offset:28160
    ds_read_b128 v[84:87], v129 offset:26624
    ds_read_b64_tr_b16 v[108:109], v130 offset:31744
    ds_read_b64_tr_b16 v[110:111], v130 offset:33024
    ds_read_b64_tr_b16 v[112:113], v130 offset:31808
    ds_read_b64_tr_b16 v[114:115], v130 offset:33088
    ds_read_b64_tr_b16 v[116:117], v130 offset:31872
    ds_read_b64_tr_b16 v[118:119], v130 offset:33152
    ds_read_b64_tr_b16 v[120:121], v130 offset:31936
    ds_read_b64_tr_b16 v[122:123], v130 offset:33216
    ds_read_b64_tr_b16 v[124:125], v130 offset:32000
    ds_read_b64_tr_b16 v[126:127], v130 offset:33280
    s_add_u32 m0, s24, 0
    s_nop 0
    global_load_lds_dwordx4 v[132:133], off
    v_lshl_add_u64 v[132:133], v[132:133], 0, s[40:41]
    s_add_u32 m0, s25, 0
    s_nop 0
    global_load_lds_dwordx4 v[134:135], off
    v_lshl_add_u64 v[134:135], v[134:135], 0, s[42:43]
    s_add_u32 m0, s26, 0
    s_nop 0
    global_load_lds_dwordx4 v[136:137], off
    v_lshl_add_u64 v[136:137], v[136:137], 0, s[44:45]
    s_waitcnt lgkmcnt(11)
    v_mfma_f32_32x32x16_bf16 v[0:15], v[80:83], v[88:91], v[0:15]
    v_mfma_f32_32x32x16_bf16 v[16:31], v[80:83], v[92:95], v[16:31]
    v_mfma_f32_32x32x16_bf16 v[32:47], v[80:83], v[96:99], v[32:47]
    v_mfma_f32_32x32x16_bf16 v[48:63], v[80:83], v[100:103], v[48:63]
    v_mfma_f32_32x32x16_bf16 v[64:79], v[80:83], v[104:107], v[64:79]
    s_waitcnt lgkmcnt(0)
    v_mfma_f32_32x32x16_bf16 v[0:15], v[84:87], v[108:111], v[0:15]
    v_mfma_f32_32x32x16_bf16 v[16:31], v[84:87], v[112:115], v[16:31]
    v_mfma_f32_32x32x16_bf16 v[32:47], v[84:87], v[116:119], v[32:47]
    v_mfma_f32_32x32x16_bf16 v[48:63], v[84:87], v[120:123], v[48:63]
    v_mfma_f32_32x32x16_bf16 v[64:79], v[84:87], v[124:127], v[64:79]
    v_add_u32 v156, 53248, v128
    v_add_u32 v158, 53248, v130
    v_add_u32 v157, 53248, v129
    v_add_u32 v159, 53248, v131
    s_waitcnt vmcnt(9)
    s_barrier
    ds_read_b128 v[80:83], v156 offset:0
    ds_read_b64_tr_b16 v[88:89], v158 offset:0
    ds_read_b64_tr_b16 v[90:91], v158 offset:1280
    ds_read_b64_tr_b16 v[92:93], v158 offset:64
    ds_read_b64_tr_b16 v[94:95], v158 offset:1344
    ds_read_b64_tr_b16 v[96:97], v158 offset:128
    ds_read_b64_tr_b16 v[98:99], v158 offset:1408
    ds_read_b64_tr_b16 v[100:101], v158 offset:192
    ds_read_b64_tr_b16 v[102:103], v158 offset:1472
    ds_read_b64_tr_b16 v[104:105], v158 offset:256
    ds_read_b64_tr_b16 v[106:107], v158 offset:1536
    ds_read_b128 v[84:87], v157 offset:0
    ds_read_b64_tr_b16 v[108:109], v158 offset:5120
    ds_read_b64_tr_b16 v[110:111], v158 offset:6400
    ds_read_b64_tr_b16 v[112:113], v158 offset:5184
    ds_read_b64_tr_b16 v[114:115], v158 offset:6464
    ds_read_b64_tr_b16 v[116:117], v158 offset:5248
    ds_read_b64_tr_b16 v[118:119], v158 offset:6528
    ds_read_b64_tr_b16 v[120:121], v158 offset:5312
    ds_read_b64_tr_b16 v[122:123], v158 offset:6592
    ds_read_b64_tr_b16 v[124:125], v158 offset:5376
    ds_read_b64_tr_b16 v[126:127], v158 offset:6656
    s_add_u32 m0, s24, 26624
    s_nop 0
    global_load_lds_dwordx4 v[132:133], off
    v_lshl_add_u64 v[132:133], v[132:133], 0, s[40:41]
    s_add_u32 m0, s25, 26624
    s_nop 0
    global_load_lds_dwordx4 v[134:135], off
    v_lshl_add_u64 v[134:135], v[134:135], 0, s[42:43]
    s_add_u32 m0, s26, 26624
    s_nop 0
    global_load_lds_dwordx4 v[136:137], off
    v_lshl_add_u64 v[136:137], v[136:137], 0, s[44:45]
    s_waitcnt lgkmcnt(11)
    v_mfma_f32_32x32x16_bf16 v[0:15], v[80:83], v[88:91], v[0:15]
    v_mfma_f32_32x32x16_bf16 v[16:31], v[80:83], v[92:95], v[16:31]
    v_mfma_f32_32x32x16_bf16 v[32:47], v[80:83], v[96:99], v[32:47]
    v_mfma_f32_32x32x16_bf16 v[48:63], v[80:83], v[100:103], v[48:63]
    v_mfma_f32_32x32x16_bf16 v[64:79], v[80:83], v[104:107], v[64:79]
    s_waitcnt lgkmcnt(0)
    v_mfma_f32_32x32x16_bf16 v[0:15], v[84:87], v[108:111], v[0:15]
    v_mfma_f32_32x32x16_bf16 v[16:31], v[84:87], v[112:115], v[16:31]
    v_mfma_f32_32x32x16_bf16 v[32:47], v[84:87], v[116:119], v[32:47]
    v_mfma_f32_32x32x16_bf16 v[48:63], v[84:87], v[120:123], v[48:63]
    v_mfma_f32_32x32x16_bf16 v[64:79], v[84:87], v[124:127], v[64:79]
    v_add_u32 v156, 53248, v128
    v_add_u32 v158, 53248, v130
    v_add_u32 v157, 53248, v129
    v_add_u32 v159, 53248, v131
    s_waitcnt vmcnt(9)
    s_barrier
    ds_read_b128 v[80:83], v156 offset:26624
    ds_read_b64_tr_b16 v[88:89], v158 offset:26624
    ds_read_b64_tr_b16 v[90:91], v158 offset:27904
    ds_read_b64_tr_b16 v[92:93], v158 offset:26688
    ds_read_b64_tr_b16 v[94:95], v158 offset:27968
    ds_read_b64_tr_b16 v[96:97], v158 offset:26752
    ds_read_b64_tr_b16 v[98:99], v158 offset:28032
    ds_read_b64_tr_b16 v[100:101], v158 offset:26816
    ds_read_b64_tr_b16 v[102:103], v158 offset:28096
    ds_read_b64_tr_b16 v[104:105], v158 offset:26880
    ds_read_b64_tr_b16 v[106:107], v158 offset:28160
    ds_read_b128 v[84:87], v157 offset:26624
    ds_read_b64_tr_b16 v[108:109], v158 offset:31744
    ds_read_b64_tr_b16 v[110:111], v158 offset:33024
    ds_read_b64_tr_b16 v[112:113], v158 offset:31808
    ds_read_b64_tr_b16 v[114:115], v158 offset:33088
    ds_read_b64_tr_b16 v[116:117], v158 offset:31872
    ds_read_b64_tr_b16 v[118:119], v158 offset:33152
    ds_read_b64_tr_b16 v[120:121], v158 offset:31936
    ds_read_b64_tr_b16 v[122:123], v158 offset:33216
    ds_read_b64_tr_b16 v[124:125], v158 offset:32000
    ds_read_b64_tr_b16 v[126:127], v158 offset:33280
    s_add_u32 m0, s24, 53248
    s_nop 0
    global_load_lds_dwordx4 v[132:133], off
    v_lshl_add_u64 v[132:133], v[132:133], 0, s[40:41]
    s_add_u32 m0, s25, 53248
    s_nop 0
    global_load_lds_dwordx4 v[134:135], off
    v_lshl_add_u64 v[134:135], v[134:135], 0, s[42:43]
    s_add_u32 m0, s26, 53248
    s_nop 0
    global_load_lds_dwordx4 v[136:137], off
    v_lshl_add_u64 v[136:137], v[136:137], 0, s[44:45]
    s_waitcnt lgkmcnt(11)
    v_mfma_f32_32x32x16_bf16 v[0:15], v[80:83], v[88:91], v[0:15]
    v_mfma_f32_32x32x16_bf16 v[16:31], v[80:83], v[92:95], v[16:31]
    v_mfma_f32_32x32x16_bf16 v[32:47], v[80:83], v[96:99], v[32:47]
    v_mfma_f32_32x32x16_bf16 v[48:63], v[80:83], v[100:103], v[48:63]
    v_mfma_f32_32x32x16_bf16 v[64:79], v[80:83], v[104:107], v[64:79]
    s_waitcnt lgkmcnt(0)
    v_mfma_f32_32x32x16_bf16 v[0:15], v[84:87], v[108:111], v[0:15]
    v_mfma_f32_32x32x16_bf16 v[16:31], v[84:87], v[112:115], v[16:31]
    v_mfma_f32_32x32x16_bf16 v[32:47], v[84:87], v[116:119], v[32:47]
    v_mfma_f32_32x32x16_bf16 v[48:63], v[84:87], v[120:123], v[48:63]
    v_mfma_f32_32x32x16_bf16 v[64:79], v[84:87], v[124:127], v[64:79]
    v_add_u32 v156, 106496, v128
    v_add_u32 v158, 106496, v130
    v_add_u32 v157, 106496, v129
    v_add_u32 v159, 106496, v131
    s_waitcnt vmcnt(9)
    s_barrier
    ds_read_b128 v[80:83], v156 offset:0
    ds_read_b64_tr_b16 v[88:89], v158 offset:0
    ds_read_b64_tr_b16 v[90:91], v158 offset:1280
    ds_read_b64_tr_b16 v[92:93], v158 offset:64
    ds_read_b64_tr_b16 v[94:95], v158 offset:1344
    ds_read_b64_tr_b16 v[96:97], v158 offset:128
    ds_read_b64_tr_b16 v[98:99], v158 offset:1408
    ds_read_b64_tr_b16 v[100:101], v158 offset:192
    ds_read_b64_tr_b16 v[102:103], v158 offset:1472
    ds_read_b64_tr_b16 v[104:105], v158 offset:256
    ds_read_b64_tr_b16 v[106:107], v158 offset:1536
    ds_read_b128 v[84:87], v157 offset:0
    ds_read_b64_tr_b16 v[108:109], v158 offset:5120
    ds_read_b64_tr_b16 v[110:111], v158 offset:6400
    ds_read_b64_tr_b16 v[112:113], v158 offset:5184
    ds_read_b64_tr_b16 v[114:115], v158 offset:6464
    ds_read_b64_tr_b16 v[116:117], v158 offset:5248
    ds_read_b64_tr_b16 v[118:119], v158 offset:6528
    ds_read_b64_tr_b16 v[120:121], v158 offset:5312
    ds_read_b64_tr_b16 v[122:123], v158 offset:6592
    ds_read_b64_tr_b16 v[124:125], v158 offset:5376
    ds_read_b64_tr_b16 v[126:127], v158 offset:6656
    s_add_u32 m0, s24, 79872
    s_nop 0
    global_load_lds_dwordx4 v[132:133], off
    v_lshl_add_u64 v[132:133], v[132:133], 0, s[40:41]
    s_add_u32 m0, s25, 79872
    s_nop 0
    global_load_lds_dwordx4 v[134:135], off
    v_lshl_add_u64 v[134:135], v[134:135], 0, s[42:43]
    s_add_u32 m0, s26, 79872
    s_nop 0
    global_load_lds_dwordx4 v[136:137], off
    v_lshl_add_u64 v[136:137], v[136:137], 0, s[44:45]
    s_waitcnt lgkmcnt(11)
    v_mfma_f32_32x32x16_bf16 v[0:15], v[80:83], v[88:91], v[0:15]
    v_mfma_f32_32x32x16_bf16 v[16:31], v[80:83], v[92:95], v[16:31]
    v_mfma_f32_32x32x16_bf16 v[32:47], v[80:83], v[96:99], v[32:47]
    v_mfma_f32_32x32x16_bf16 v[48:63], v[80:83], v[100:103], v[48:63]
    v_mfma_f32_32x32x16_bf16 v[64:79], v[80:83], v[104:107], v[64:79]
    s_waitcnt lgkmcnt(0)
    v_mfma_f32_32x32x16_bf16 v[0:15], v[84:87], v[108:111], v[0:15]
    v_mfma_f32_32x32x16_bf16 v[16:31], v[84:87], v[112:115], v[16:31]
    v_mfma_f32_32x32x16_bf16 v[32:47], v[84:87], v[116:119], v[32:47]
    v_mfma_f32_32x32x16_bf16 v[48:63], v[84:87], v[120:123], v[48:63]
    v_mfma_f32_32x32x16_bf16 v[64:79], v[84:87], v[124:127], v[64:79]
    s_waitcnt vmcnt(9)
    s_barrier
    ds_read_b128 v[80:83], v128 offset:0
    ds_read_b64_tr_b16 v[88:89], v130 offset:0
    ds_read_b64_tr_b16 v[90:91], v130 offset:1280
    ds_read_b64_tr_b16 v[92:93], v130 offset:64
    ds_read_b64_tr_b16 v[94:95], v130 offset:1344
    ds_read_b64_tr_b16 v[96:97], v130 offset:128
    ds_read_b64_tr_b16 v[98:99], v130 offset:1408
    ds_read_b64_tr_b16 v[100:101], v130 offset:192
    ds_read_b64_tr_b16 v[102:103], v130 offset:1472
    ds_read_b64_tr_b16 v[104:105], v130 offset:256
    ds_read_b64_tr_b16 v[106:107], v130 offset:1536
    ds_read_b128 v[84:87], v129 offset:0
    ds_read_b64_tr_b16 v[108:109], v130 offset:5120
    ds_read_b64_tr_b16 v[110:111], v130 offset:6400
    ds_read_b64_tr_b16 v[112:113], v130 offset:5184
    ds_read_b64_tr_b16 v[114:115], v130 offset:6464
    ds_read_b64_tr_b16 v[116:117], v130 offset:5248
    ds_read_b64_tr_b16 v[118:119], v130 offset:6528
    ds_read_b64_tr_b16 v[120:121], v130 offset:5312
    ds_read_b64_tr_b16 v[122:123], v130 offset:6592
    ds_read_b64_tr_b16 v[124:125], v130 offset:5376
    ds_read_b64_tr_b16 v[126:127], v130 offset:6656
    s_add_u32 m0, s24, 106496
    s_nop 0
    global_load_lds_dwordx4 v[132:133], off
    v_lshl_add_u64 v[132:133], v[132:133], 0, s[40:41]
    s_add_u32 m0, s25, 106496
    s_nop 0
    global_load_lds_dwordx4 v[134:135], off
    v_lshl_add_u64 v[134:135], v[134:135], 0, s[42:43]
    s_add_u32 m0, s26, 106496
    s_nop 0
    global_load_lds_dwordx4 v[136:137], off
    v_lshl_add_u64 v[136:137], v[136:137], 0, s[44:45]
    s_waitcnt lgkmcnt(11)
    v_mfma_f32_32x32x16_bf16 v[0:15], v[80:83], v[88:91], v[0:15]
    v_mfma_f32_32x32x16_bf16 v[16:31], v[80:83], v[92:95], v[16:31]
    v_mfma_f32_32x32x16_bf16 v[32:47], v[80:83], v[96:99], v[32:47]
    v_mfma_f32_32x32x16_bf16 v[48:63], v[80:83], v[100:103], v[48:63]
    v_mfma_f32_32x32x16_bf16 v[64:79], v[80:83], v[104:107], v[64:79]
    s_waitcnt lgkmcnt(0)
    v_mfma_f32_32x32x16_bf16 v[0:15], v[84:87], v[108:111], v[0:15]
    v_mfma_f32_32x32x16_bf16 v[16:31], v[84:87], v[112:115], v[16:31]
    v_mfma_f32_32x32x16_bf16 v[32:47], v[84:87], v[116:119], v[32:47]
    v_mfma_f32_32x32x16_bf16 v[48:63], v[84:87], v[120:123], v[48:63]
    v_mfma_f32_32x32x16_bf16 v[64:79], v[84:87], v[124:127], v[64:79]
    s_waitcnt vmcnt(9)
    s_barrier
    ds_read_b128 v[80:83], v128 offset:26624
    ds_read_b64_tr_b16 v[88:89], v130 offset:26624
    ds_read_b64_tr_b16 v[90:91], v130 offset:27904
    ds_read_b64_tr_b16 v[92:93], v130 offset:26688
    ds_read_b64_tr_b16 v[94:95], v130 offset:27968
    ds_read_b64_tr_b16 v[96:97], v130 offset:26752
    ds_read_b64_tr_b16 v[98:99], v130 offset:28032
    ds_read_b64_tr_b16 v[100:101], v130 offset:26816
    ds_read_b64_tr_b16 v[102:103], v130 offset:28096
    ds_read_b64_tr_b16 v[104:105], v130 offset:26880
    ds_read_b64_tr_b16 v[106:107], v130 offset:28160
    ds_read_b128 v[84:87], v129 offset:26624
    ds_read_b64_tr_b16 v[108:109], v130 offset:31744
    ds_read_b64_tr_b16 v[110:111], v130 offset:33024
    ds_read_b64_tr_b16 v[112:113], v130 offset:31808
    ds_read_b64_tr_b16 v[114:115], v130 offset:33088
    ds_read_b64_tr_b16 v[116:117], v130 offset:31872
    ds_read_b64_tr_b16 v[118:119], v130 offset:33152
    ds_read_b64_tr_b16 v[120:121], v130 offset:31936
    ds_read_b64_tr_b16 v[122:123], v130 offset:33216
    ds_read_b64_tr_b16 v[124:125], v130 offset:32000
    ds_read_b64_tr_b16 v[126:127], v130 offset:33280
    s_add_u32 m0, s24, 0
    s_nop 0
    global_load_lds_dwordx4 v[132:133], off
    v_lshl_add_u64 v[132:133], v[132:133], 0, s[40:41]
    s_add_u32 m0, s25, 0
    s_nop 0
    global_load_lds_dwordx4 v[134:135], off
    v_lshl_add_u64 v[134:135], v[134:135], 0, s[42:43]
    s_add_u32 m0, s26, 0
    s_nop 0
    global_load_lds_dwordx4 v[136:137], off
    v_lshl_add_u64 v[136:137], v[136:137], 0, s[44:45]
    s_waitcnt lgkmcnt(11)
    v_mfma_f32_32x32x16_bf16 v[0:15], v[80:83], v[88:91], v[0:15]
    v_mfma_f32_32x32x16_bf16 v[16:31], v[80:83], v[92:95], v[16:31]
    v_mfma_f32_32x32x16_bf16 v[32:47], v[80:83], v[96:99], v[32:47]
    v_mfma_f32_32x32x16_bf16 v[48:63], v[80:83], v[100:103], v[48:63]
    v_mfma_f32_32x32x16_bf16 v[64:79], v[80:83], v[104:107], v[64:79]
    s_waitcnt lgkmcnt(0)
    v_mfma_f32_32x32x16_bf16 v[0:15], v[84:87], v[108:111], v[0:15]
    v_mfma_f32_32x32x16_bf16 v[16:31], v[84:87], v[112:115], v[16:31]
    v_mfma_f32_32x32x16_bf16 v[32:47], v[84:87], v[116:119], v[32:47]
    v_mfma_f32_32x32x16_bf16 v[48:63], v[84:87], v[120:123], v[48:63]
    v_mfma_f32_32x32x16_bf16 v[64:79], v[84:87], v[124:127], v[64:79]
    v_add_u32 v156, 53248, v128
    v_add_u32 v158, 53248, v130
    v_add_u32 v157, 53248, v129
    v_add_u32 v159, 53248, v131
    s_waitcnt vmcnt(9)
    s_barrier
    ds_read_b128 v[80:83], v156 offset:0
    ds_read_b64_tr_b16 v[88:89], v158 offset:0
    ds_read_b64_tr_b16 v[90:91], v158 offset:1280
    ds_read_b64_tr_b16 v[92:93], v158 offset:64
    ds_read_b64_tr_b16 v[94:95], v158 offset:1344
    ds_read_b64_tr_b16 v[96:97], v158 offset:128
    ds_read_b64_tr_b16 v[98:99], v158 offset:1408
    ds_read_b64_tr_b16 v[100:101], v158 offset:192
    ds_read_b64_tr_b16 v[102:103], v158 offset:1472
    ds_read_b64_tr_b16 v[104:105], v158 offset:256
    ds_read_b64_tr_b16 v[106:107], v158 offset:1536
    ds_read_b128 v[84:87], v157 offset:0
    ds_read_b64_tr_b16 v[108:109], v158 offset:5120
    ds_read_b64_tr_b16 v[110:111], v158 offset:6400
    ds_read_b64_tr_b16 v[112:113], v158 offset:5184
    ds_read_b64_tr_b16 v[114:115], v158 offset:6464
    ds_read_b64_tr_b16 v[116:117], v158 offset:5248
    ds_read_b64_tr_b16 v[118:119], v158 offset:6528
    ds_read_b64_tr_b16 v[120:121], v158 offset:5312
    ds_read_b64_tr_b16 v[122:123], v158 offset:6592
    ds_read_b64_tr_b16 v[124:125], v158 offset:5376
    ds_read_b64_tr_b16 v[126:127], v158 offset:6656
    s_add_u32 m0, s24, 26624
    s_nop 0
    global_load_lds_dwordx4 v[132:133], off
    v_lshl_add_u64 v[132:133], v[132:133], 0, s[40:41]
    s_add_u32 m0, s25, 26624
    s_nop 0
    global_load_lds_dwordx4 v[134:135], off
    v_lshl_add_u64 v[134:135], v[134:135], 0, s[42:43]
    s_add_u32 m0, s26, 26624
    s_nop 0
    global_load_lds_dwordx4 v[136:137], off
    v_lshl_add_u64 v[136:137], v[136:137], 0, s[44:45]
    s_waitcnt lgkmcnt(11)
    v_mfma_f32_32x32x16_bf16 v[0:15], v[80:83], v[88:91], v[0:15]
    v_mfma_f32_32x32x16_bf16 v[16:31], v[80:83], v[92:95], v[16:31]
    v_mfma_f32_32x32x16_bf16 v[32:47], v[80:83], v[96:99], v[32:47]
    v_mfma_f32_32x32x16_bf16 v[48:63], v[80:83], v[100:103], v[48:63]
    v_mfma_f32_32x32x16_bf16 v[64:79], v[80:83], v[104:107], v[64:79]
    s_waitcnt lgkmcnt(0)
    v_mfma_f32_32x32x16_bf16 v[0:15], v[84:87], v[108:111], v[0:15]
    v_mfma_f32_32x32x16_bf16 v[16:31], v[84:87], v[112:115], v[16:31]
    v_mfma_f32_32x32x16_bf16 v[32:47], v[84:87], v[116:119], v[32:47]
    v_mfma_f32_32x32x16_bf16 v[48:63], v[84:87], v[120:123], v[48:63]
    v_mfma_f32_32x32x16_bf16 v[64:79], v[84:87], v[124:127], v[64:79]
    v_add_u32 v156, 53248, v128
    v_add_u32 v158, 53248, v130
    v_add_u32 v157, 53248, v129
    v_add_u32 v159, 53248, v131
    s_waitcnt vmcnt(9)
    s_barrier
    ds_read_b128 v[80:83], v156 offset:26624
    ds_read_b64_tr_b16 v[88:89], v158 offset:26624
    ds_read_b64_tr_b16 v[90:91], v158 offset:27904
    ds_read_b64_tr_b16 v[92:93], v158 offset:26688
    ds_read_b64_tr_b16 v[94:95], v158 offset:27968
    ds_read_b64_tr_b16 v[96:97], v158 offset:26752
    ds_read_b64_tr_b16 v[98:99], v158 offset:28032
    ds_read_b64_tr_b16 v[100:101], v158 offset:26816
    ds_read_b64_tr_b16 v[102:103], v158 offset:28096
    ds_read_b64_tr_b16 v[104:105], v158 offset:26880
    ds_read_b64_tr_b16 v[106:107], v158 offset:28160
    ds_read_b128 v[84:87], v157 offset:26624
    ds_read_b64_tr_b16 v[108:109], v158 offset:31744
    ds_read_b64_tr_b16 v[110:111], v158 offset:33024
    ds_read_b64_tr_b16 v[112:113], v158 offset:31808
    ds_read_b64_tr_b16 v[114:115], v158 offset:33088
    ds_read_b64_tr_b16 v[116:117], v158 offset:31872
    ds_read_b64_tr_b16 v[118:119], v158 offset:33152
    ds_read_b64_tr_b16 v[120:121], v158 offset:31936
    ds_read_b64_tr_b16 v[122:123], v158 offset:33216
    ds_read_b64_tr_b16 v[124:125], v158 offset:32000
    ds_read_b64_tr_b16 v[126:127], v158 offset:33280
    s_add_u32 m0, s24, 53248
    s_nop 0
    global_load_lds_dwordx4 v[132:133], off
    v_lshl_add_u64 v[132:133], v[132:133], 0, s[40:41]
    s_add_u32 m0, s25, 53248
    s_nop 0
    global_load_lds_dwordx4 v[134:135], off
    v_lshl_add_u64 v[134:135], v[134:135], 0, s[42:43]
    s_add_u32 m0, s26, 53248
    s_nop 0
    global_load_lds_dwordx4 v[136:137], off
    v_lshl_add_u64 v[136:137], v[136:137], 0, s[44:45]
    s_waitcnt lgkmcnt(11)
    v_mfma_f32_32x32x16_bf16 v[0:15], v[80:83], v[88:91], v[0:15]
    v_mfma_f32_32x32x16_bf16 v[16:31], v[80:83], v[92:95], v[16:31]
    v_mfma_f32_32x32x16_bf16 v[32:47], v[80:83], v[96:99], v[32:47]
    v_mfma_f32_32x32x16_bf16 v[48:63], v[80:83], v[100:103], v[48:63]
    v_mfma_f32_32x32x16_bf16 v[64:79], v[80:83], v[104:107], v[64:79]
    s_waitcnt lgkmcnt(0)
    v_mfma_f32_32x32x16_bf16 v[0:15], v[84:87], v[108:111], v[0:15]
    v_mfma_f32_32x32x16_bf16 v[16:31], v[84:87], v[112:115], v[16:31]
    v_mfma_f32_32x32x16_bf16 v[32:47], v[84:87], v[116:119], v[32:47]
    v_mfma_f32_32x32x16_bf16 v[48:63], v[84:87], v[120:123], v[48:63]
    v_mfma_f32_32x32x16_bf16 v[64:79], v[84:87], v[124:127], v[64:79]
    v_add_u32 v156, 106496, v128
    v_add_u32 v158, 106496, v130
    v_add_u32 v157, 106496, v129
    v_add_u32 v159, 106496, v131
    s_waitcnt vmcnt(9)
    s_barrier
    ds_read_b128 v[80:83], v156 offset:0
    ds_read_b64_tr_b16 v[88:89], v158 offset:0
    ds_read_b64_tr_b16 v[90:91], v158 offset:1280
    ds_read_b64_tr_b16 v[92:93], v158 offset:64
    ds_read_b64_tr_b16 v[94:95], v158 offset:1344
    ds_read_b64_tr_b16 v[96:97], v158 offset:128
    ds_read_b64_tr_b16 v[98:99], v158 offset:1408
    ds_read_b64_tr_b16 v[100:101], v158 offset:192
    ds_read_b64_tr_b16 v[102:103], v158 offset:1472
    ds_read_b64_tr_b16 v[104:105], v158 offset:256
    ds_read_b64_tr_b16 v[106:107], v158 offset:1536
    ds_read_b128 v[84:87], v157 offset:0
    ds_read_b64_tr_b16 v[108:109], v158 offset:5120
    ds_read_b64_tr_b16 v[110:111], v158 offset:6400
    ds_read_b64_tr_b16 v[112:113], v158 offset:5184
    ds_read_b64_tr_b16 v[114:115], v158 offset:6464
    ds_read_b64_tr_b16 v[116:117], v158 offset:5248
    ds_read_b64_tr_b16 v[118:119], v158 offset:6528
    ds_read_b64_tr_b16 v[120:121], v158 offset:5312
    ds_read_b64_tr_b16 v[122:123], v158 offset:6592
    ds_read_b64_tr_b16 v[124:125], v158 offset:5376
    ds_read_b64_tr_b16 v[126:127], v158 offset:6656
    s_add_u32 m0, s24, 79872
    s_nop 0
    global_load_lds_dwordx4 v[132:133], off
    v_lshl_add_u64 v[132:133], v[132:133], 0, s[40:41]
    s_add_u32 m0, s25, 79872
    s_nop 0
    global_load_lds_dwordx4 v[134:135], off
    v_lshl_add_u64 v[134:135], v[134:135], 0, s[42:43]
    s_add_u32 m0, s26, 79872
    s_nop 0
    global_load_lds_dwordx4 v[136:137], off
    v_lshl_add_u64 v[136:137], v[136:137], 0, s[44:45]
    s_waitcnt lgkmcnt(11)
    v_mfma_f32_32x32x16_bf16 v[0:15], v[80:83], v[88:91], v[0:15]
    v_mfma_f32_32x32x16_bf16 v[16:31], v[80:83], v[92:95], v[16:31]
    v_mfma_f32_32x32x16_bf16 v[32:47], v[80:83], v[96:99], v[32:47]
    v_mfma_f32_32x32x16_bf16 v[48:63], v[80:83], v[100:103], v[48:63]
    v_mfma_f32_32x32x16_bf16 v[64:79], v[80:83], v[104:107], v[64:79]
    s_waitcnt lgkmcnt(0)
    v_mfma_f32_32x32x16_bf16 v[0:15], v[84:87], v[108:111], v[0:15]
    v_mfma_f32_32x32x16_bf16 v[16:31], v[84:87], v[112:115], v[16:31]
    v_mfma_f32_32x32x16_bf16 v[32:47], v[84:87], v[116:119], v[32:47]
    v_mfma_f32_32x32x16_bf16 v[48:63], v[84:87], v[120:123], v[48:63]
    v_mfma_f32_32x32x16_bf16 v[64:79], v[84:87], v[124:127], v[64:79]
    s_waitcnt vmcnt(9)
    s_barrier
    ds_read_b128 v[80:83], v128 offset:0
    ds_read_b64_tr_b16 v[88:89], v130 offset:0
    ds_read_b64_tr_b16 v[90:91], v130 offset:1280
    ds_read_b64_tr_b16 v[92:93], v130 offset:64
    ds_read_b64_tr_b16 v[94:95], v130 offset:1344
    ds_read_b64_tr_b16 v[96:97], v130 offset:128
    ds_read_b64_tr_b16 v[98:99], v130 offset:1408
    ds_read_b64_tr_b16 v[100:101], v130 offset:192
    ds_read_b64_tr_b16 v[102:103], v130 offset:1472
    ds_read_b64_tr_b16 v[104:105], v130 offset:256
    ds_read_b64_tr_b16 v[106:107], v130 offset:1536
    ds_read_b128 v[84:87], v129 offset:0
    ds_read_b64_tr_b16 v[108:109], v130 offset:5120
    ds_read_b64_tr_b16 v[110:111], v130 offset:6400
    ds_read_b64_tr_b16 v[112:113], v130 offset:5184
    ds_read_b64_tr_b16 v[114:115], v130 offset:6464
    ds_read_b64_tr_b16 v[116:117], v130 offset:5248
    ds_read_b64_tr_b16 v[118:119], v130 offset:6528
    ds_read_b64_tr_b16 v[120:121], v130 offset:5312
    ds_read_b64_tr_b16 v[122:123], v130 offset:6592
    ds_read_b64_tr_b16 v[124:125], v130 offset:5376
    ds_read_b64_tr_b16 v[126:127], v130 offset:6656
    s_add_u32 m0, s24, 106496
    s_nop 0
    global_load_lds_dwordx4 v[132:133], off
    v_lshl_add_u64 v[132:133], v[132:133], 0, s[40:41]
    s_add_u32 m0, s25, 106496
    s_nop 0
    global_load_lds_dwordx4 v[134:135], off
    v_lshl_add_u64 v[134:135], v[134:135], 0, s[42:43]
    s_add_u32 m0, s26, 106496
    s_nop 0
    global_load_lds_dwordx4 v[136:137], off
    v_lshl_add_u64 v[136:137], v[136:137], 0, s[44:45]
    s_waitcnt lgkmcnt(11)
    v_mfma_f32_32x32x16_bf16 v[0:15], v[80:83], v[88:91], v[0:15]
    v_mfma_f32_32x32x16_bf16 v[16:31], v[80:83], v[92:95], v[16:31]
    v_mfma_f32_32x32x16_bf16 v[32:47], v[80:83], v[96:99], v[32:47]
    v_mfma_f32_32x32x16_bf16 v[48:63], v[80:83], v[100:103], v[48:63]
    v_mfma_f32_32x32x16_bf16 v[64:79], v[80:83], v[104:107], v[64:79]
    s_waitcnt lgkmcnt(0)
    v_mfma_f32_32x32x16_bf16 v[0:15], v[84:87], v[108:111], v[0:15]
    v_mfma_f32_32x32x16_bf16 v[16:31], v[84:87], v[112:115], v[16:31]
    v_mfma_f32_32x32x16_bf16 v[32:47], v[84:87], v[116:119], v[32:47]
    v_mfma_f32_32x32x16_bf16 v[48:63], v[84:87], v[120:123], v[48:63]
    v_mfma_f32_32x32x16_bf16 v[64:79], v[84:87], v[124:127], v[64:79]
    s_waitcnt vmcnt(9)
    s_barrier
    ds_read_b128 v[80:83], v128 offset:26624
    ds_read_b64_tr_b16 v[88:89], v130 offset:26624
    ds_read_b64_tr_b16 v[90:91], v130 offset:27904
    ds_read_b64_tr_b16 v[92:93], v130 offset:26688
    ds_read_b64_tr_b16 v[94:95], v130 offset:27968
    ds_read_b64_tr_b16 v[96:97], v130 offset:26752
    ds_read_b64_tr_b16 v[98:99], v130 offset:28032
    ds_read_b64_tr_b16 v[100:101], v130 offset:26816
    ds_read_b64_tr_b16 v[102:103], v130 offset:28096
    ds_read_b64_tr_b16 v[104:105], v130 offset:26880
    ds_read_b64_tr_b16 v[106:107], v130 offset:28160
    ds_read_b128 v[84:87], v129 offset:26624
    ds_read_b64_tr_b16 v[108:109], v130 offset:31744
    ds_read_b64_tr_b16 v[110:111], v130 offset:33024
    ds_read_b64_tr_b16 v[112:113], v130 offset:31808
    ds_read_b64_tr_b16 v[114:115], v130 offset:33088
    ds_read_b64_tr_b16 v[116:117], v130 offset:31872
    ds_read_b64_tr_b16 v[118:119], v130 offset:33152
    ds_read_b64_tr_b16 v[120:121], v130 offset:31936
    ds_read_b64_tr_b16 v[122:123], v130 offset:33216
    ds_read_b64_tr_b16 v[124:125], v130 offset:32000
    ds_read_b64_tr_b16 v[126:127], v130 offset:33280
    s_add_u32 m0, s24, 0
    s_nop 0
    global_load_lds_dwordx4 v[132:133], off
    v_lshl_add_u64 v[132:133], v[132:133], 0, s[40:41]
    s_add_u32 m0, s25, 0
    s_nop 0
    global_load_lds_dwordx4 v[134:135], off
    v_lshl_add_u64 v[134:135], v[134:135], 0, s[42:43]
    s_add_u32 m0, s26, 0
    s_nop 0
    global_load_lds_dwordx4 v[136:137], off
    v_lshl_add_u64 v[136:137], v[136:137], 0, s[44:45]
    s_waitcnt lgkmcnt(11)
    v_mfma_f32_32x32x16_bf16 v[0:15], v[80:83], v[88:91], v[0:15]
    v_mfma_f32_32x32x16_bf16 v[16:31], v[80:83], v[92:95], v[16:31]
    v_mfma_f32_32x32x16_bf16 v[32:47], v[80:83], v[96:99], v[32:47]
    v_mfma_f32_32x32x16_bf16 v[48:63], v[80:83], v[100:103], v[48:63]
    v_mfma_f32_32x32x16_bf16 v[64:79], v[80:83], v[104:107], v[64:79]
    s_waitcnt lgkmcnt(0)
    v_mfma_f32_32x32x16_bf16 v[0:15], v[84:87], v[108:111], v[0:15]
    v_mfma_f32_32x32x16_bf16 v[16:31], v[84:87], v[112:115], v[16:31]
    v_mfma_f32_32x32x16_bf16 v[32:47], v[84:87], v[116:119], v[32:47]
    v_mfma_f32_32x32x16_bf16 v[48:63], v[84:87], v[120:123], v[48:63]
    v_mfma_f32_32x32x16_bf16 v[64:79], v[84:87], v[124:127], v[64:79]
    v_add_u32 v156, 53248, v128
    v_add_u32 v158, 53248, v130
    v_add_u32 v157, 53248, v129
    v_add_u32 v159, 53248, v131
    s_waitcnt vmcnt(9)
    s_barrier
    ds_read_b128 v[80:83], v156 offset:0
    ds_read_b64_tr_b16 v[88:89], v158 offset:0
    ds_read_b64_tr_b16 v[90:91], v158 offset:1280
    ds_read_b64_tr_b16 v[92:93], v158 offset:64
    ds_read_b64_tr_b16 v[94:95], v158 offset:1344
    ds_read_b64_tr_b16 v[96:97], v158 offset:128
    ds_read_b64_tr_b16 v[98:99], v158 offset:1408
    ds_read_b64_tr_b16 v[100:101], v158 offset:192
    ds_read_b64_tr_b16 v[102:103], v158 offset:1472
    ds_read_b64_tr_b16 v[104:105], v158 offset:256
    ds_read_b64_tr_b16 v[106:107], v158 offset:1536
    ds_read_b128 v[84:87], v157 offset:0
    ds_read_b64_tr_b16 v[108:109], v158 offset:5120
    ds_read_b64_tr_b16 v[110:111], v158 offset:6400
    ds_read_b64_tr_b16 v[112:113], v158 offset:5184
    ds_read_b64_tr_b16 v[114:115], v158 offset:6464
    ds_read_b64_tr_b16 v[116:117], v158 offset:5248
    ds_read_b64_tr_b16 v[118:119], v158 offset:6528
    ds_read_b64_tr_b16 v[120:121], v158 offset:5312
    ds_read_b64_tr_b16 v[122:123], v158 offset:6592
    ds_read_b64_tr_b16 v[124:125], v158 offset:5376
    ds_read_b64_tr_b16 v[126:127], v158 offset:6656
    s_add_u32 m0, s24, 26624
    s_nop 0
    global_load_lds_dwordx4 v[132:133], off
    v_lshl_add_u64 v[132:133], v[132:133], 0, s[40:41]
    s_add_u32 m0, s25, 26624
    s_nop 0
    global_load_lds_dwordx4 v[134:135], off
    v_lshl_add_u64 v[134:135], v[134:135], 0, s[42:43]
    s_add_u32 m0, s26, 26624
    s_nop 0
    global_load_lds_dwordx4 v[136:137], off
    v_lshl_add_u64 v[136:137], v[136:137], 0, s[44:45]
    s_waitcnt lgkmcnt(11)
    v_mfma_f32_32x32x16_bf16 v[0:15], v[80:83], v[88:91], v[0:15]
    v_mfma_f32_32x32x16_bf16 v[16:31], v[80:83], v[92:95], v[16:31]
    v_mfma_f32_32x32x16_bf16 v[32:47], v[80:83], v[96:99], v[32:47]
    v_mfma_f32_32x32x16_bf16 v[48:63], v[80:83], v[100:103], v[48:63]
    v_mfma_f32_32x32x16_bf16 v[64:79], v[80:83], v[104:107], v[64:79]
    s_waitcnt lgkmcnt(0)
    v_mfma_f32_32x32x16_bf16 v[0:15], v[84:87], v[108:111], v[0:15]
    v_mfma_f32_32x32x16_bf16 v[16:31], v[84:87], v[112:115], v[16:31]
    v_mfma_f32_32x32x16_bf16 v[32:47], v[84:87], v[116:119], v[32:47]
    v_mfma_f32_32x32x16_bf16 v[48:63], v[84:87], v[120:123], v[48:63]
    v_mfma_f32_32x32x16_bf16 v[64:79], v[84:87], v[124:127], v[64:79]
    v_add_u32 v156, 53248, v128
    v_add_u32 v158, 53248, v130
    v_add_u32 v157, 53248, v129
    v_add_u32 v159, 53248, v131
    s_waitcnt vmcnt(9)
    s_barrier
    ds_read_b128 v[80:83], v156 offset:26624
    ds_read_b64_tr_b16 v[88:89], v158 offset:26624
    ds_read_b64_tr_b16 v[90:91], v158 offset:27904
    ds_read_b64_tr_b16 v[92:93], v158 offset:26688
    ds_read_b64_tr_b16 v[94:95], v158 offset:27968
    ds_read_b64_tr_b16 v[96:97], v158 offset:26752
    ds_read_b64_tr_b16 v[98:99], v158 offset:28032
    ds_read_b64_tr_b16 v[100:101], v158 offset:26816
    ds_read_b64_tr_b16 v[102:103], v158 offset:28096
    ds_read_b64_tr_b16 v[104:105], v158 offset:26880
    ds_read_b64_tr_b16 v[106:107], v158 offset:28160
    ds_read_b128 v[84:87], v157 offset:26624
    ds_read_b64_tr_b16 v[108:109], v158 offset:31744
    ds_read_b64_tr_b16 v[110:111], v158 offset:33024
    ds_read_b64_tr_b16 v[112:113], v158 offset:31808
    ds_read_b64_tr_b16 v[114:115], v158 offset:33088
    ds_read_b64_tr_b16 v[116:117], v158 offset:31872
    ds_read_b64_tr_b16 v[118:119], v158 offset:33152
    ds_read_b64_tr_b16 v[120:121], v158 offset:31936
    ds_read_b64_tr_b16 v[122:123], v158 offset:33216
    ds_read_b64_tr_b16 v[124:125], v158 offset:32000
    ds_read_b64_tr_b16 v[126:127], v158 offset:33280
    s_add_u32 m0, s24, 53248
    s_nop 0
    global_load_lds_dwordx4 v[132:133], off
    v_lshl_add_u64 v[132:133], v[132:133], 0, s[40:41]
    s_add_u32 m0, s25, 53248
    s_nop 0
    global_load_lds_dwordx4 v[134:135], off
    v_lshl_add_u64 v[134:135], v[134:135], 0, s[42:43]
    s_add_u32 m0, s26, 53248
    s_nop 0
    global_load_lds_dwordx4 v[136:137], off
    v_lshl_add_u64 v[136:137], v[136:137], 0, s[44:45]
    s_waitcnt lgkmcnt(11)
    v_mfma_f32_32x32x16_bf16 v[0:15], v[80:83], v[88:91], v[0:15]
    v_mfma_f32_32x32x16_bf16 v[16:31], v[80:83], v[92:95], v[16:31]
    v_mfma_f32_32x32x16_bf16 v[32:47], v[80:83], v[96:99], v[32:47]
    v_mfma_f32_32x32x16_bf16 v[48:63], v[80:83], v[100:103], v[48:63]
    v_mfma_f32_32x32x16_bf16 v[64:79], v[80:83], v[104:107], v[64:79]
    s_waitcnt lgkmcnt(0)
    v_mfma_f32_32x32x16_bf16 v[0:15], v[84:87], v[108:111], v[0:15]
    v_mfma_f32_32x32x16_bf16 v[16:31], v[84:87], v[112:115], v[16:31]
    v_mfma_f32_32x32x16_bf16 v[32:47], v[84:87], v[116:119], v[32:47]
    v_mfma_f32_32x32x16_bf16 v[48:63], v[84:87], v[120:123], v[48:63]
    v_mfma_f32_32x32x16_bf16 v[64:79], v[84:87], v[124:127], v[64:79]
    v_add_u32 v156, 106496, v128
    v_add_u32 v158, 106496, v130
    v_add_u32 v157, 106496, v129
    v_add_u32 v159, 106496, v131
    s_waitcnt vmcnt(9)
    s_barrier
    ds_read_b128 v[80:83], v156 offset:0
    ds_read_b64_tr_b16 v[88:89], v158 offset:0
    ds_read_b64_tr_b16 v[90:91], v158 offset:1280
    ds_read_b64_tr_b16 v[92:93], v158 offset:64
    ds_read_b64_tr_b16 v[94:95], v158 offset:1344
    ds_read_b64_tr_b16 v[96:97], v158 offset:128
    ds_read_b64_tr_b16 v[98:99], v158 offset:1408
    ds_read_b64_tr_b16 v[100:101], v158 offset:192
    ds_read_b64_tr_b16 v[102:103], v158 offset:1472
    ds_read_b64_tr_b16 v[104:105], v158 offset:256
    ds_read_b64_tr_b16 v[106:107], v158 offset:1536
    ds_read_b128 v[84:87], v157 offset:0
    ds_read_b64_tr_b16 v[108:109], v158 offset:5120
    ds_read_b64_tr_b16 v[110:111], v158 offset:6400
    ds_read_b64_tr_b16 v[112:113], v158 offset:5184
    ds_read_b64_tr_b16 v[114:115], v158 offset:6464
    ds_read_b64_tr_b16 v[116:117], v158 offset:5248
    ds_read_b64_tr_b16 v[118:119], v158 offset:6528
    ds_read_b64_tr_b16 v[120:121], v158 offset:5312
    ds_read_b64_tr_b16 v[122:123], v158 offset:6592
    ds_read_b64_tr_b16 v[124:125], v158 offset:5376
    ds_read_b64_tr_b16 v[126:127], v158 offset:6656
    s_add_u32 m0, s24, 79872
    s_nop 0
    global_load_lds_dwordx4 v[132:133], off
    v_lshl_add_u64 v[132:133], v[132:133], 0, s[40:41]
    s_add_u32 m0, s25, 79872
    s_nop 0
    global_load_lds_dwordx4 v[134:135], off
    v_lshl_add_u64 v[134:135], v[134:135], 0, s[42:43]
    s_add_u32 m0, s26, 79872
    s_nop 0
    global_load_lds_dwordx4 v[136:137], off
    v_lshl_add_u64 v[136:137], v[136:137], 0, s[44:45]
    s_waitcnt lgkmcnt(11)
    v_mfma_f32_32x32x16_bf16 v[0:15], v[80:83], v[88:91], v[0:15]
    v_mfma_f32_32x32x16_bf16 v[16:31], v[80:83], v[92:95], v[16:31]
    v_mfma_f32_32x32x16_bf16 v[32:47], v[80:83], v[96:99], v[32:47]
    v_mfma_f32_32x32x16_bf16 v[48:63], v[80:83], v[100:103], v[48:63]
    v_mfma_f32_32x32x16_bf16 v[64:79], v[80:83], v[104:107], v[64:79]
    s_waitcnt lgkmcnt(0)
    v_mfma_f32_32x32x16_bf16 v[0:15], v[84:87], v[108:111], v[0:15]
    v_mfma_f32_32x32x16_bf16 v[16:31], v[84:87], v[112:115], v[16:31]
    v_mfma_f32_32x32x16_bf16 v[32:47], v[84:87], v[116:119], v[32:47]
    v_mfma_f32_32x32x16_bf16 v[48:63], v[84:87], v[120:123], v[48:63]
    v_mfma_f32_32x32x16_bf16 v[64:79], v[84:87], v[124:127], v[64:79]
    s_waitcnt vmcnt(9)
    s_barrier
    ds_read_b128 v[80:83], v128 offset:0
    ds_read_b64_tr_b16 v[88:89], v130 offset:0
    ds_read_b64_tr_b16 v[90:91], v130 offset:1280
    ds_read_b64_tr_b16 v[92:93], v130 offset:64
    ds_read_b64_tr_b16 v[94:95], v130 offset:1344
    ds_read_b64_tr_b16 v[96:97], v130 offset:128
    ds_read_b64_tr_b16 v[98:99], v130 offset:1408
    ds_read_b64_tr_b16 v[100:101], v130 offset:192
    ds_read_b64_tr_b16 v[102:103], v130 offset:1472
    ds_read_b64_tr_b16 v[104:105], v130 offset:256
    ds_read_b64_tr_b16 v[106:107], v130 offset:1536
    ds_read_b128 v[84:87], v129 offset:0
    ds_read_b64_tr_b16 v[108:109], v130 offset:5120
    ds_read_b64_tr_b16 v[110:111], v130 offset:6400
    ds_read_b64_tr_b16 v[112:113], v130 offset:5184
    ds_read_b64_tr_b16 v[114:115], v130 offset:6464
    ds_read_b64_tr_b16 v[116:117], v130 offset:5248
    ds_read_b64_tr_b16 v[118:119], v130 offset:6528
    ds_read_b64_tr_b16 v[120:121], v130 offset:5312
    ds_read_b64_tr_b16 v[122:123], v130 offset:6592
    ds_read_b64_tr_b16 v[124:125], v130 offset:5376
    ds_read_b64_tr_b16 v[126:127], v130 offset:6656
    s_add_u32 m0, s24, 106496
    s_nop 0
    global_load_lds_dwordx4 v[132:133], off
    v_lshl_add_u64 v[132:133], v[132:133], 0, s[40:41]
    s_add_u32 m0, s25, 106496
    s_nop 0
    global_load_lds_dwordx4 v[134:135], off
    v_lshl_add_u64 v[134:135], v[134:135], 0, s[42:43]
    s_add_u32 m0, s26, 106496
    s_nop 0
    global_load_lds_dwordx4 v[136:137], off
    v_lshl_add_u64 v[136:137], v[136:137], 0, s[44:45]
    s_waitcnt lgkmcnt(11)
    v_mfma_f32_32x32x16_bf16 v[0:15], v[80:83], v[88:91], v[0:15]
    v_mfma_f32_32x32x16_bf16 v[16:31], v[80:83], v[92:95], v[16:31]
    v_mfma_f32_32x32x16_bf16 v[32:47], v[80:83], v[96:99], v[32:47]
    v_mfma_f32_32x32x16_bf16 v[48:63], v[80:83], v[100:103], v[48:63]
    v_mfma_f32_32x32x16_bf16 v[64:79], v[80:83], v[104:107], v[64:79]
    s_waitcnt lgkmcnt(0)
    v_mfma_f32_32x32x16_bf16 v[0:15], v[84:87], v[108:111], v[0:15]
    v_mfma_f32_32x32x16_bf16 v[16:31], v[84:87], v[112:115], v[16:31]
    v_mfma_f32_32x32x16_bf16 v[32:47], v[84:87], v[116:119], v[32:47]
    v_mfma_f32_32x32x16_bf16 v[48:63], v[84:87], v[120:123], v[48:63]
    v_mfma_f32_32x32x16_bf16 v[64:79], v[84:87], v[124:127], v[64:79]
    s_waitcnt vmcnt(9)
    s_barrier
    ds_read_b128 v[80:83], v128 offset:26624
    ds_read_b64_tr_b16 v[88:89], v130 offset:26624
    ds_read_b64_tr_b16 v[90:91], v130 offset:27904
    ds_read_b64_tr_b16 v[92:93], v130 offset:26688
    ds_read_b64_tr_b16 v[94:95], v130 offset:27968
    ds_read_b64_tr_b16 v[96:97], v130 offset:26752
    ds_read_b64_tr_b16 v[98:99], v130 offset:28032
    ds_read_b64_tr_b16 v[100:101], v130 offset:26816
    ds_read_b64_tr_b16 v[102:103], v130 offset:28096
    ds_read_b64_tr_b16 v[104:105], v130 offset:26880
    ds_read_b64_tr_b16 v[106:107], v130 offset:28160
    ds_read_b128 v[84:87], v129 offset:26624
    ds_read_b64_tr_b16 v[108:109], v130 offset:31744
    ds_read_b64_tr_b16 v[110:111], v130 offset:33024
    ds_read_b64_tr_b16 v[112:113], v130 offset:31808
    ds_read_b64_tr_b16 v[114:115], v130 offset:33088
    ds_read_b64_tr_b16 v[116:117], v130 offset:31872
    ds_read_b64_tr_b16 v[118:119], v130 offset:33152
    ds_read_b64_tr_b16 v[120:121], v130 offset:31936
    ds_read_b64_tr_b16 v[122:123], v130 offset:33216
    ds_read_b64_tr_b16 v[124:125], v130 offset:32000
    ds_read_b64_tr_b16 v[126:127], v130 offset:33280
    s_waitcnt lgkmcnt(11)
    v_mfma_f32_32x32x16_bf16 v[0:15], v[80:83], v[88:91], v[0:15]
    v_mfma_f32_32x32x16_bf16 v[16:31], v[80:83], v[92:95], v[16:31]
    v_mfma_f32_32x32x16_bf16 v[32:47], v[80:83], v[96:99], v[32:47]
    v_mfma_f32_32x32x16_bf16 v[48:63], v[80:83], v[100:103], v[48:63]
    v_mfma_f32_32x32x16_bf16 v[64:79], v[80:83], v[104:107], v[64:79]
    s_waitcnt lgkmcnt(0)
    v_mfma_f32_32x32x16_bf16 v[0:15], v[84:87], v[108:111], v[0:15]
    v_mfma_f32_32x32x16_bf16 v[16:31], v[84:87], v[112:115], v[16:31]
    v_mfma_f32_32x32x16_bf16 v[32:47], v[84:87], v[116:119], v[32:47]
    v_mfma_f32_32x32x16_bf16 v[48:63], v[84:87], v[120:123], v[48:63]
    v_mfma_f32_32x32x16_bf16 v[64:79], v[84:87], v[124:127], v[64:79]
    v_add_u32 v156, 53248, v128
    v_add_u32 v158, 53248, v130
    v_add_u32 v157, 53248, v129
    v_add_u32 v159, 53248, v131
    s_waitcnt vmcnt(6)
    s_barrier
    ds_read_b128 v[80:83], v156 offset:0
    ds_read_b64_tr_b16 v[88:89], v158 offset:0
    ds_read_b64_tr_b16 v[90:91], v158 offset:1280
    ds_read_b64_tr_b16 v[92:93], v158 offset:64
    ds_read_b64_tr_b16 v[94:95], v158 offset:1344
    ds_read_b64_tr_b16 v[96:97], v158 offset:128
    ds_read_b64_tr_b16 v[98:99], v158 offset:1408
    ds_read_b64_tr_b16 v[100:101], v158 offset:192
    ds_read_b64_tr_b16 v[102:103], v158 offset:1472
    ds_read_b64_tr_b16 v[104:105], v158 offset:256
    ds_read_b64_tr_b16 v[106:107], v158 offset:1536
    ds_read_b128 v[84:87], v157 offset:0
    ds_read_b64_tr_b16 v[108:109], v158 offset:5120
    ds_read_b64_tr_b16 v[110:111], v158 offset:6400
    ds_read_b64_tr_b16 v[112:113], v158 offset:5184
    ds_read_b64_tr_b16 v[114:115], v158 offset:6464
    ds_read_b64_tr_b16 v[116:117], v158 offset:5248
    ds_read_b64_tr_b16 v[118:119], v158 offset:6528
    ds_read_b64_tr_b16 v[120:121], v158 offset:5312
    ds_read_b64_tr_b16 v[122:123], v158 offset:6592
    ds_read_b64_tr_b16 v[124:125], v158 offset:5376
    ds_read_b64_tr_b16 v[126:127], v158 offset:6656
    s_waitcnt lgkmcnt(11)
    v_mfma_f32_32x32x16_bf16 v[0:15], v[80:83], v[88:91], v[0:15]
    v_mfma_f32_32x32x16_bf16 v[16:31], v[80:83], v[92:95], v[16:31]
    v_mfma_f32_32x32x16_bf16 v[32:47], v[80:83], v[96:99], v[32:47]
    v_mfma_f32_32x32x16_bf16 v[48:63], v[80:83], v[100:103], v[48:63]
    v_mfma_f32_32x32x16_bf16 v[64:79], v[80:83], v[104:107], v[64:79]
    s_waitcnt lgkmcnt(0)
    v_mfma_f32_32x32x16_bf16 v[0:15], v[84:87], v[108:111], v[0:15]
    v_mfma_f32_32x32x16_bf16 v[16:31], v[84:87], v[112:115], v[16:31]
    v_mfma_f32_32x32x16_bf16 v[32:47], v[84:87], v[116:119], v[32:47]
    v_mfma_f32_32x32x16_bf16 v[48:63], v[84:87], v[120:123], v[48:63]
    v_mfma_f32_32x32x16_bf16 v[64:79], v[84:87], v[124:127], v[64:79]
    v_add_u32 v156, 53248, v128
    v_add_u32 v158, 53248, v130
    v_add_u32 v157, 53248, v129
    v_add_u32 v159, 53248, v131
    s_waitcnt vmcnt(3)
    s_barrier
    ds_read_b128 v[80:83], v156 offset:26624
    ds_read_b64_tr_b16 v[88:89], v158 offset:26624
    ds_read_b64_tr_b16 v[90:91], v158 offset:27904
    ds_read_b64_tr_b16 v[92:93], v158 offset:26688
    ds_read_b64_tr_b16 v[94:95], v158 offset:27968
    ds_read_b64_tr_b16 v[96:97], v158 offset:26752
    ds_read_b64_tr_b16 v[98:99], v158 offset:28032
    ds_read_b64_tr_b16 v[100:101], v158 offset:26816
    ds_read_b64_tr_b16 v[102:103], v158 offset:28096
    ds_read_b64_tr_b16 v[104:105], v158 offset:26880
    ds_read_b64_tr_b16 v[106:107], v158 offset:28160
    ds_read_b128 v[84:87], v157 offset:26624
    ds_read_b64_tr_b16 v[108:109], v158 offset:31744
    ds_read_b64_tr_b16 v[110:111], v158 offset:33024
    ds_read_b64_tr_b16 v[112:113], v158 offset:31808
    ds_read_b64_tr_b16 v[114:115], v158 offset:33088
    ds_read_b64_tr_b16 v[116:117], v158 offset:31872
    ds_read_b64_tr_b16 v[118:119], v158 offset:33152
    ds_read_b64_tr_b16 v[120:121], v158 offset:31936
    ds_read_b64_tr_b16 v[122:123], v158 offset:33216
    ds_read_b64_tr_b16 v[124:125], v158 offset:32000
    ds_read_b64_tr_b16 v[126:127], v158 offset:33280
    s_waitcnt lgkmcnt(11)
    v_mfma_f32_32x32x16_bf16 v[0:15], v[80:83], v[88:91], v[0:15]
    v_mfma_f32_32x32x16_bf16 v[16:31], v[80:83], v[92:95], v[16:31]
    v_mfma_f32_32x32x16_bf16 v[32:47], v[80:83], v[96:99], v[32:47]
    v_mfma_f32_32x32x16_bf16 v[48:63], v[80:83], v[100:103], v[48:63]
    v_mfma_f32_32x32x16_bf16 v[64:79], v[80:83], v[104:107], v[64:79]
    s_waitcnt lgkmcnt(0)
    v_mfma_f32_32x32x16_bf16 v[0:15], v[84:87], v[108:111], v[0:15]
    v_mfma_f32_32x32x16_bf16 v[16:31], v[84:87], v[112:115], v[16:31]
    v_mfma_f32_32x32x16_bf16 v[32:47], v[84:87], v[116:119], v[32:47]
    v_mfma_f32_32x32x16_bf16 v[48:63], v[84:87], v[120:123], v[48:63]
    v_mfma_f32_32x32x16_bf16 v[64:79], v[84:87], v[124:127], v[64:79]
    v_add_u32 v156, 106496, v128
    v_add_u32 v158, 106496, v130
    v_add_u32 v157, 106496, v129
    v_add_u32 v159, 106496, v131
    s_waitcnt vmcnt(0)
    s_barrier
    ds_read_b128 v[80:83], v156 offset:0
    ds_read_b64_tr_b16 v[88:89], v158 offset:0
    ds_read_b64_tr_b16 v[90:91], v158 offset:1280
    ds_read_b64_tr_b16 v[92:93], v158 offset:64
    ds_read_b64_tr_b16 v[94:95], v158 offset:1344
    ds_read_b64_tr_b16 v[96:97], v158 offset:128
    ds_read_b64_tr_b16 v[98:99], v158 offset:1408
    ds_read_b64_tr_b16 v[100:101], v158 offset:192
    ds_read_b64_tr_b16 v[102:103], v158 offset:1472
    ds_read_b64_tr_b16 v[104:105], v158 offset:256
    ds_read_b64_tr_b16 v[106:107], v158 offset:1536
    ds_read_b128 v[84:87], v157 offset:0
    ds_read_b64_tr_b16 v[108:109], v158 offset:5120
    ds_read_b64_tr_b16 v[110:111], v158 offset:6400
    ds_read_b64_tr_b16 v[112:113], v158 offset:5184
    ds_read_b64_tr_b16 v[114:115], v158 offset:6464
    ds_read_b64_tr_b16 v[116:117], v158 offset:5248
    ds_read_b64_tr_b16 v[118:119], v158 offset:6528
    ds_read_b64_tr_b16 v[120:121], v158 offset:5312
    ds_read_b64_tr_b16 v[122:123], v158 offset:6592
    ds_read_b64_tr_b16 v[124:125], v158 offset:5376
    ds_read_b64_tr_b16 v[126:127], v158 offset:6656
    s_waitcnt lgkmcnt(11)
    v_mfma_f32_32x32x16_bf16 v[0:15], v[80:83], v[88:91], v[0:15]
    v_mfma_f32_32x32x16_bf16 v[16:31], v[80:83], v[92:95], v[16:31]
    v_mfma_f32_32x32x16_bf16 v[32:47], v[80:83], v[96:99], v[32:47]
    v_mfma_f32_32x32x16_bf16 v[48:63], v[80:83], v[100:103], v[48:63]
    v_mfma_f32_32x32x16_bf16 v[64:79], v[80:83], v[104:107], v[64:79]
    s_waitcnt lgkmcnt(0)
    v_mfma_f32_32x32x16_bf16 v[0:15], v[84:87], v[108:111], v[0:15]
    v_mfma_f32_32x32x16_bf16 v[16:31], v[84:87], v[112:115], v[16:31]
    v_mfma_f32_32x32x16_bf16 v[32:47], v[84:87], v[116:119], v[32:47]
    v_mfma_f32_32x32x16_bf16 v[48:63], v[84:87], v[120:123], v[48:63]
    v_mfma_f32_32x32x16_bf16 v[64:79], v[84:87], v[124:127], v[64:79]
    s_barrier
    s_nop 15
    s_mov_b32 s38, 12582912
    v_and_b32 v143, 31, v140
    v_lshrrev_b32 v142, 5, v140
    s_lshl_b32 s37, s30, 11
    s_movk_i32 s39, 3277
    v_add_u32 v144, 0, v143
    v_mul_lo_u32 v145, v144, s39
    v_lshrrev_b32 v145, 16, v145
    v_mul_u32_u24 v146, 20, v145
    v_sub_u32 v146, v144, v146
    v_lshlrev_b32 v145, 14, v145
    v_add_u32 v145, s37, v145
    v_bfe_u32 v147, v146, 2, 2
    v_xor_b32 v147, v147, v142
    v_lshlrev_b32 v147, 4, v147
    v_lshl_add_u32 v147, v146, 6, v147
    v_add_u32 v147, v147, v145
    v_xor_b32 v148, 32, v147
    v_add_u32 v149, 12, v146
    v_bfe_u32 v150, v149, 2, 2
    v_xor_b32 v150, v150, v142
    v_lshlrev_b32 v150, 4, v150
    v_lshl_add_u32 v150, v149, 6, v150
    v_add_u32 v150, v150, v145
    v_xor_b32 v151, 32, v150
    v_cmp_eq_u32 vcc, 8, v146
    v_mov_b32 v152, 0x3f803f80
    s_nop 0
    v_cndmask_b32 v156, 0, v152, vcc
    v_mov_b32 v157, v156
    v_mov_b32 v158, v156
    v_mov_b32 v159, v156
    v_cmp_le_u32 s[52:53], 8, v146
    v_cvt_pk_bf16_f32 v152, v0, v1
    v_cvt_pk_bf16_f32 v153, v2, v3
    v_cvt_pk_bf16_f32 v154, v4, v5
    v_cvt_pk_bf16_f32 v155, v6, v7
    ds_write_b128 v147, v[152:155]
    s_nop 1
    v_cvt_pk_bf16_f32 v152, v8, v9
    v_cvt_pk_bf16_f32 v153, v10, v11
    v_cvt_pk_bf16_f32 v154, v12, v13
    v_cvt_pk_bf16_f32 v155, v14, v15
    ds_write_b128 v148, v[152:155]
    s_nop 1
    s_mov_b64 s[54:55], exec
    s_and_b64 exec, exec, s[52:53]
    ds_write_b128 v150, v[156:159]
    ds_write_b128 v151, v[156:159]
    s_mov_b64 exec, s[54:55]
    s_nop 1
    v_add_u32 v144, 32, v143
    v_mul_lo_u32 v145, v144, s39
    v_lshrrev_b32 v145, 16, v145
    v_mul_u32_u24 v146, 20, v145
    v_sub_u32 v146, v144, v146
    v_lshlrev_b32 v145, 14, v145
    v_add_u32 v145, s37, v145
    v_bfe_u32 v147, v146, 2, 2
    v_xor_b32 v147, v147, v142
    v_lshlrev_b32 v147, 4, v147
    v_lshl_add_u32 v147, v146, 6, v147
    v_add_u32 v147, v147, v145
    v_xor_b32 v148, 32, v147
    v_add_u32 v149, 12, v146
    v_bfe_u32 v150, v149, 2, 2
    v_xor_b32 v150, v150, v142
    v_lshlrev_b32 v150, 4, v150
    v_lshl_add_u32 v150, v149, 6, v150
    v_add_u32 v150, v150, v145
    v_xor_b32 v151, 32, v150
    v_cmp_eq_u32 vcc, 8, v146
    v_mov_b32 v152, 0x3f803f80
    s_nop 0
    v_cndmask_b32 v156, 0, v152, vcc
    v_mov_b32 v157, v156
    v_mov_b32 v158, v156
    v_mov_b32 v159, v156
    v_cmp_le_u32 s[52:53], 8, v146
    v_cvt_pk_bf16_f32 v152, v16, v17
    v_cvt_pk_bf16_f32 v153, v18, v19
    v_cvt_pk_bf16_f32 v154, v20, v21
    v_cvt_pk_bf16_f32 v155, v22, v23
    ds_write_b128 v147, v[152:155]
    s_nop 1
    v_cvt_pk_bf16_f32 v152, v24, v25
    v_cvt_pk_bf16_f32 v153, v26, v27
    v_cvt_pk_bf16_f32 v154, v28, v29
    v_cvt_pk_bf16_f32 v155, v30, v31
    ds_write_b128 v148, v[152:155]
    s_nop 1
    s_mov_b64 s[54:55], exec
    s_and_b64 exec, exec, s[52:53]
    ds_write_b128 v150, v[156:159]
    ds_write_b128 v151, v[156:159]
    s_mov_b64 exec, s[54:55]
    s_nop 1
    v_add_u32 v144, 64, v143
    v_mul_lo_u32 v145, v144, s39
    v_lshrrev_b32 v145, 16, v145
    v_mul_u32_u24 v146, 20, v145
    v_sub_u32 v146, v144, v146
    v_lshlrev_b32 v145, 14, v145
    v_add_u32 v145, s37, v145
    v_bfe_u32 v147, v146, 2, 2
    v_xor_b32 v147, v147, v142
    v_lshlrev_b32 v147, 4, v147
    v_lshl_add_u32 v147, v146, 6, v147
    v_add_u32 v147, v147, v145
    v_xor_b32 v148, 32, v147
    v_add_u32 v149, 12, v146
    v_bfe_u32 v150, v149, 2, 2
    v_xor_b32 v150, v150, v142
    v_lshlrev_b32 v150, 4, v150
    v_lshl_add_u32 v150, v149, 6, v150
    v_add_u32 v150, v150, v145
    v_xor_b32 v151, 32, v150
    v_cmp_eq_u32 vcc, 8, v146
    v_mov_b32 v152, 0x3f803f80
    s_nop 0
    v_cndmask_b32 v156, 0, v152, vcc
    v_mov_b32 v157, v156
    v_mov_b32 v158, v156
    v_mov_b32 v159, v156
    v_cmp_le_u32 s[52:53], 8, v146
    v_cvt_pk_bf16_f32 v152, v32, v33
    v_cvt_pk_bf16_f32 v153, v34, v35
    v_cvt_pk_bf16_f32 v154, v36, v37
    v_cvt_pk_bf16_f32 v155, v38, v39
    ds_write_b128 v147, v[152:155]
    s_nop 1
    v_cvt_pk_bf16_f32 v152, v40, v41
    v_cvt_pk_bf16_f32 v153, v42, v43
    v_cvt_pk_bf16_f32 v154, v44, v45
    v_cvt_pk_bf16_f32 v155, v46, v47
    ds_write_b128 v148, v[152:155]
    s_nop 1
    s_mov_b64 s[54:55], exec
    s_and_b64 exec, exec, s[52:53]
    ds_write_b128 v150, v[156:159]
    ds_write_b128 v151, v[156:159]
    s_mov_b64 exec, s[54:55]
    s_nop 1
    v_add_u32 v144, 96, v143
    v_mul_lo_u32 v145, v144, s39
    v_lshrrev_b32 v145, 16, v145
    v_mul_u32_u24 v146, 20, v145
    v_sub_u32 v146, v144, v146
    v_lshlrev_b32 v145, 14, v145
    v_add_u32 v145, s37, v145
    v_bfe_u32 v147, v146, 2, 2
    v_xor_b32 v147, v147, v142
    v_lshlrev_b32 v147, 4, v147
    v_lshl_add_u32 v147, v146, 6, v147
    v_add_u32 v147, v147, v145
    v_xor_b32 v148, 32, v147
    v_add_u32 v149, 12, v146
    v_bfe_u32 v150, v149, 2, 2
    v_xor_b32 v150, v150, v142
    v_lshlrev_b32 v150, 4, v150
    v_lshl_add_u32 v150, v149, 6, v150
    v_add_u32 v150, v150, v145
    v_xor_b32 v151, 32, v150
    v_cmp_eq_u32 vcc, 8, v146
    v_mov_b32 v152, 0x3f803f80
    s_nop 0
    v_cndmask_b32 v156, 0, v152, vcc
    v_mov_b32 v157, v156
    v_mov_b32 v158, v156
    v_mov_b32 v159, v156
    v_cmp_le_u32 s[52:53], 8, v146
    v_cvt_pk_bf16_f32 v152, v48, v49
    v_cvt_pk_bf16_f32 v153, v50, v51
    v_cvt_pk_bf16_f32 v154, v52, v53
    v_cvt_pk_bf16_f32 v155, v54, v55
    ds_write_b128 v147, v[152:155]
    s_nop 1
    v_cvt_pk_bf16_f32 v152, v56, v57
    v_cvt_pk_bf16_f32 v153, v58, v59
    v_cvt_pk_bf16_f32 v154, v60, v61
    v_cvt_pk_bf16_f32 v155, v62, v63
    ds_write_b128 v148, v[152:155]
    s_nop 1
    s_mov_b64 s[54:55], exec
    s_and_b64 exec, exec, s[52:53]
    ds_write_b128 v150, v[156:159]
    ds_write_b128 v151, v[156:159]
    s_mov_b64 exec, s[54:55]
    s_nop 1
    v_add_u32 v144, 128, v143
    v_mul_lo_u32 v145, v144, s39
    v_lshrrev_b32 v145, 16, v145
    v_mul_u32_u24 v146, 20, v145
    v_sub_u32 v146, v144, v146
    v_lshlrev_b32 v145, 14, v145
    v_add_u32 v145, s37, v145
    v_bfe_u32 v147, v146, 2, 2
    v_xor_b32 v147, v147, v142
    v_lshlrev_b32 v147, 4, v147
    v_lshl_add_u32 v147, v146, 6, v147
    v_add_u32 v147, v147, v145
    v_xor_b32 v148, 32, v147
    v_add_u32 v149, 12, v146
    v_bfe_u32 v150, v149, 2, 2
    v_xor_b32 v150, v150, v142
    v_lshlrev_b32 v150, 4, v150
    v_lshl_add_u32 v150, v149, 6, v150
    v_add_u32 v150, v150, v145
    v_xor_b32 v151, 32, v150
    v_cmp_eq_u32 vcc, 8, v146
    v_mov_b32 v152, 0x3f803f80
    s_nop 0
    v_cndmask_b32 v156, 0, v152, vcc
    v_mov_b32 v157, v156
    v_mov_b32 v158, v156
    v_mov_b32 v159, v156
    v_cmp_le_u32 s[52:53], 8, v146
    v_cvt_pk_bf16_f32 v152, v64, v65
    v_cvt_pk_bf16_f32 v153, v66, v67
    v_cvt_pk_bf16_f32 v154, v68, v69
    v_cvt_pk_bf16_f32 v155, v70, v71
    ds_write_b128 v147, v[152:155]
    s_nop 1
    v_cvt_pk_bf16_f32 v152, v72, v73
    v_cvt_pk_bf16_f32 v153, v74, v75
    v_cvt_pk_bf16_f32 v154, v76, v77
    v_cvt_pk_bf16_f32 v155, v78, v79
    ds_write_b128 v148, v[152:155]
    s_nop 1
    s_mov_b64 s[54:55], exec
    s_and_b64 exec, exec, s[52:53]
    ds_write_b128 v150, v[156:159]
    ds_write_b128 v151, v[156:159]
    s_mov_b64 exec, s[54:55]
    s_nop 1
G1_copyout:
    s_add_u32 s44, s6, s38
    s_addc_u32 s45, s7, 0
    s_mov_b32 s46, 4194304
    s_mov_b32 s47, 0x00020000
    v_lshlrev_b32 v142, 4, v138
    v_add_u32 v144, 0x10000, v142
    s_and_b32 s37, s35, 3
    s_lshl_b32 s37, s37, 20
    s_lshl_b32 s39, s36, 6
    s_add_u32 s37, s37, s39
    v_add_u32 v143, s37, v142
    s_waitcnt lgkmcnt(0)
    s_barrier
    ds_read_b128 v[0:3], v142 offset:0
    ds_read_b128 v[4:7], v142 offset:8192
    ds_read_b128 v[8:11], v142 offset:16384
    ds_read_b128 v[12:15], v142 offset:24576
    ds_read_b128 v[16:19], v142 offset:32768
    ds_read_b128 v[20:23], v142 offset:40960
    ds_read_b128 v[24:27], v142 offset:49152
    ds_read_b128 v[28:31], v142 offset:57344
    ds_read_b128 v[32:35], v144 offset:0
    ds_read_b128 v[36:39], v144 offset:8192
    ds_read_b128 v[40:43], v144 offset:16384
    ds_read_b128 v[44:47], v144 offset:24576
    ds_read_b128 v[48:51], v144 offset:32768
    ds_read_b128 v[52:55], v144 offset:40960
    ds_read_b128 v[56:59], v144 offset:49152
    ds_read_b128 v[60:63], v144 offset:57344
    s_mov_b32 s39, 0
    s_waitcnt lgkmcnt(15)
    buffer_store_dwordx4 v[0:3], v143, s[44:47], s39 offen
    s_mov_b32 s39, 8192
    s_waitcnt lgkmcnt(14)
    buffer_store_dwordx4 v[4:7], v143, s[44:47], s39 offen
    s_mov_b32 s39, 131072
    s_waitcnt lgkmcnt(13)
    buffer_store_dwordx4 v[8:11], v143, s[44:47], s39 offen
    s_mov_b32 s39, 139264
    s_waitcnt lgkmcnt(12)
    buffer_store_dwordx4 v[12:15], v143, s[44:47], s39 offen
    s_mov_b32 s39, 262144
    s_waitcnt lgkmcnt(11)
    buffer_store_dwordx4 v[16:19], v143, s[44:47], s39 offen
    s_mov_b32 s39, 270336
    s_waitcnt lgkmcnt(10)
    buffer_store_dwordx4 v[20:23], v143, s[44:47], s39 offen
    s_mov_b32 s39, 393216
    s_waitcnt lgkmcnt(9)
    buffer_store_dwordx4 v[24:27], v143, s[44:47], s39 offen
    s_mov_b32 s39, 401408
    s_waitcnt lgkmcnt(8)
    buffer_store_dwordx4 v[28:31], v143, s[44:47], s39 offen
    s_mov_b32 s39, 524288
    s_waitcnt lgkmcnt(7)
    buffer_store_dwordx4 v[32:35], v143, s[44:47], s39 offen
    s_mov_b32 s39, 532480
    s_waitcnt lgkmcnt(6)
    buffer_store_dwordx4 v[36:39], v143, s[44:47], s39 offen
    s_mov_b32 s39, 655360
    s_waitcnt lgkmcnt(5)
    buffer_store_dwordx4 v[40:43], v143, s[44:47], s39 offen
    s_mov_b32 s39, 663552
    s_waitcnt lgkmcnt(4)
    buffer_store_dwordx4 v[44:47], v143, s[44:47], s39 offen
    s_mov_b32 s39, 786432
    s_waitcnt lgkmcnt(3)
    buffer_store_dwordx4 v[48:51], v143, s[44:47], s39 offen
    s_mov_b32 s39, 794624
    s_waitcnt lgkmcnt(2)
    buffer_store_dwordx4 v[52:55], v143, s[44:47], s39 offen
    s_mov_b32 s39, 917504
    s_waitcnt lgkmcnt(1)
    buffer_store_dwordx4 v[56:59], v143, s[44:47], s39 offen
    s_mov_b32 s39, 925696
    s_waitcnt lgkmcnt(0)
    buffer_store_dwordx4 v[60:63], v143, s[44:47], s39 offen
    s_branch G1_done
G1_glu:
    s_sub_u32 s35, s35, 12
    s_mul_i32 s37, s35, 192
    v_mov_b32 v106, v0
    v_and_b32 v108, 63, v0
    v_lshrrev_b32 v109, 6, v0
    s_nop 0
    v_readfirstlane_b32 s30, v109
    s_waitcnt lgkmcnt(0)
    s_lshl_b32 s33, s30, 4
    s_add_u32 s33, s33, s36
    v_lshrrev_b32 v110, 2, v108
    v_add_u32 v110, s33, v110
    v_mul_u32_u24 v110, 1280, v110
    v_and_b32 v111, 3, v108
    v_bfe_u32 v112, v108, 4, 2
    v_xor_b32 v111, v111, v112
    v_lshl_add_u32 v110, v111, 4, v110
    v_mov_b32 v101, s7
    v_add_co_u32 v100, vcc, s6, v110
    s_nop 1
    v_addc_co_u32 v101, vcc, 0, v101, vcc
    s_lshl_b32 s24, s30, 10
    s_mov_b32 s40, 64
    s_mov_b32 s41, 0
    s_mov_b32 s44, 110592
    s_mov_b32 s45, 0
    s_cmp_lt_u32 s30, 4
    s_cbranch_scc0 G1_x1_3
    s_add_u32 s25, s30, 12
    s_lshl_b32 s33, s25, 4
    s_add_u32 s33, s33, s36
    v_lshrrev_b32 v110, 2, v108
    v_add_u32 v110, s33, v110
    v_mul_u32_u24 v110, 1280, v110
    v_and_b32 v111, 3, v108
    v_bfe_u32 v112, v108, 4, 2
    v_xor_b32 v111, v111, v112
    v_lshl_add_u32 v110, v111, 4, v110
    v_mov_b32 v103, s7
    v_add_co_u32 v102, vcc, s6, v110
    s_nop 1
    v_addc_co_u32 v103, vcc, 0, v103, vcc
    s_lshl_b32 s25, s25, 10
    s_mov_b32 s42, 64
    s_branch G1_x2_4
G1_x1_3:
    s_sub_u32 s25, s30, 4
    s_lshl_b32 s33, s25, 6
    v_add_u32 v113, s33, v108
    s_movk_i32 s33, 2731
    v_mul_lo_u32 v110, v113, s33
    v_lshrrev_b32 v110, 16, v110
    v_mul_u32_u24 v111, 24, v110
    v_sub_u32 v113, v113, v111
    v_lshrrev_b32 v111, 2, v113
    v_bfe_u32 v112, v110, 1, 1
    v_xor_b32 v111, v111, v112
    v_and_b32 v113, 3, v113
    v_mul_u32_u24 v110, 3456, v110
    v_lshl_add_u32 v110, v113, 4, v110
    v_lshrrev_b32 v112, 1, v111
    v_lshl_add_u32 v110, v112, 6, v110
    v_add_u32 v110, s37, v110
    v_and_b32 v111, 1, v111
    v_cmp_eq_u32 vcc, 1, v111
    v_mov_b32 v112, s8
    v_mov_b32 v113, s9
    v_mov_b32 v114, s10
    v_mov_b32 v115, s11
    v_cndmask_b32 v112, v112, v114, vcc
    v_cndmask_b32 v113, v113, v115, vcc
    v_add_co_u32 v102, vcc, v112, v110
    s_nop 1
    v_addc_co_u32 v103, vcc, 0, v113, vcc
    s_lshl_b32 s25, s25, 10
    s_add_u32 s25, s25, 16384
    s_mov_b32 s42, 110592
G1_x2_4:
    s_mov_b32 s43, 0
    s_add_u32 s26, s30, 8
    s_min_u32 s26, s26, 11
    s_lshl_b32 s33, s26, 6
    v_add_u32 v113, s33, v108
    s_movk_i32 s33, 2731
    v_mul_lo_u32 v110, v113, s33
    v_lshrrev_b32 v110, 16, v110
    v_mul_u32_u24 v111, 24, v110
    v_sub_u32 v113, v113, v111
    v_lshrrev_b32 v111, 2, v113
    v_bfe_u32 v112, v110, 1, 1
    v_xor_b32 v111, v111, v112
    v_and_b32 v113, 3, v113
    v_mul_u32_u24 v110, 3456, v110
    v_lshl_add_u32 v110, v113, 4, v110
    v_lshrrev_b32 v112, 1, v111
    v_lshl_add_u32 v110, v112, 6, v110
    v_add_u32 v110, s37, v110
    v_and_b32 v111, 1, v111
    v_cmp_eq_u32 vcc, 1, v111
    v_mov_b32 v112, s8
    v_mov_b32 v113, s9
    v_mov_b32 v114, s10
    v_mov_b32 v115, s11
    v_cndmask_b32 v112, v112, v114, vcc
    v_cndmask_b32 v113, v113, v115, vcc
    v_add_co_u32 v104, vcc, v112, v110
    s_nop 1
    v_addc_co_u32 v105, vcc, 0, v113, vcc
    s_lshl_b32 s26, s26, 10
    s_add_u32 s26, s26, 16384
    s_add_u32 m0, s24, 0
    s_nop 0
    global_load_lds_dwordx4 v[100:101], off
    v_lshl_add_u64 v[100:101], v[100:101], 0, s[40:41]
    s_add_u32 m0, s25, 0
    s_nop 0
    global_load_lds_dwordx4 v[102:103], off
    v_lshl_add_u64 v[102:103], v[102:103], 0, s[42:43]
    s_add_u32 m0, s26, 0
    s_nop 0
    global_load_lds_dwordx4 v[104:105], off
    v_lshl_add_u64 v[104:105], v[104:105], 0, s[44:45]
    s_add_u32 m0, s24, 28672
    s_nop 0
    global_load_lds_dwordx4 v[100:101], off
    v_lshl_add_u64 v[100:101], v[100:101], 0, s[40:41]
    s_add_u32 m0, s25, 28672
    s_nop 0
    global_load_lds_dwordx4 v[102:103], off
    v_lshl_add_u64 v[102:103], v[102:103], 0, s[42:43]
    s_add_u32 m0, s26, 28672
    s_nop 0
    global_load_lds_dwordx4 v[104:105], off
    v_lshl_add_u64 v[104:105], v[104:105], 0, s[44:45]
    s_add_u32 m0, s24, 57344
    s_nop 0
    global_load_lds_dwordx4 v[100:101], off
    v_lshl_add_u64 v[100:101], v[100:101], 0, s[40:41]
    s_add_u32 m0, s25, 57344
    s_nop 0
    global_load_lds_dwordx4 v[102:103], off
    v_lshl_add_u64 v[102:103], v[102:103], 0, s[42:43]
    s_add_u32 m0, s26, 57344
    s_nop 0
    global_load_lds_dwordx4 v[104:105], off
    v_lshl_add_u64 v[104:105], v[104:105], 0, s[44:45]
    s_add_u32 m0, s24, 86016
    s_nop 0
    global_load_lds_dwordx4 v[100:101], off
    v_lshl_add_u64 v[100:101], v[100:101], 0, s[40:41]
    s_add_u32 m0, s25, 86016
    s_nop 0
    global_load_lds_dwordx4 v[102:103], off
    v_lshl_add_u64 v[102:103], v[102:103], 0, s[42:43]
    s_add_u32 m0, s26, 86016
    s_nop 0
    global_load_lds_dwordx4 v[104:105], off
    v_lshl_add_u64 v[104:105], v[104:105], 0, s[44:45]
    s_and_b32 s31, s30, 3
    s_lshr_b32 s32, s30, 2
    v_and_b32 v110, 31, v108
    s_mul_i32 s33, s31, 64
    v_add_u32 v110, s33, v110
    v_lshrrev_b32 v111, 5, v108
    v_bfe_u32 v112, v108, 2, 2
    v_xor_b32 v111, v111, v112
    v_lshlrev_b32 v111, 4, v111
    v_lshl_add_u32 v96, v110, 6, v111
    v_xor_b32 v97, 32, v96
    v_lshrrev_b32 v110, 5, v108
    v_lshlrev_b32 v110, 3, v110
    v_bfe_u32 v111, v108, 2, 2
    v_add_u32 v110, v110, v111
    v_mul_u32_u24 v110, 384, v110
    v_lshrrev_b32 v111, 1, v111
    s_lshl_b32 s33, s32, 1
    v_xor_b32 v111, s33, v111
    v_lshl_add_u32 v110, v111, 6, v110
    v_bfe_u32 v111, v108, 4, 1
    v_lshl_add_u32 v110, v111, 5, v110
    v_and_b32 v111, 3, v108
    v_lshl_add_u32 v110, v111, 3, v110
    v_add_u32 v98, 16384, v110
    v_xor_b32 v99, 64, v98
    v_mov_b32 v0, 0
    v_mov_b32 v1, 0
    v_mov_b32 v2, 0
    v_mov_b32 v3, 0
    v_mov_b32 v4, 0
    v_mov_b32 v5, 0
    v_mov_b32 v6, 0
    v_mov_b32 v7, 0
    v_mov_b32 v8, 0
    v_mov_b32 v9, 0
    v_mov_b32 v10, 0
    v_mov_b32 v11, 0
    v_mov_b32 v12, 0
    v_mov_b32 v13, 0
    v_mov_b32 v14, 0
    v_mov_b32 v15, 0
    v_mov_b32 v16, 0
    v_mov_b32 v17, 0
    v_mov_b32 v18, 0
    v_mov_b32 v19, 0
    v_mov_b32 v20, 0
    v_mov_b32 v21, 0
    v_mov_b32 v22, 0
    v_mov_b32 v23, 0
    v_mov_b32 v24, 0
    v_mov_b32 v25, 0
    v_mov_b32 v26, 0
    v_mov_b32 v27, 0
    v_mov_b32 v28, 0
    v_mov_b32 v29, 0
    v_mov_b32 v30, 0
    v_mov_b32 v31, 0
    v_mov_b32 v32, 0
    v_mov_b32 v33, 0
    v_mov_b32 v34, 0
    v_mov_b32 v35, 0
    v_mov_b32 v36, 0
    v_mov_b32 v37, 0
    v_mov_b32 v38, 0
    v_mov_b32 v39, 0
    v_mov_b32 v40, 0
    v_mov_b32 v41, 0
    v_mov_b32 v42, 0
    v_mov_b32 v43, 0
    v_mov_b32 v44, 0
    v_mov_b32 v45, 0
    v_mov_b32 v46, 0
    v_mov_b32 v47, 0
    v_mov_b32 v48, 0
    v_mov_b32 v49, 0
    v_mov_b32 v50, 0
    v_mov_b32 v51, 0
    v_mov_b32 v52, 0
    v_mov_b32 v53, 0
    v_mov_b32 v54, 0
    v_mov_b32 v55, 0
    v_mov_b32 v56, 0
    v_mov_b32 v57, 0
    v_mov_b32 v58, 0
    v_mov_b32 v59, 0
    v_mov_b32 v60, 0
    v_mov_b32 v61, 0
    v_mov_b32 v62, 0
    v_mov_b32 v63, 0
    s_waitcnt vmcnt(9)
    s_barrier
    ds_read_b128 v[64:67], v96 offset:0
    ds_read_b128 v[68:71], v96 offset:2048
    ds_read_b64_tr_b16 v[80:81], v98 offset:0
    ds_read_b64_tr_b16 v[82:83], v98 offset:1536
    ds_read_b64_tr_b16 v[84:85], v99 offset:0
    ds_read_b64_tr_b16 v[86:87], v99 offset:1536
    ds_read_b128 v[72:75], v97 offset:0
    ds_read_b128 v[76:79], v97 offset:2048
    ds_read_b64_tr_b16 v[88:89], v98 offset:6144
    ds_read_b64_tr_b16 v[90:91], v98 offset:7680
    ds_read_b64_tr_b16 v[92:93], v99 offset:6144
    ds_read_b64_tr_b16 v[94:95], v99 offset:7680
    s_add_u32 m0, s24, 114688
    s_nop 0
    global_load_lds_dwordx4 v[100:101], off
    v_lshl_add_u64 v[100:101], v[100:101], 0, s[40:41]
    s_add_u32 m0, s25, 114688
    s_nop 0
    global_load_lds_dwordx4 v[102:103], off
    v_lshl_add_u64 v[102:103], v[102:103], 0, s[42:43]
    s_add_u32 m0, s26, 114688
    s_nop 0
    global_load_lds_dwordx4 v[104:105], off
    v_lshl_add_u64 v[104:105], v[104:105], 0, s[44:45]
    s_waitcnt lgkmcnt(6)
    v_mfma_f32_32x32x16_bf16 v[0:15], v[80:83], v[64:67], v[0:15]
    v_mfma_f32_32x32x16_bf16 v[16:31], v[84:87], v[64:67], v[16:31]
    v_mfma_f32_32x32x16_bf16 v[32:47], v[80:83], v[68:71], v[32:47]
    v_mfma_f32_32x32x16_bf16 v[48:63], v[84:87], v[68:71], v[48:63]
    s_waitcnt lgkmcnt(0)
    v_mfma_f32_32x32x16_bf16 v[0:15], v[88:91], v[72:75], v[0:15]
    v_mfma_f32_32x32x16_bf16 v[16:31], v[92:95], v[72:75], v[16:31]
    v_mfma_f32_32x32x16_bf16 v[32:47], v[88:91], v[76:79], v[32:47]
    v_mfma_f32_32x32x16_bf16 v[48:63], v[92:95], v[76:79], v[48:63]
    s_waitcnt vmcnt(9)
    s_barrier
    ds_read_b128 v[64:67], v96 offset:28672
    ds_read_b128 v[68:71], v96 offset:30720
    ds_read_b64_tr_b16 v[80:81], v98 offset:28672
    ds_read_b64_tr_b16 v[82:83], v98 offset:30208
    ds_read_b64_tr_b16 v[84:85], v99 offset:28672
    ds_read_b64_tr_b16 v[86:87], v99 offset:30208
    ds_read_b128 v[72:75], v97 offset:28672
    ds_read_b128 v[76:79], v97 offset:30720
    ds_read_b64_tr_b16 v[88:89], v98 offset:34816
    ds_read_b64_tr_b16 v[90:91], v98 offset:36352
    ds_read_b64_tr_b16 v[92:93], v99 offset:34816
    ds_read_b64_tr_b16 v[94:95], v99 offset:36352
    s_add_u32 m0, s24, 0
    s_nop 0
    global_load_lds_dwordx4 v[100:101], off
    v_lshl_add_u64 v[100:101], v[100:101], 0, s[40:41]
    s_add_u32 m0, s25, 0
    s_nop 0
    global_load_lds_dwordx4 v[102:103], off
    v_lshl_add_u64 v[102:103], v[102:103], 0, s[42:43]
    s_add_u32 m0, s26, 0
    s_nop 0
    global_load_lds_dwordx4 v[104:105], off
    v_lshl_add_u64 v[104:105], v[104:105], 0, s[44:45]
    s_waitcnt lgkmcnt(6)
    v_mfma_f32_32x32x16_bf16 v[0:15], v[80:83], v[64:67], v[0:15]
    v_mfma_f32_32x32x16_bf16 v[16:31], v[84:87], v[64:67], v[16:31]
    v_mfma_f32_32x32x16_bf16 v[32:47], v[80:83], v[68:71], v[32:47]
    v_mfma_f32_32x32x16_bf16 v[48:63], v[84:87], v[68:71], v[48:63]
    s_waitcnt lgkmcnt(0)
    v_mfma_f32_32x32x16_bf16 v[0:15], v[88:91], v[72:75], v[0:15]
    v_mfma_f32_32x32x16_bf16 v[16:31], v[92:95], v[72:75], v[16:31]
    v_mfma_f32_32x32x16_bf16 v[32:47], v[88:91], v[76:79], v[32:47]
    v_mfma_f32_32x32x16_bf16 v[48:63], v[92:95], v[76:79], v[48:63]
    v_add_u32 v124, 57344, v96
    v_add_u32 v126, 57344, v98
    v_add_u32 v125, 57344, v97
    v_add_u32 v127, 57344, v99
    s_waitcnt vmcnt(9)
    s_barrier
    ds_read_b128 v[64:67], v124 offset:0
    ds_read_b128 v[68:71], v124 offset:2048
    ds_read_b64_tr_b16 v[80:81], v126 offset:0
    ds_read_b64_tr_b16 v[82:83], v126 offset:1536
    ds_read_b64_tr_b16 v[84:85], v127 offset:0
    ds_read_b64_tr_b16 v[86:87], v127 offset:1536
    ds_read_b128 v[72:75], v125 offset:0
    ds_read_b128 v[76:79], v125 offset:2048
    ds_read_b64_tr_b16 v[88:89], v126 offset:6144
    ds_read_b64_tr_b16 v[90:91], v126 offset:7680
    ds_read_b64_tr_b16 v[92:93], v127 offset:6144
    ds_read_b64_tr_b16 v[94:95], v127 offset:7680
    s_add_u32 m0, s24, 28672
    s_nop 0
    global_load_lds_dwordx4 v[100:101], off
    v_lshl_add_u64 v[100:101], v[100:101], 0, s[40:41]
    s_add_u32 m0, s25, 28672
    s_nop 0
    global_load_lds_dwordx4 v[102:103], off
    v_lshl_add_u64 v[102:103], v[102:103], 0, s[42:43]
    s_add_u32 m0, s26, 28672
    s_nop 0
    global_load_lds_dwordx4 v[104:105], off
    v_lshl_add_u64 v[104:105], v[104:105], 0, s[44:45]
    s_waitcnt lgkmcnt(6)
    v_mfma_f32_32x32x16_bf16 v[0:15], v[80:83], v[64:67], v[0:15]
    v_mfma_f32_32x32x16_bf16 v[16:31], v[84:87], v[64:67], v[16:31]
    v_mfma_f32_32x32x16_bf16 v[32:47], v[80:83], v[68:71], v[32:47]
    v_mfma_f32_32x32x16_bf16 v[48:63], v[84:87], v[68:71], v[48:63]
    s_waitcnt lgkmcnt(0)
    v_mfma_f32_32x32x16_bf16 v[0:15], v[88:91], v[72:75], v[0:15]
    v_mfma_f32_32x32x16_bf16 v[16:31], v[92:95], v[72:75], v[16:31]
    v_mfma_f32_32x32x16_bf16 v[32:47], v[88:91], v[76:79], v[32:47]
    v_mfma_f32_32x32x16_bf16 v[48:63], v[92:95], v[76:79], v[48:63]
    v_add_u32 v124, 57344, v96
    v_add_u32 v126, 57344, v98
    v_add_u32 v125, 57344, v97
    v_add_u32 v127, 57344, v99
    s_waitcnt vmcnt(9)
    s_barrier
    ds_read_b128 v[64:67], v124 offset:28672
    ds_read_b128 v[68:71], v124 offset:30720
    ds_read_b64_tr_b16 v[80:81], v126 offset:28672
    ds_read_b64_tr_b16 v[82:83], v126 offset:30208
    ds_read_b64_tr_b16 v[84:85], v127 offset:28672
    ds_read_b64_tr_b16 v[86:87], v127 offset:30208
    ds_read_b128 v[72:75], v125 offset:28672
    ds_read_b128 v[76:79], v125 offset:30720
    ds_read_b64_tr_b16 v[88:89], v126 offset:34816
    ds_read_b64_tr_b16 v[90:91], v126 offset:36352
    ds_read_b64_tr_b16 v[92:93], v127 offset:34816
    ds_read_b64_tr_b16 v[94:95], v127 offset:36352
    s_add_u32 m0, s24, 57344
    s_nop 0
    global_load_lds_dwordx4 v[100:101], off
    v_lshl_add_u64 v[100:101], v[100:101], 0, s[40:41]
    s_add_u32 m0, s25, 57344
    s_nop 0
    global_load_lds_dwordx4 v[102:103], off
    v_lshl_add_u64 v[102:103], v[102:103], 0, s[42:43]
    s_add_u32 m0, s26, 57344
    s_nop 0
    global_load_lds_dwordx4 v[104:105], off
    v_lshl_add_u64 v[104:105], v[104:105], 0, s[44:45]
    s_waitcnt lgkmcnt(6)
    v_mfma_f32_32x32x16_bf16 v[0:15], v[80:83], v[64:67], v[0:15]
    v_mfma_f32_32x32x16_bf16 v[16:31], v[84:87], v[64:67], v[16:31]
    v_mfma_f32_32x32x16_bf16 v[32:47], v[80:83], v[68:71], v[32:47]
    v_mfma_f32_32x32x16_bf16 v[48:63], v[84:87], v[68:71], v[48:63]
    s_waitcnt lgkmcnt(0)
    v_mfma_f32_32x32x16_bf16 v[0:15], v[88:91], v[72:75], v[0:15]
    v_mfma_f32_32x32x16_bf16 v[16:31], v[92:95], v[72:75], v[16:31]
    v_mfma_f32_32x32x16_bf16 v[32:47], v[88:91], v[76:79], v[32:47]
    v_mfma_f32_32x32x16_bf16 v[48:63], v[92:95], v[76:79], v[48:63]
    v_add_u32 v124, 114688, v96
    v_add_u32 v126, 114688, v98
    v_add_u32 v125, 114688, v97
    v_add_u32 v127, 114688, v99
    s_waitcnt vmcnt(9)
    s_barrier
    ds_read_b128 v[64:67], v124 offset:0
    ds_read_b128 v[68:71], v124 offset:2048
    ds_read_b64_tr_b16 v[80:81], v126 offset:0
    ds_read_b64_tr_b16 v[82:83], v126 offset:1536
    ds_read_b64_tr_b16 v[84:85], v127 offset:0
    ds_read_b64_tr_b16 v[86:87], v127 offset:1536
    ds_read_b128 v[72:75], v125 offset:0
    ds_read_b128 v[76:79], v125 offset:2048
    ds_read_b64_tr_b16 v[88:89], v126 offset:6144
    ds_read_b64_tr_b16 v[90:91], v126 offset:7680
    ds_read_b64_tr_b16 v[92:93], v127 offset:6144
    ds_read_b64_tr_b16 v[94:95], v127 offset:7680
    s_add_u32 m0, s24, 86016
    s_nop 0
    global_load_lds_dwordx4 v[100:101], off
    v_lshl_add_u64 v[100:101], v[100:101], 0, s[40:41]
    s_add_u32 m0, s25, 86016
    s_nop 0
    global_load_lds_dwordx4 v[102:103], off
    v_lshl_add_u64 v[102:103], v[102:103], 0, s[42:43]
    s_add_u32 m0, s26, 86016
    s_nop 0
    global_load_lds_dwordx4 v[104:105], off
    v_lshl_add_u64 v[104:105], v[104:105], 0, s[44:45]
    s_waitcnt lgkmcnt(6)
    v_mfma_f32_32x32x16_bf16 v[0:15], v[80:83], v[64:67], v[0:15]
    v_mfma_f32_32x32x16_bf16 v[16:31], v[84:87], v[64:67], v[16:31]
    v_mfma_f32_32x32x16_bf16 v[32:47], v[80:83], v[68:71], v[32:47]
    v_mfma_f32_32x32x16_bf16 v[48:63], v[84:87], v[68:71], v[48:63]
    s_waitcnt lgkmcnt(0)
    v_mfma_f32_32x32x16_bf16 v[0:15], v[88:91], v[72:75], v[0:15]
    v_mfma_f32_32x32x16_bf16 v[16:31], v[92:95], v[72:75], v[16:31]
    v_mfma_f32_32x32x16_bf16 v[32:47], v[88:91], v[76:79], v[32:47]
    v_mfma_f32_32x32x16_bf16 v[48:63], v[92:95], v[76:79], v[48:63]
    s_waitcnt vmcnt(9)
    s_barrier
    ds_read_b128 v[64:67], v96 offset:0
    ds_read_b128 v[68:71], v96 offset:2048
    ds_read_b64_tr_b16 v[80:81], v98 offset:0
    ds_read_b64_tr_b16 v[82:83], v98 offset:1536
    ds_read_b64_tr_b16 v[84:85], v99 offset:0
    ds_read_b64_tr_b16 v[86:87], v99 offset:1536
    ds_read_b128 v[72:75], v97 offset:0
    ds_read_b128 v[76:79], v97 offset:2048
    ds_read_b64_tr_b16 v[88:89], v98 offset:6144
    ds_read_b64_tr_b16 v[90:91], v98 offset:7680
    ds_read_b64_tr_b16 v[92:93], v99 offset:6144
    ds_read_b64_tr_b16 v[94:95], v99 offset:7680
    s_add_u32 m0, s24, 114688
    s_nop 0
    global_load_lds_dwordx4 v[100:101], off
    v_lshl_add_u64 v[100:101], v[100:101], 0, s[40:41]
    s_add_u32 m0, s25, 114688
    s_nop 0
    global_load_lds_dwordx4 v[102:103], off
    v_lshl_add_u64 v[102:103], v[102:103], 0, s[42:43]
    s_add_u32 m0, s26, 114688
    s_nop 0
    global_load_lds_dwordx4 v[104:105], off
    v_lshl_add_u64 v[104:105], v[104:105], 0, s[44:45]
    s_waitcnt lgkmcnt(6)
    v_mfma_f32_32x32x16_bf16 v[0:15], v[80:83], v[64:67], v[0:15]
    v_mfma_f32_32x32x16_bf16 v[16:31], v[84:87], v[64:67], v[16:31]
    v_mfma_f32_32x32x16_bf16 v[32:47], v[80:83], v[68:71], v[32:47]
    v_mfma_f32_32x32x16_bf16 v[48:63], v[84:87], v[68:71], v[48:63]
    s_waitcnt lgkmcnt(0)
    v_mfma_f32_32x32x16_bf16 v[0:15], v[88:91], v[72:75], v[0:15]
    v_mfma_f32_32x32x16_bf16 v[16:31], v[92:95], v[72:75], v[16:31]
    v_mfma_f32_32x32x16_bf16 v[32:47], v[88:91], v[76:79], v[32:47]
    v_mfma_f32_32x32x16_bf16 v[48:63], v[92:95], v[76:79], v[48:63]
    s_waitcnt vmcnt(9)
    s_barrier
    ds_read_b128 v[64:67], v96 offset:28672
    ds_read_b128 v[68:71], v96 offset:30720
    ds_read_b64_tr_b16 v[80:81], v98 offset:28672
    ds_read_b64_tr_b16 v[82:83], v98 offset:30208
    ds_read_b64_tr_b16 v[84:85], v99 offset:28672
    ds_read_b64_tr_b16 v[86:87], v99 offset:30208
    ds_read_b128 v[72:75], v97 offset:28672
    ds_read_b128 v[76:79], v97 offset:30720
    ds_read_b64_tr_b16 v[88:89], v98 offset:34816
    ds_read_b64_tr_b16 v[90:91], v98 offset:36352
    ds_read_b64_tr_b16 v[92:93], v99 offset:34816
    ds_read_b64_tr_b16 v[94:95], v99 offset:36352
    s_add_u32 m0, s24, 0
    s_nop 0
    global_load_lds_dwordx4 v[100:101], off
    v_lshl_add_u64 v[100:101], v[100:101], 0, s[40:41]
    s_add_u32 m0, s25, 0
    s_nop 0
    global_load_lds_dwordx4 v[102:103], off
    v_lshl_add_u64 v[102:103], v[102:103], 0, s[42:43]
    s_add_u32 m0, s26, 0
    s_nop 0
    global_load_lds_dwordx4 v[104:105], off
    v_lshl_add_u64 v[104:105], v[104:105], 0, s[44:45]
    s_waitcnt lgkmcnt(6)
    v_mfma_f32_32x32x16_bf16 v[0:15], v[80:83], v[64:67], v[0:15]
    v_mfma_f32_32x32x16_bf16 v[16:31], v[84:87], v[64:67], v[16:31]
    v_mfma_f32_32x32x16_bf16 v[32:47], v[80:83], v[68:71], v[32:47]
    v_mfma_f32_32x32x16_bf16 v[48:63], v[84:87], v[68:71], v[48:63]
    s_waitcnt lgkmcnt(0)
    v_mfma_f32_32x32x16_bf16 v[0:15], v[88:91], v[72:75], v[0:15]
    v_mfma_f32_32x32x16_bf16 v[16:31], v[92:95], v[72:75], v[16:31]
    v_mfma_f32_32x32x16_bf16 v[32:47], v[88:91], v[76:79], v[32:47]
    v_mfma_f32_32x32x16_bf16 v[48:63], v[92:95], v[76:79], v[48:63]
    v_add_u32 v124, 57344, v96
    v_add_u32 v126, 57344, v98
    v_add_u32 v125, 57344, v97
    v_add_u32 v127, 57344, v99
    s_waitcnt vmcnt(9)
    s_barrier
    ds_read_b128 v[64:67], v124 offset:0
    ds_read_b128 v[68:71], v124 offset:2048
    ds_read_b64_tr_b16 v[80:81], v126 offset:0
    ds_read_b64_tr_b16 v[82:83], v126 offset:1536
    ds_read_b64_tr_b16 v[84:85], v127 offset:0
    ds_read_b64_tr_b16 v[86:87], v127 offset:1536
    ds_read_b128 v[72:75], v125 offset:0
    ds_read_b128 v[76:79], v125 offset:2048
    ds_read_b64_tr_b16 v[88:89], v126 offset:6144
    ds_read_b64_tr_b16 v[90:91], v126 offset:7680
    ds_read_b64_tr_b16 v[92:93], v127 offset:6144
    ds_read_b64_tr_b16 v[94:95], v127 offset:7680
    s_add_u32 m0, s24, 28672
    s_nop 0
    global_load_lds_dwordx4 v[100:101], off
    v_lshl_add_u64 v[100:101], v[100:101], 0, s[40:41]
    s_add_u32 m0, s25, 28672
    s_nop 0
    global_load_lds_dwordx4 v[102:103], off
    v_lshl_add_u64 v[102:103], v[102:103], 0, s[42:43]
    s_add_u32 m0, s26, 28672
    s_nop 0
    global_load_lds_dwordx4 v[104:105], off
    v_lshl_add_u64 v[104:105], v[104:105], 0, s[44:45]
    s_waitcnt lgkmcnt(6)
    v_mfma_f32_32x32x16_bf16 v[0:15], v[80:83], v[64:67], v[0:15]
    v_mfma_f32_32x32x16_bf16 v[16:31], v[84:87], v[64:67], v[16:31]
    v_mfma_f32_32x32x16_bf16 v[32:47], v[80:83], v[68:71], v[32:47]
    v_mfma_f32_32x32x16_bf16 v[48:63], v[84:87], v[68:71], v[48:63]
    s_waitcnt lgkmcnt(0)
    v_mfma_f32_32x32x16_bf16 v[0:15], v[88:91], v[72:75], v[0:15]
    v_mfma_f32_32x32x16_bf16 v[16:31], v[92:95], v[72:75], v[16:31]
    v_mfma_f32_32x32x16_bf16 v[32:47], v[88:91], v[76:79], v[32:47]
    v_mfma_f32_32x32x16_bf16 v[48:63], v[92:95], v[76:79], v[48:63]
    v_add_u32 v124, 57344, v96
    v_add_u32 v126, 57344, v98
    v_add_u32 v125, 57344, v97
    v_add_u32 v127, 57344, v99
    s_waitcnt vmcnt(9)
    s_barrier
    ds_read_b128 v[64:67], v124 offset:28672
    ds_read_b128 v[68:71], v124 offset:30720
    ds_read_b64_tr_b16 v[80:81], v126 offset:28672
    ds_read_b64_tr_b16 v[82:83], v126 offset:30208
    ds_read_b64_tr_b16 v[84:85], v127 offset:28672
    ds_read_b64_tr_b16 v[86:87], v127 offset:30208
    ds_read_b128 v[72:75], v125 offset:28672
    ds_read_b128 v[76:79], v125 offset:30720
    ds_read_b64_tr_b16 v[88:89], v126 offset:34816
    ds_read_b64_tr_b16 v[90:91], v126 offset:36352
    ds_read_b64_tr_b16 v[92:93], v127 offset:34816
    ds_read_b64_tr_b16 v[94:95], v127 offset:36352
    s_add_u32 m0, s24, 57344
    s_nop 0
    global_load_lds_dwordx4 v[100:101], off
    v_lshl_add_u64 v[100:101], v[100:101], 0, s[40:41]
    s_add_u32 m0, s25, 57344
    s_nop 0
    global_load_lds_dwordx4 v[102:103], off
    v_lshl_add_u64 v[102:103], v[102:103], 0, s[42:43]
    s_add_u32 m0, s26, 57344
    s_nop 0
    global_load_lds_dwordx4 v[104:105], off
    v_lshl_add_u64 v[104:105], v[104:105], 0, s[44:45]
    s_waitcnt lgkmcnt(6)
    v_mfma_f32_32x32x16_bf16 v[0:15], v[80:83], v[64:67], v[0:15]
    v_mfma_f32_32x32x16_bf16 v[16:31], v[84:87], v[64:67], v[16:31]
    v_mfma_f32_32x32x16_bf16 v[32:47], v[80:83], v[68:71], v[32:47]
    v_mfma_f32_32x32x16_bf16 v[48:63], v[84:87], v[68:71], v[48:63]
    s_waitcnt lgkmcnt(0)
    v_mfma_f32_32x32x16_bf16 v[0:15], v[88:91], v[72:75], v[0:15]
    v_mfma_f32_32x32x16_bf16 v[16:31], v[92:95], v[72:75], v[16:31]
    v_mfma_f32_32x32x16_bf16 v[32:47], v[88:91], v[76:79], v[32:47]
    v_mfma_f32_32x32x16_bf16 v[48:63], v[92:95], v[76:79], v[48:63]
    v_add_u32 v124, 114688, v96
    v_add_u32 v126, 114688, v98
    v_add_u32 v125, 114688, v97
    v_add_u32 v127, 114688, v99
    s_waitcnt vmcnt(9)
    s_barrier
    ds_read_b128 v[64:67], v124 offset:0
    ds_read_b128 v[68:71], v124 offset:2048
    ds_read_b64_tr_b16 v[80:81], v126 offset:0
    ds_read_b64_tr_b16 v[82:83], v126 offset:1536
    ds_read_b64_tr_b16 v[84:85], v127 offset:0
    ds_read_b64_tr_b16 v[86:87], v127 offset:1536
    ds_read_b128 v[72:75], v125 offset:0
    ds_read_b128 v[76:79], v125 offset:2048
    ds_read_b64_tr_b16 v[88:89], v126 offset:6144
    ds_read_b64_tr_b16 v[90:91], v126 offset:7680
    ds_read_b64_tr_b16 v[92:93], v127 offset:6144
    ds_read_b64_tr_b16 v[94:95], v127 offset:7680
    s_add_u32 m0, s24, 86016
    s_nop 0
    global_load_lds_dwordx4 v[100:101], off
    v_lshl_add_u64 v[100:101], v[100:101], 0, s[40:41]
    s_add_u32 m0, s25, 86016
    s_nop 0
    global_load_lds_dwordx4 v[102:103], off
    v_lshl_add_u64 v[102:103], v[102:103], 0, s[42:43]
    s_add_u32 m0, s26, 86016
    s_nop 0
    global_load_lds_dwordx4 v[104:105], off
    v_lshl_add_u64 v[104:105], v[104:105], 0, s[44:45]
    s_waitcnt lgkmcnt(6)
    v_mfma_f32_32x32x16_bf16 v[0:15], v[80:83], v[64:67], v[0:15]
    v_mfma_f32_32x32x16_bf16 v[16:31], v[84:87], v[64:67], v[16:31]
    v_mfma_f32_32x32x16_bf16 v[32:47], v[80:83], v[68:71], v[32:47]
    v_mfma_f32_32x32x16_bf16 v[48:63], v[84:87], v[68:71], v[48:63]
    s_waitcnt lgkmcnt(0)
    v_mfma_f32_32x32x16_bf16 v[0:15], v[88:91], v[72:75], v[0:15]
    v_mfma_f32_32x32x16_bf16 v[16:31], v[92:95], v[72:75], v[16:31]
    v_mfma_f32_32x32x16_bf16 v[32:47], v[88:91], v[76:79], v[32:47]
    v_mfma_f32_32x32x16_bf16 v[48:63], v[92:95], v[76:79], v[48:63]
    s_waitcnt vmcnt(9)
    s_barrier
    ds_read_b128 v[64:67], v96 offset:0
    ds_read_b128 v[68:71], v96 offset:2048
    ds_read_b64_tr_b16 v[80:81], v98 offset:0
    ds_read_b64_tr_b16 v[82:83], v98 offset:1536
    ds_read_b64_tr_b16 v[84:85], v99 offset:0
    ds_read_b64_tr_b16 v[86:87], v99 offset:1536
    ds_read_b128 v[72:75], v97 offset:0
    ds_read_b128 v[76:79], v97 offset:2048
    ds_read_b64_tr_b16 v[88:89], v98 offset:6144
    ds_read_b64_tr_b16 v[90:91], v98 offset:7680
    ds_read_b64_tr_b16 v[92:93], v99 offset:6144
    ds_read_b64_tr_b16 v[94:95], v99 offset:7680
    s_add_u32 m0, s24, 114688
    s_nop 0
    global_load_lds_dwordx4 v[100:101], off
    v_lshl_add_u64 v[100:101], v[100:101], 0, s[40:41]
    s_add_u32 m0, s25, 114688
    s_nop 0
    global_load_lds_dwordx4 v[102:103], off
    v_lshl_add_u64 v[102:103], v[102:103], 0, s[42:43]
    s_add_u32 m0, s26, 114688
    s_nop 0
    global_load_lds_dwordx4 v[104:105], off
    v_lshl_add_u64 v[104:105], v[104:105], 0, s[44:45]
    s_waitcnt lgkmcnt(6)
    v_mfma_f32_32x32x16_bf16 v[0:15], v[80:83], v[64:67], v[0:15]
    v_mfma_f32_32x32x16_bf16 v[16:31], v[84:87], v[64:67], v[16:31]
    v_mfma_f32_32x32x16_bf16 v[32:47], v[80:83], v[68:71], v[32:47]
    v_mfma_f32_32x32x16_bf16 v[48:63], v[84:87], v[68:71], v[48:63]
    s_waitcnt lgkmcnt(0)
    v_mfma_f32_32x32x16_bf16 v[0:15], v[88:91], v[72:75], v[0:15]
    v_mfma_f32_32x32x16_bf16 v[16:31], v[92:95], v[72:75], v[16:31]
    v_mfma_f32_32x32x16_bf16 v[32:47], v[88:91], v[76:79], v[32:47]
    v_mfma_f32_32x32x16_bf16 v[48:63], v[92:95], v[76:79], v[48:63]
    s_waitcnt vmcnt(9)
    s_barrier
    ds_read_b128 v[64:67], v96 offset:28672
    ds_read_b128 v[68:71], v96 offset:30720
    ds_read_b64_tr_b16 v[80:81], v98 offset:28672
    ds_read_b64_tr_b16 v[82:83], v98 offset:30208
    ds_read_b64_tr_b16 v[84:85], v99 offset:28672
    ds_read_b64_tr_b16 v[86:87], v99 offset:30208
    ds_read_b128 v[72:75], v97 offset:28672
    ds_read_b128 v[76:79], v97 offset:30720
    ds_read_b64_tr_b16 v[88:89], v98 offset:34816
    ds_read_b64_tr_b16 v[90:91], v98 offset:36352
    ds_read_b64_tr_b16 v[92:93], v99 offset:34816
    ds_read_b64_tr_b16 v[94:95], v99 offset:36352
    s_add_u32 m0, s24, 0
    s_nop 0
    global_load_lds_dwordx4 v[100:101], off
    v_lshl_add_u64 v[100:101], v[100:101], 0, s[40:41]
    s_add_u32 m0, s25, 0
    s_nop 0
    global_load_lds_dwordx4 v[102:103], off
    v_lshl_add_u64 v[102:103], v[102:103], 0, s[42:43]
    s_add_u32 m0, s26, 0
    s_nop 0
    global_load_lds_dwordx4 v[104:105], off
    v_lshl_add_u64 v[104:105], v[104:105], 0, s[44:45]
    s_waitcnt lgkmcnt(6)
    v_mfma_f32_32x32x16_bf16 v[0:15], v[80:83], v[64:67], v[0:15]
    v_mfma_f32_32x32x16_bf16 v[16:31], v[84:87], v[64:67], v[16:31]
    v_mfma_f32_32x32x16_bf16 v[32:47], v[80:83], v[68:71], v[32:47]
    v_mfma_f32_32x32x16_bf16 v[48:63], v[84:87], v[68:71], v[48:63]
    s_waitcnt lgkmcnt(0)
    v_mfma_f32_32x32x16_bf16 v[0:15], v[88:91], v[72:75], v[0:15]
    v_mfma_f32_32x32x16_bf16 v[16:31], v[92:95], v[72:75], v[16:31]
    v_mfma_f32_32x32x16_bf16 v[32:47], v[88:91], v[76:79], v[32:47]
    v_mfma_f32_32x32x16_bf16 v[48:63], v[92:95], v[76:79], v[48:63]
    v_add_u32 v124, 57344, v96
    v_add_u32 v126, 57344, v98
    v_add_u32 v125, 57344, v97
    v_add_u32 v127, 57344, v99
    s_waitcnt vmcnt(9)
    s_barrier
    ds_read_b128 v[64:67], v124 offset:0
    ds_read_b128 v[68:71], v124 offset:2048
    ds_read_b64_tr_b16 v[80:81], v126 offset:0
    ds_read_b64_tr_b16 v[82:83], v126 offset:1536
    ds_read_b64_tr_b16 v[84:85], v127 offset:0
    ds_read_b64_tr_b16 v[86:87], v127 offset:1536
    ds_read_b128 v[72:75], v125 offset:0
    ds_read_b128 v[76:79], v125 offset:2048
    ds_read_b64_tr_b16 v[88:89], v126 offset:6144
    ds_read_b64_tr_b16 v[90:91], v126 offset:7680
    ds_read_b64_tr_b16 v[92:93], v127 offset:6144
    ds_read_b64_tr_b16 v[94:95], v127 offset:7680
    s_add_u32 m0, s24, 28672
    s_nop 0
    global_load_lds_dwordx4 v[100:101], off
    v_lshl_add_u64 v[100:101], v[100:101], 0, s[40:41]
    s_add_u32 m0, s25, 28672
    s_nop 0
    global_load_lds_dwordx4 v[102:103], off
    v_lshl_add_u64 v[102:103], v[102:103], 0, s[42:43]
    s_add_u32 m0, s26, 28672
    s_nop 0
    global_load_lds_dwordx4 v[104:105], off
    v_lshl_add_u64 v[104:105], v[104:105], 0, s[44:45]
    s_waitcnt lgkmcnt(6)
    v_mfma_f32_32x32x16_bf16 v[0:15], v[80:83], v[64:67], v[0:15]
    v_mfma_f32_32x32x16_bf16 v[16:31], v[84:87], v[64:67], v[16:31]
    v_mfma_f32_32x32x16_bf16 v[32:47], v[80:83], v[68:71], v[32:47]
    v_mfma_f32_32x32x16_bf16 v[48:63], v[84:87], v[68:71], v[48:63]
    s_waitcnt lgkmcnt(0)
    v_mfma_f32_32x32x16_bf16 v[0:15], v[88:91], v[72:75], v[0:15]
    v_mfma_f32_32x32x16_bf16 v[16:31], v[92:95], v[72:75], v[16:31]
    v_mfma_f32_32x32x16_bf16 v[32:47], v[88:91], v[76:79], v[32:47]
    v_mfma_f32_32x32x16_bf16 v[48:63], v[92:95], v[76:79], v[48:63]
    v_add_u32 v124, 57344, v96
    v_add_u32 v126, 57344, v98
    v_add_u32 v125, 57344, v97
    v_add_u32 v127, 57344, v99
    s_waitcnt vmcnt(9)
    s_barrier
    ds_read_b128 v[64:67], v124 offset:28672
    ds_read_b128 v[68:71], v124 offset:30720
    ds_read_b64_tr_b16 v[80:81], v126 offset:28672
    ds_read_b64_tr_b16 v[82:83], v126 offset:30208
    ds_read_b64_tr_b16 v[84:85], v127 offset:28672
    ds_read_b64_tr_b16 v[86:87], v127 offset:30208
    ds_read_b128 v[72:75], v125 offset:28672
    ds_read_b128 v[76:79], v125 offset:30720
    ds_read_b64_tr_b16 v[88:89], v126 offset:34816
    ds_read_b64_tr_b16 v[90:91], v126 offset:36352
    ds_read_b64_tr_b16 v[92:93], v127 offset:34816
    ds_read_b64_tr_b16 v[94:95], v127 offset:36352
    s_add_u32 m0, s24, 57344
    s_nop 0
    global_load_lds_dwordx4 v[100:101], off
    v_lshl_add_u64 v[100:101], v[100:101], 0, s[40:41]
    s_add_u32 m0, s25, 57344
    s_nop 0
    global_load_lds_dwordx4 v[102:103], off
    v_lshl_add_u64 v[102:103], v[102:103], 0, s[42:43]
    s_add_u32 m0, s26, 57344
    s_nop 0
    global_load_lds_dwordx4 v[104:105], off
    v_lshl_add_u64 v[104:105], v[104:105], 0, s[44:45]
    s_waitcnt lgkmcnt(6)
    v_mfma_f32_32x32x16_bf16 v[0:15], v[80:83], v[64:67], v[0:15]
    v_mfma_f32_32x32x16_bf16 v[16:31], v[84:87], v[64:67], v[16:31]
    v_mfma_f32_32x32x16_bf16 v[32:47], v[80:83], v[68:71], v[32:47]
    v_mfma_f32_32x32x16_bf16 v[48:63], v[84:87], v[68:71], v[48:63]
    s_waitcnt lgkmcnt(0)
    v_mfma_f32_32x32x16_bf16 v[0:15], v[88:91], v[72:75], v[0:15]
    v_mfma_f32_32x32x16_bf16 v[16:31], v[92:95], v[72:75], v[16:31]
    v_mfma_f32_32x32x16_bf16 v[32:47], v[88:91], v[76:79], v[32:47]
    v_mfma_f32_32x32x16_bf16 v[48:63], v[92:95], v[76:79], v[48:63]
    v_add_u32 v124, 114688, v96
    v_add_u32 v126, 114688, v98
    v_add_u32 v125, 114688, v97
    v_add_u32 v127, 114688, v99
    s_waitcnt vmcnt(9)
    s_barrier
    ds_read_b128 v[64:67], v124 offset:0
    ds_read_b128 v[68:71], v124 offset:2048
    ds_read_b64_tr_b16 v[80:81], v126 offset:0
    ds_read_b64_tr_b16 v[82:83], v126 offset:1536
    ds_read_b64_tr_b16 v[84:85], v127 offset:0
    ds_read_b64_tr_b16 v[86:87], v127 offset:1536
    ds_read_b128 v[72:75], v125 offset:0
    ds_read_b128 v[76:79], v125 offset:2048
    ds_read_b64_tr_b16 v[88:89], v126 offset:6144
    ds_read_b64_tr_b16 v[90:91], v126 offset:7680
    ds_read_b64_tr_b16 v[92:93], v127 offset:6144
    ds_read_b64_tr_b16 v[94:95], v127 offset:7680
    s_add_u32 m0, s24, 86016
    s_nop 0
    global_load_lds_dwordx4 v[100:101], off
    v_lshl_add_u64 v[100:101], v[100:101], 0, s[40:41]
    s_add_u32 m0, s25, 86016
    s_nop 0
    global_load_lds_dwordx4 v[102:103], off
    v_lshl_add_u64 v[102:103], v[102:103], 0, s[42:43]
    s_add_u32 m0, s26, 86016
    s_nop 0
    global_load_lds_dwordx4 v[104:105], off
    v_lshl_add_u64 v[104:105], v[104:105], 0, s[44:45]
    s_waitcnt lgkmcnt(6)
    v_mfma_f32_32x32x16_bf16 v[0:15], v[80:83], v[64:67], v[0:15]
    v_mfma_f32_32x32x16_bf16 v[16:31], v[84:87], v[64:67], v[16:31]
    v_mfma_f32_32x32x16_bf16 v[32:47], v[80:83], v[68:71], v[32:47]
    v_mfma_f32_32x32x16_bf16 v[48:63], v[84:87], v[68:71], v[48:63]
    s_waitcnt lgkmcnt(0)
    v_mfma_f32_32x32x16_bf16 v[0:15], v[88:91], v[72:75], v[0:15]
    v_mfma_f32_32x32x16_bf16 v[16:31], v[92:95], v[72:75], v[16:31]
    v_mfma_f32_32x32x16_bf16 v[32:47], v[88:91], v[76:79], v[32:47]
    v_mfma_f32_32x32x16_bf16 v[48:63], v[92:95], v[76:79], v[48:63]
    s_waitcnt vmcnt(9)
    s_barrier
    ds_read_b128 v[64:67], v96 offset:0
    ds_read_b128 v[68:71], v96 offset:2048
    ds_read_b64_tr_b16 v[80:81], v98 offset:0
    ds_read_b64_tr_b16 v[82:83], v98 offset:1536
    ds_read_b64_tr_b16 v[84:85], v99 offset:0
    ds_read_b64_tr_b16 v[86:87], v99 offset:1536
    ds_read_b128 v[72:75], v97 offset:0
    ds_read_b128 v[76:79], v97 offset:2048
    ds_read_b64_tr_b16 v[88:89], v98 offset:6144
    ds_read_b64_tr_b16 v[90:91], v98 offset:7680
    ds_read_b64_tr_b16 v[92:93], v99 offset:6144
    ds_read_b64_tr_b16 v[94:95], v99 offset:7680
    s_add_u32 m0, s24, 114688
    s_nop 0
    global_load_lds_dwordx4 v[100:101], off
    v_lshl_add_u64 v[100:101], v[100:101], 0, s[40:41]
    s_add_u32 m0, s25, 114688
    s_nop 0
    global_load_lds_dwordx4 v[102:103], off
    v_lshl_add_u64 v[102:103], v[102:103], 0, s[42:43]
    s_add_u32 m0, s26, 114688
    s_nop 0
    global_load_lds_dwordx4 v[104:105], off
    v_lshl_add_u64 v[104:105], v[104:105], 0, s[44:45]
    s_waitcnt lgkmcnt(6)
    v_mfma_f32_32x32x16_bf16 v[0:15], v[80:83], v[64:67], v[0:15]
    v_mfma_f32_32x32x16_bf16 v[16:31], v[84:87], v[64:67], v[16:31]
    v_mfma_f32_32x32x16_bf16 v[32:47], v[80:83], v[68:71], v[32:47]
    v_mfma_f32_32x32x16_bf16 v[48:63], v[84:87], v[68:71], v[48:63]
    s_waitcnt lgkmcnt(0)
    v_mfma_f32_32x32x16_bf16 v[0:15], v[88:91], v[72:75], v[0:15]
    v_mfma_f32_32x32x16_bf16 v[16:31], v[92:95], v[72:75], v[16:31]
    v_mfma_f32_32x32x16_bf16 v[32:47], v[88:91], v[76:79], v[32:47]
    v_mfma_f32_32x32x16_bf16 v[48:63], v[92:95], v[76:79], v[48:63]
    s_waitcnt vmcnt(9)
    s_barrier
    ds_read_b128 v[64:67], v96 offset:28672
    ds_read_b128 v[68:71], v96 offset:30720
    ds_read_b64_tr_b16 v[80:81], v98 offset:28672
    ds_read_b64_tr_b16 v[82:83], v98 offset:30208
    ds_read_b64_tr_b16 v[84:85], v99 offset:28672
    ds_read_b64_tr_b16 v[86:87], v99 offset:30208
    ds_read_b128 v[72:75], v97 offset:28672
    ds_read_b128 v[76:79], v97 offset:30720
    ds_read_b64_tr_b16 v[88:89], v98 offset:34816
    ds_read_b64_tr_b16 v[90:91], v98 offset:36352
    ds_read_b64_tr_b16 v[92:93], v99 offset:34816
    ds_read_b64_tr_b16 v[94:95], v99 offset:36352
    s_waitcnt lgkmcnt(6)
    v_mfma_f32_32x32x16_bf16 v[0:15], v[80:83], v[64:67], v[0:15]
    v_mfma_f32_32x32x16_bf16 v[16:31], v[84:87], v[64:67], v[16:31]
    v_mfma_f32_32x32x16_bf16 v[32:47], v[80:83], v[68:71], v[32:47]
    v_mfma_f32_32x32x16_bf16 v[48:63], v[84:87], v[68:71], v[48:63]
    s_waitcnt lgkmcnt(0)
    v_mfma_f32_32x32x16_bf16 v[0:15], v[88:91], v[72:75], v[0:15]
    v_mfma_f32_32x32x16_bf16 v[16:31], v[92:95], v[72:75], v[16:31]
    v_mfma_f32_32x32x16_bf16 v[32:47], v[88:91], v[76:79], v[32:47]
    v_mfma_f32_32x32x16_bf16 v[48:63], v[92:95], v[76:79], v[48:63]
    v_add_u32 v124, 57344, v96
    v_add_u32 v126, 57344, v98
    v_add_u32 v125, 57344, v97
    v_add_u32 v127, 57344, v99
    s_waitcnt vmcnt(6)
    s_barrier
    ds_read_b128 v[64:67], v124 offset:0
    ds_read_b128 v[68:71], v124 offset:2048
    ds_read_b64_tr_b16 v[80:81], v126 offset:0
    ds_read_b64_tr_b16 v[82:83], v126 offset:1536
    ds_read_b64_tr_b16 v[84:85], v127 offset:0
    ds_read_b64_tr_b16 v[86:87], v127 offset:1536
    ds_read_b128 v[72:75], v125 offset:0
    ds_read_b128 v[76:79], v125 offset:2048
    ds_read_b64_tr_b16 v[88:89], v126 offset:6144
    ds_read_b64_tr_b16 v[90:91], v126 offset:7680
    ds_read_b64_tr_b16 v[92:93], v127 offset:6144
    ds_read_b64_tr_b16 v[94:95], v127 offset:7680
    s_waitcnt lgkmcnt(6)
    v_mfma_f32_32x32x16_bf16 v[0:15], v[80:83], v[64:67], v[0:15]
    v_mfma_f32_32x32x16_bf16 v[16:31], v[84:87], v[64:67], v[16:31]
    v_mfma_f32_32x32x16_bf16 v[32:47], v[80:83], v[68:71], v[32:47]
    v_mfma_f32_32x32x16_bf16 v[48:63], v[84:87], v[68:71], v[48:63]
    s_waitcnt lgkmcnt(0)
    v_mfma_f32_32x32x16_bf16 v[0:15], v[88:91], v[72:75], v[0:15]
    v_mfma_f32_32x32x16_bf16 v[16:31], v[92:95], v[72:75], v[16:31]
    v_mfma_f32_32x32x16_bf16 v[32:47], v[88:91], v[76:79], v[32:47]
    v_mfma_f32_32x32x16_bf16 v[48:63], v[92:95], v[76:79], v[48:63]
    v_add_u32 v124, 57344, v96
    v_add_u32 v126, 57344, v98
    v_add_u32 v125, 57344, v97
    v_add_u32 v127, 57344, v99
    s_waitcnt vmcnt(3)
    s_barrier
    ds_read_b128 v[64:67], v124 offset:28672
    ds_read_b128 v[68:71], v124 offset:30720
    ds_read_b64_tr_b16 v[80:81], v126 offset:28672
    ds_read_b64_tr_b16 v[82:83], v126 offset:30208
    ds_read_b64_tr_b16 v[84:85], v127 offset:28672
    ds_read_b64_tr_b16 v[86:87], v127 offset:30208
    ds_read_b128 v[72:75], v125 offset:28672
    ds_read_b128 v[76:79], v125 offset:30720
    ds_read_b64_tr_b16 v[88:89], v126 offset:34816
    ds_read_b64_tr_b16 v[90:91], v126 offset:36352
    ds_read_b64_tr_b16 v[92:93], v127 offset:34816
    ds_read_b64_tr_b16 v[94:95], v127 offset:36352
    s_waitcnt lgkmcnt(6)
    v_mfma_f32_32x32x16_bf16 v[0:15], v[80:83], v[64:67], v[0:15]
    v_mfma_f32_32x32x16_bf16 v[16:31], v[84:87], v[64:67], v[16:31]
    v_mfma_f32_32x32x16_bf16 v[32:47], v[80:83], v[68:71], v[32:47]
    v_mfma_f32_32x32x16_bf16 v[48:63], v[84:87], v[68:71], v[48:63]
    s_waitcnt lgkmcnt(0)
    v_mfma_f32_32x32x16_bf16 v[0:15], v[88:91], v[72:75], v[0:15]
    v_mfma_f32_32x32x16_bf16 v[16:31], v[92:95], v[72:75], v[16:31]
    v_mfma_f32_32x32x16_bf16 v[32:47], v[88:91], v[76:79], v[32:47]
    v_mfma_f32_32x32x16_bf16 v[48:63], v[92:95], v[76:79], v[48:63]
    v_add_u32 v124, 114688, v96
    v_add_u32 v126, 114688, v98
    v_add_u32 v125, 114688, v97
    v_add_u32 v127, 114688, v99
    s_waitcnt vmcnt(0)
    s_barrier
    ds_read_b128 v[64:67], v124 offset:0
    ds_read_b128 v[68:71], v124 offset:2048
    ds_read_b64_tr_b16 v[80:81], v126 offset:0
    ds_read_b64_tr_b16 v[82:83], v126 offset:1536
    ds_read_b64_tr_b16 v[84:85], v127 offset:0
    ds_read_b64_tr_b16 v[86:87], v127 offset:1536
    ds_read_b128 v[72:75], v125 offset:0
    ds_read_b128 v[76:79], v125 offset:2048
    ds_read_b64_tr_b16 v[88:89], v126 offset:6144
    ds_read_b64_tr_b16 v[90:91], v126 offset:7680
    ds_read_b64_tr_b16 v[92:93], v127 offset:6144
    ds_read_b64_tr_b16 v[94:95], v127 offset:7680
    s_waitcnt lgkmcnt(6)
    v_mfma_f32_32x32x16_bf16 v[0:15], v[80:83], v[64:67], v[0:15]
    v_mfma_f32_32x32x16_bf16 v[16:31], v[84:87], v[64:67], v[16:31]
    v_mfma_f32_32x32x16_bf16 v[32:47], v[80:83], v[68:71], v[32:47]
    v_mfma_f32_32x32x16_bf16 v[48:63], v[84:87], v[68:71], v[48:63]
    s_waitcnt lgkmcnt(0)
    v_mfma_f32_32x32x16_bf16 v[0:15], v[88:91], v[72:75], v[0:15]
    v_mfma_f32_32x32x16_bf16 v[16:31], v[92:95], v[72:75], v[16:31]
    v_mfma_f32_32x32x16_bf16 v[32:47], v[88:91], v[76:79], v[32:47]
    v_mfma_f32_32x32x16_bf16 v[48:63], v[92:95], v[76:79], v[48:63]
    s_barrier
    s_nop 15
    v_and_b32 v110, 31, v108
    s_lshl_b32 s39, s31, 6
    v_add_u32 v110, s39, v110
    v_mul_u32_u24 v110, 208, v110
    s_lshl_b32 s39, s32, 6
    v_lshrrev_b32 v111, 5, v108
    v_lshlrev_b32 v111, 3, v111
    v_add3_u32 v110, v110, v111, s39
    s_mov_b32 s38, 0x3d372713
    s_mov_b32 s39, 0xc0135761
    v_mul_f32 v116, v0, v0
    v_fma_f32 v116, v116, s38, 1.0
    v_mul_f32 v116, v116, v0
    v_mul_f32 v116, s39, v116
    v_exp_f32 v116, v116
    v_mul_f32 v0, v0, v16
    v_mul_f32 v117, v1, v1
    v_fma_f32 v117, v117, s38, 1.0
    v_mul_f32 v117, v117, v1
    v_mul_f32 v117, s39, v117
    v_exp_f32 v117, v117
    v_mul_f32 v1, v1, v17
    v_mul_f32 v118, v2, v2
    v_fma_f32 v118, v118, s38, 1.0
    v_mul_f32 v118, v118, v2
    v_mul_f32 v118, s39, v118
    v_exp_f32 v118, v118
    v_mul_f32 v2, v2, v18
    v_mul_f32 v119, v3, v3
    v_fma_f32 v119, v119, s38, 1.0
    v_mul_f32 v119, v119, v3
    v_mul_f32 v119, s39, v119
    v_exp_f32 v119, v119
    v_mul_f32 v3, v3, v19
    v_add_f32 v116, 1.0, v116
    v_rcp_f32 v116, v116
    v_add_f32 v117, 1.0, v117
    v_rcp_f32 v117, v117
    v_add_f32 v118, 1.0, v118
    v_rcp_f32 v118, v118
    v_add_f32 v119, 1.0, v119
    v_rcp_f32 v119, v119
    s_nop 0
    v_mul_f32 v116, v0, v116
    v_mul_f32 v117, v1, v117
    v_mul_f32 v118, v2, v118
    v_mul_f32 v119, v3, v119
    v_cvt_pk_bf16_f32 v120, v116, v117
    v_cvt_pk_bf16_f32 v121, v118, v119
    ds_write_b64 v110, v[120:121] offset:0
    v_mul_f32 v116, v4, v4
    v_fma_f32 v116, v116, s38, 1.0
    v_mul_f32 v116, v116, v4
    v_mul_f32 v116, s39, v116
    v_exp_f32 v116, v116
    v_mul_f32 v4, v4, v20
    v_mul_f32 v117, v5, v5
    v_fma_f32 v117, v117, s38, 1.0
    v_mul_f32 v117, v117, v5
    v_mul_f32 v117, s39, v117
    v_exp_f32 v117, v117
    v_mul_f32 v5, v5, v21
    v_mul_f32 v118, v6, v6
    v_fma_f32 v118, v118, s38, 1.0
    v_mul_f32 v118, v118, v6
    v_mul_f32 v118, s39, v118
    v_exp_f32 v118, v118
    v_mul_f32 v6, v6, v22
    v_mul_f32 v119, v7, v7
    v_fma_f32 v119, v119, s38, 1.0
    v_mul_f32 v119, v119, v7
    v_mul_f32 v119, s39, v119
    v_exp_f32 v119, v119
    v_mul_f32 v7, v7, v23
    v_add_f32 v116, 1.0, v116
    v_rcp_f32 v116, v116
    v_add_f32 v117, 1.0, v117
    v_rcp_f32 v117, v117
    v_add_f32 v118, 1.0, v118
    v_rcp_f32 v118, v118
    v_add_f32 v119, 1.0, v119
    v_rcp_f32 v119, v119
    s_nop 0
    v_mul_f32 v116, v4, v116
    v_mul_f32 v117, v5, v117
    v_mul_f32 v118, v6, v118
    v_mul_f32 v119, v7, v119
    v_cvt_pk_bf16_f32 v120, v116, v117
    v_cvt_pk_bf16_f32 v121, v118, v119
    ds_write_b64 v110, v[120:121] offset:16
    v_mul_f32 v116, v8, v8
    v_fma_f32 v116, v116, s38, 1.0
    v_mul_f32 v116, v116, v8
    v_mul_f32 v116, s39, v116
    v_exp_f32 v116, v116
    v_mul_f32 v8, v8, v24
    v_mul_f32 v117, v9, v9
    v_fma_f32 v117, v117, s38, 1.0
    v_mul_f32 v117, v117, v9
    v_mul_f32 v117, s39, v117
    v_exp_f32 v117, v117
    v_mul_f32 v9, v9, v25
    v_mul_f32 v118, v10, v10
    v_fma_f32 v118, v118, s38, 1.0
    v_mul_f32 v118, v118, v10
    v_mul_f32 v118, s39, v118
    v_exp_f32 v118, v118
    v_mul_f32 v10, v10, v26
    v_mul_f32 v119, v11, v11
    v_fma_f32 v119, v119, s38, 1.0
    v_mul_f32 v119, v119, v11
    v_mul_f32 v119, s39, v119
    v_exp_f32 v119, v119
    v_mul_f32 v11, v11, v27
    v_add_f32 v116, 1.0, v116
    v_rcp_f32 v116, v116
    v_add_f32 v117, 1.0, v117
    v_rcp_f32 v117, v117
    v_add_f32 v118, 1.0, v118
    v_rcp_f32 v118, v118
    v_add_f32 v119, 1.0, v119
    v_rcp_f32 v119, v119
    s_nop 0
    v_mul_f32 v116, v8, v116
    v_mul_f32 v117, v9, v117
    v_mul_f32 v118, v10, v118
    v_mul_f32 v119, v11, v119
    v_cvt_pk_bf16_f32 v120, v116, v117
    v_cvt_pk_bf16_f32 v121, v118, v119
    ds_write_b64 v110, v[120:121] offset:32
    v_mul_f32 v116, v12, v12
    v_fma_f32 v116, v116, s38, 1.0
    v_mul_f32 v116, v116, v12
    v_mul_f32 v116, s39, v116
    v_exp_f32 v116, v116
    v_mul_f32 v12, v12, v28
    v_mul_f32 v117, v13, v13
    v_fma_f32 v117, v117, s38, 1.0
    v_mul_f32 v117, v117, v13
    v_mul_f32 v117, s39, v117
    v_exp_f32 v117, v117
    v_mul_f32 v13, v13, v29
    v_mul_f32 v118, v14, v14
    v_fma_f32 v118, v118, s38, 1.0
    v_mul_f32 v118, v118, v14
    v_mul_f32 v118, s39, v118
    v_exp_f32 v118, v118
    v_mul_f32 v14, v14, v30
    v_mul_f32 v119, v15, v15
    v_fma_f32 v119, v119, s38, 1.0
    v_mul_f32 v119, v119, v15
    v_mul_f32 v119, s39, v119
    v_exp_f32 v119, v119
    v_mul_f32 v15, v15, v31
    v_add_f32 v116, 1.0, v116
    v_rcp_f32 v116, v116
    v_add_f32 v117, 1.0, v117
    v_rcp_f32 v117, v117
    v_add_f32 v118, 1.0, v118
    v_rcp_f32 v118, v118
    v_add_f32 v119, 1.0, v119
    v_rcp_f32 v119, v119
    s_nop 0
    v_mul_f32 v116, v12, v116
    v_mul_f32 v117, v13, v117
    v_mul_f32 v118, v14, v118
    v_mul_f32 v119, v15, v119
    v_cvt_pk_bf16_f32 v120, v116, v117
    v_cvt_pk_bf16_f32 v121, v118, v119
    ds_write_b64 v110, v[120:121] offset:48
    v_mul_f32 v116, v32, v32
    v_fma_f32 v116, v116, s38, 1.0
    v_mul_f32 v116, v116, v32
    v_mul_f32 v116, s39, v116
    v_exp_f32 v116, v116
    v_mul_f32 v32, v32, v48
    v_mul_f32 v117, v33, v33
    v_fma_f32 v117, v117, s38, 1.0
    v_mul_f32 v117, v117, v33
    v_mul_f32 v117, s39, v117
    v_exp_f32 v117, v117
    v_mul_f32 v33, v33, v49
    v_mul_f32 v118, v34, v34
    v_fma_f32 v118, v118, s38, 1.0
    v_mul_f32 v118, v118, v34
    v_mul_f32 v118, s39, v118
    v_exp_f32 v118, v118
    v_mul_f32 v34, v34, v50
    v_mul_f32 v119, v35, v35
    v_fma_f32 v119, v119, s38, 1.0
    v_mul_f32 v119, v119, v35
    v_mul_f32 v119, s39, v119
    v_exp_f32 v119, v119
    v_mul_f32 v35, v35, v51
    v_add_f32 v116, 1.0, v116
    v_rcp_f32 v116, v116
    v_add_f32 v117, 1.0, v117
    v_rcp_f32 v117, v117
    v_add_f32 v118, 1.0, v118
    v_rcp_f32 v118, v118
    v_add_f32 v119, 1.0, v119
    v_rcp_f32 v119, v119
    s_nop 0
    v_mul_f32 v116, v32, v116
    v_mul_f32 v117, v33, v117
    v_mul_f32 v118, v34, v118
    v_mul_f32 v119, v35, v119
    v_cvt_pk_bf16_f32 v120, v116, v117
    v_cvt_pk_bf16_f32 v121, v118, v119
    ds_write_b64 v110, v[120:121] offset:6656
    v_mul_f32 v116, v36, v36
    v_fma_f32 v116, v116, s38, 1.0
    v_mul_f32 v116, v116, v36
    v_mul_f32 v116, s39, v116
    v_exp_f32 v116, v116
    v_mul_f32 v36, v36, v52
    v_mul_f32 v117, v37, v37
    v_fma_f32 v117, v117, s38, 1.0
    v_mul_f32 v117, v117, v37
    v_mul_f32 v117, s39, v117
    v_exp_f32 v117, v117
    v_mul_f32 v37, v37, v53
    v_mul_f32 v118, v38, v38
    v_fma_f32 v118, v118, s38, 1.0
    v_mul_f32 v118, v118, v38
    v_mul_f32 v118, s39, v118
    v_exp_f32 v118, v118
    v_mul_f32 v38, v38, v54
    v_mul_f32 v119, v39, v39
    v_fma_f32 v119, v119, s38, 1.0
    v_mul_f32 v119, v119, v39
    v_mul_f32 v119, s39, v119
    v_exp_f32 v119, v119
    v_mul_f32 v39, v39, v55
    v_add_f32 v116, 1.0, v116
    v_rcp_f32 v116, v116
    v_add_f32 v117, 1.0, v117
    v_rcp_f32 v117, v117
    v_add_f32 v118, 1.0, v118
    v_rcp_f32 v118, v118
    v_add_f32 v119, 1.0, v119
    v_rcp_f32 v119, v119
    s_nop 0
    v_mul_f32 v116, v36, v116
    v_mul_f32 v117, v37, v117
    v_mul_f32 v118, v38, v118
    v_mul_f32 v119, v39, v119
    v_cvt_pk_bf16_f32 v120, v116, v117
    v_cvt_pk_bf16_f32 v121, v118, v119
    ds_write_b64 v110, v[120:121] offset:6672
    v_mul_f32 v116, v40, v40
    v_fma_f32 v116, v116, s38, 1.0
    v_mul_f32 v116, v116, v40
    v_mul_f32 v116, s39, v116
    v_exp_f32 v116, v116
    v_mul_f32 v40, v40, v56
    v_mul_f32 v117, v41, v41
    v_fma_f32 v117, v117, s38, 1.0
    v_mul_f32 v117, v117, v41
    v_mul_f32 v117, s39, v117
    v_exp_f32 v117, v117
    v_mul_f32 v41, v41, v57
    v_mul_f32 v118, v42, v42
    v_fma_f32 v118, v118, s38, 1.0
    v_mul_f32 v118, v118, v42
    v_mul_f32 v118, s39, v118
    v_exp_f32 v118, v118
    v_mul_f32 v42, v42, v58
    v_mul_f32 v119, v43, v43
    v_fma_f32 v119, v119, s38, 1.0
    v_mul_f32 v119, v119, v43
    v_mul_f32 v119, s39, v119
    v_exp_f32 v119, v119
    v_mul_f32 v43, v43, v59
    v_add_f32 v116, 1.0, v116
    v_rcp_f32 v116, v116
    v_add_f32 v117, 1.0, v117
    v_rcp_f32 v117, v117
    v_add_f32 v118, 1.0, v118
    v_rcp_f32 v118, v118
    v_add_f32 v119, 1.0, v119
    v_rcp_f32 v119, v119
    s_nop 0
    v_mul_f32 v116, v40, v116
    v_mul_f32 v117, v41, v117
    v_mul_f32 v118, v42, v118
    v_mul_f32 v119, v43, v119
    v_cvt_pk_bf16_f32 v120, v116, v117
    v_cvt_pk_bf16_f32 v121, v118, v119
    ds_write_b64 v110, v[120:121] offset:6688
    v_mul_f32 v116, v44, v44
    v_fma_f32 v116, v116, s38, 1.0
    v_mul_f32 v116, v116, v44
    v_mul_f32 v116, s39, v116
    v_exp_f32 v116, v116
    v_mul_f32 v44, v44, v60
    v_mul_f32 v117, v45, v45
    v_fma_f32 v117, v117, s38, 1.0
    v_mul_f32 v117, v117, v45
    v_mul_f32 v117, s39, v117
    v_exp_f32 v117, v117
    v_mul_f32 v45, v45, v61
    v_mul_f32 v118, v46, v46
    v_fma_f32 v118, v118, s38, 1.0
    v_mul_f32 v118, v118, v46
    v_mul_f32 v118, s39, v118
    v_exp_f32 v118, v118
    v_mul_f32 v46, v46, v62
    v_mul_f32 v119, v47, v47
    v_fma_f32 v119, v119, s38, 1.0
    v_mul_f32 v119, v119, v47
    v_mul_f32 v119, s39, v119
    v_exp_f32 v119, v119
    v_mul_f32 v47, v47, v63
    v_add_f32 v116, 1.0, v116
    v_rcp_f32 v116, v116
    v_add_f32 v117, 1.0, v117
    v_rcp_f32 v117, v117
    v_add_f32 v118, 1.0, v118
    v_rcp_f32 v118, v118
    v_add_f32 v119, 1.0, v119
    v_rcp_f32 v119, v119
    s_nop 0
    v_mul_f32 v116, v44, v116
    v_mul_f32 v117, v45, v117
    v_mul_f32 v118, v46, v118
    v_mul_f32 v119, v47, v119
    v_cvt_pk_bf16_f32 v120, v116, v117
    v_cvt_pk_bf16_f32 v121, v118, v119
    ds_write_b64 v110, v[120:121] offset:6704
    s_add_u32 s44, s6, 16777216
    s_addc_u32 s45, s7, 0
    s_mov_b32 s46, 7077888
    s_mov_b32 s47, 0x00020000
    s_movk_i32 s33, 5462
    v_mul_lo_u32 v110, v106, s33
    v_lshrrev_b32 v110, 16, v110
    v_mul_u32_u24 v111, 12, v110
    v_sub_u32 v111, v106, v111
    v_lshlrev_b32 v111, 4, v111
    v_mul_u32_u24 v112, 208, v110
    v_add_u32 v112, v112, v111
    v_add_u32 v110, s36, v110
    v_mul_u32_u24 v110, 3456, v110
    v_add3_u32 v110, v110, v111, s37
    s_waitcnt lgkmcnt(0)
    s_barrier
    ds_read_b128 v[0:3], v112 offset:0
    ds_read_b128 v[4:7], v112 offset:13312
    ds_read_b128 v[8:11], v112 offset:26624
    ds_read_b128 v[12:15], v112 offset:39936
    s_mov_b32 s39, 0
    s_waitcnt lgkmcnt(3)
    buffer_store_dwordx4 v[0:3], v110, s[44:47], s39 offen
    s_mov_b32 s39, 221184
    s_waitcnt lgkmcnt(2)
    buffer_store_dwordx4 v[4:7], v110, s[44:47], s39 offen
    s_mov_b32 s39, 442368
    s_waitcnt lgkmcnt(1)
    buffer_store_dwordx4 v[8:11], v110, s[44:47], s39 offen
    s_mov_b32 s39, 663552
    s_waitcnt lgkmcnt(0)
    buffer_store_dwordx4 v[12:15], v110, s[44:47], s39 offen
G1_done:
    s_endpgm
.globl attn_kernel
.p2align 8
.type attn_kernel,@function
attn_kernel:
    s_cmp_ge_u32 s2, 496
    s_cbranch_scc1 AT_done
    s_cmp_ge_u32 s2, 256
    s_cbranch_scc1 AT_gemm
    s_load_dwordx2 s[6:7], s[0:1], 72
    s_and_b32 s34, s2, 31
    s_lshr_b32 s35, s2, 5
    v_and_b32 v87, 63, v0
    v_lshrrev_b32 v93, 6, v0
    s_nop 0
    v_readfirstlane_b32 s30, v93
    s_waitcnt lgkmcnt(0)
    s_lshl_b32 s36, s34, 17
    s_add_u32 s8, s6, 4194304
    s_addc_u32 s9, s7, 0
    s_add_u32 s8, s8, s36
    s_addc_u32 s9, s9, 0
    s_mov_b32 s10, 131072
    s_mov_b32 s11, 0x00020000
    s_add_u32 s12, s6, 8388608
    s_addc_u32 s13, s7, 0
    s_add_u32 s12, s12, s36
    s_addc_u32 s13, s13, 0
    s_mov_b32 s14, 131072
    s_mov_b32 s15, 0x00020000
    s_add_u32 s16, s6, 12582912
    s_addc_u32 s17, s7, 0
    s_add_u32 s16, s16, s36
    s_addc_u32 s17, s17, 0
    s_mov_b32 s18, 131072
    s_mov_b32 s19, 0x00020000
    s_add_u32 s20, s6, 25165824
    s_addc_u32 s21, s7, 0
    s_mov_b32 s22, 2621440
    s_mov_b32 s23, 0x00020000
    s_lshl_b32 s31, s30, 10
    v_lshlrev_b32 v86, 4, v87
    v_add_u32 v86, s31, v86
    v_and_b32 v94, 31, v87
    v_lshrrev_b32 v95, 5, v87
    s_lshl_b32 s36, s35, 8
    s_lshl_b32 s37, s30, 5
    s_add_u32 s36, s36, s37
    v_add_u32 v96, s36, v94
    v_lshlrev_b32 v96, 6, v96
    v_lshl_add_u32 v96, v95, 4, v96
    buffer_load_dwordx4 v[48:51], v96, s[8:11], 0 offen
    buffer_load_dwordx4 v[52:55], v96, s[8:11], 0 offen offset:32
    s_mov_b32 s44, 0
    s_mov_b32 s45, 16384
    s_mov_b32 s46, 32768
    s_mov_b32 s47, 0
    s_add_u32 m0, s44, s31
    s_nop 0
    buffer_load_dwordx4 v86, s[12:15], s47 offen lds
    s_add_u32 m0, m0, 8192
    s_nop 0
    buffer_load_dwordx4 v86, s[16:19], s47 offen lds
    s_movk_i32 s47, 8192
    s_add_u32 m0, s45, s31
    s_nop 0
    buffer_load_dwordx4 v86, s[12:15], s47 offen lds
    s_add_u32 m0, m0, 8192
    s_nop 0
    buffer_load_dwordx4 v86, s[16:19], s47 offen lds
    s_movk_i32 s47, 16384
    v_bfe_u32 v96, v87, 2, 2
    v_xor_b32 v97, v95, v96
    v_lshlrev_b32 v97, 4, v97
    v_lshl_add_u32 v88, v94, 6, v97
    v_xor_b32 v89, 32, v88
    v_mov_b32 v0, 0
    v_mov_b32 v1, 0
    v_mov_b32 v2, 0
    v_mov_b32 v3, 0
    v_mov_b32 v4, 0
    v_mov_b32 v5, 0
    v_mov_b32 v6, 0
    v_mov_b32 v7, 0
    v_mov_b32 v8, 0
    v_mov_b32 v9, 0
    v_mov_b32 v10, 0
    v_mov_b32 v11, 0
    v_mov_b32 v12, 0
    v_mov_b32 v13, 0
    v_mov_b32 v14, 0
    v_mov_b32 v15, 0
    v_mov_b32 v84, 0
    v_mov_b32 v85, 0xff7fffff
    v_mov_b32 v90, 0xff7fffff
    v_cmp_gt_u32 s[48:49], 32, v87
    s_mov_b32 s40, 0
    s_waitcnt vmcnt(2)
    s_barrier
    v_mov_b32 v80, v88
    v_mov_b32 v81, v89
    v_add_u32 v82, s45, v88
    v_add_u32 v83, s45, v89
    ds_read_b128 v[56:59], v80
    ds_read_b128 v[60:63], v81
    v_mov_b32 v72, 0
    v_mov_b32 v64, 0
    v_mov_b32 v73, 0
    v_mov_b32 v65, 0
    v_mov_b32 v74, 0
    v_mov_b32 v66, 0
    v_mov_b32 v75, 0
    v_mov_b32 v67, 0
    v_mov_b32 v76, 0
    v_mov_b32 v68, 0
    v_mov_b32 v77, 0
    v_mov_b32 v69, 0
    v_mov_b32 v78, 0
    v_mov_b32 v70, 0
    v_mov_b32 v79, 0
    v_mov_b32 v71, 0
    s_waitcnt lgkmcnt(0)
    v_mfma_f32_32x32x16_bf16 v[16:31], v[56:59], v[48:51], 0
    v_mfma_f32_32x32x16_bf16 v[16:31], v[60:63], v[52:55], v[16:31]
    ds_read_b128 v[56:59], v80 offset:2048
    ds_read_b128 v[60:63], v81 offset:2048
    s_nop 15
AT_loop:
    s_waitcnt lgkmcnt(2)
    v_mfma_f32_32x32x16_bf16 v[0:15], v[64:67], v[72:75], v[0:15]
    v_max3_f32 v94, v16, v17, v18
    v_max3_f32 v95, v19, v20, v21
    v_max3_f32 v94, v94, v22, v23
    v_max3_f32 v95, v95, v24, v25
    v_max3_f32 v94, v94, v26, v27
    v_max3_f32 v95, v95, v28, v29
    v_mfma_f32_32x32x16_bf16 v[0:15], v[68:71], v[76:79], v[0:15]
    v_max3_f32 v94, v94, v30, v31
    v_max_f32 v94, v94, v95
    v_cmp_gt_f32 vcc, v94, v90
    s_cbranch_vccz AT_nors_5
    v_mov_b32 v95, v94
    s_nop 1
    v_permlane32_swap_b32 v94, v95
    s_nop 1
    v_max_f32 v94, v94, v95
    v_max_f32 v94, v94, v85
    v_mov_b32 v85, 0
    v_mov_b32 v90, 0x41000000
    v_add_f32 v84, v84, v94
    v_min_f32 v95, 0, v94
    v_sub_f32 v95, v95, v94
    v_exp_f32 v95, v95
    v_sub_f32 v16, v16, v94
    v_sub_f32 v17, v17, v94
    v_sub_f32 v18, v18, v94
    v_sub_f32 v19, v19, v94
    v_sub_f32 v20, v20, v94
    v_sub_f32 v21, v21, v94
    v_sub_f32 v22, v22, v94
    v_sub_f32 v23, v23, v94
    v_sub_f32 v24, v24, v94
    v_sub_f32 v25, v25, v94
    v_sub_f32 v26, v26, v94
    v_sub_f32 v27, v27, v94
    v_sub_f32 v28, v28, v94
    v_sub_f32 v29, v29, v94
    v_sub_f32 v30, v30, v94
    v_sub_f32 v31, v31, v94
    v_sub_f32 v96, 0, v84
    v_cvt_pk_bf16_f32 v97, v96, v96
    v_and_b32 v97, 0xffff0000, v97
    v_sub_f32 v96, v96, v97
    v_cvt_pk_bf16_f32 v98, v96, v96
    v_and_b32 v98, 0xffff0000, v98
    v_sub_f32 v96, v96, v98
    v_cvt_pk_bf16_f32 v96, v96, v96
    v_and_b32 v96, 0xffff, v96
    v_lshrrev_b32 v97, 16, v97
    v_or_b32 v97, v97, v98
    v_cndmask_b32 v54, 0, v97, s[48:49]
    v_cndmask_b32 v55, 0, v96, s[48:49]
    s_nop 15
    v_mul_f32 v0, v0, v95
    v_mul_f32 v1, v1, v95
    v_mul_f32 v2, v2, v95
    v_mul_f32 v3, v3, v95
    v_mul_f32 v4, v4, v95
    v_mul_f32 v5, v5, v95
    v_mul_f32 v6, v6, v95
    v_mul_f32 v7, v7, v95
    v_mul_f32 v8, v8, v95
    v_mul_f32 v9, v9, v95
    v_mul_f32 v10, v10, v95
    v_mul_f32 v11, v11, v95
AT_nors_5:
    ds_read_b128 v[64:67], v80 offset:8192
    ds_read_b128 v[68:71], v81 offset:8192
    s_waitcnt lgkmcnt(2)
    v_mfma_f32_32x32x16_bf16 v[32:47], v[56:59], v[48:51], 0
    v_exp_f32 v16, v16
    v_exp_f32 v17, v17
    v_exp_f32 v18, v18
    v_exp_f32 v19, v19
    v_exp_f32 v20, v20
    v_exp_f32 v21, v21
    v_mfma_f32_32x32x16_bf16 v[32:47], v[60:63], v[52:55], v[32:47]
    v_exp_f32 v22, v22
    v_exp_f32 v23, v23
    v_exp_f32 v24, v24
    v_exp_f32 v25, v25
    v_exp_f32 v26, v26
    v_exp_f32 v27, v27
    v_cvt_pk_bf16_f32 v72, v16, v17
    v_cvt_pk_bf16_f32 v73, v18, v19
    v_cvt_pk_bf16_f32 v74, v20, v21
    ds_read_b128 v[56:59], v80 offset:4096
    ds_read_b128 v[60:63], v81 offset:4096
    v_exp_f32 v28, v28
    v_exp_f32 v29, v29
    v_exp_f32 v30, v30
    v_exp_f32 v31, v31
    v_cvt_pk_bf16_f32 v75, v22, v23
    v_cvt_pk_bf16_f32 v76, v24, v25
    v_cvt_pk_bf16_f32 v77, v26, v27
    v_cvt_pk_bf16_f32 v78, v28, v29
    v_cvt_pk_bf16_f32 v79, v30, v31
    s_nop 0
    s_waitcnt vmcnt(0)
    s_barrier
    s_cmp_lt_u32 s40, 14
    s_cbranch_scc0 AT_nodma_7
    s_add_u32 m0, s46, s31
    s_nop 0
    buffer_load_dwordx4 v86, s[12:15], s47 offen lds
    s_add_u32 m0, m0, 8192
    s_nop 0
    buffer_load_dwordx4 v86, s[16:19], s47 offen lds
    s_add_u32 s47, s47, 8192
AT_nodma_7:
    s_waitcnt lgkmcnt(2)
    v_mfma_f32_32x32x16_bf16 v[0:15], v[64:67], v[72:75], v[0:15]
    v_max3_f32 v94, v32, v33, v34
    v_max3_f32 v95, v35, v36, v37
    v_max3_f32 v94, v94, v38, v39
    v_max3_f32 v95, v95, v40, v41
    v_max3_f32 v94, v94, v42, v43
    v_max3_f32 v95, v95, v44, v45
    v_mfma_f32_32x32x16_bf16 v[0:15], v[68:71], v[76:79], v[0:15]
    v_max3_f32 v94, v94, v46, v47
    v_max_f32 v94, v94, v95
    v_cmp_gt_f32 vcc, v94, v90
    s_cbranch_vccz AT_nors_6
    v_mov_b32 v95, v94
    s_nop 1
    v_permlane32_swap_b32 v94, v95
    s_nop 1
    v_max_f32 v94, v94, v95
    v_max_f32 v94, v94, v85
    v_mov_b32 v85, 0
    v_mov_b32 v90, 0x41000000
    v_add_f32 v84, v84, v94
    v_min_f32 v95, 0, v94
    v_sub_f32 v95, v95, v94
    v_exp_f32 v95, v95
    v_sub_f32 v32, v32, v94
    v_sub_f32 v33, v33, v94
    v_sub_f32 v34, v34, v94
    v_sub_f32 v35, v35, v94
    v_sub_f32 v36, v36, v94
    v_sub_f32 v37, v37, v94
    v_sub_f32 v38, v38, v94
    v_sub_f32 v39, v39, v94
    v_sub_f32 v40, v40, v94
    v_sub_f32 v41, v41, v94
    v_sub_f32 v42, v42, v94
    v_sub_f32 v43, v43, v94
    v_sub_f32 v44, v44, v94
    v_sub_f32 v45, v45, v94
    v_sub_f32 v46, v46, v94
    v_sub_f32 v47, v47, v94
    v_sub_f32 v96, 0, v84
    v_cvt_pk_bf16_f32 v97, v96, v96
    v_and_b32 v97, 0xffff0000, v97
    v_sub_f32 v96, v96, v97
    v_cvt_pk_bf16_f32 v98, v96, v96
    v_and_b32 v98, 0xffff0000, v98
    v_sub_f32 v96, v96, v98
    v_cvt_pk_bf16_f32 v96, v96, v96
    v_and_b32 v96, 0xffff, v96
    v_lshrrev_b32 v97, 16, v97
    v_or_b32 v97, v97, v98
    v_cndmask_b32 v54, 0, v97, s[48:49]
    v_cndmask_b32 v55, 0, v96, s[48:49]
    s_nop 15
    v_mul_f32 v0, v0, v95
    v_mul_f32 v1, v1, v95
    v_mul_f32 v2, v2, v95
    v_mul_f32 v3, v3, v95
    v_mul_f32 v4, v4, v95
    v_mul_f32 v5, v5, v95
    v_mul_f32 v6, v6, v95
    v_mul_f32 v7, v7, v95
    v_mul_f32 v8, v8, v95
    v_mul_f32 v9, v9, v95
    v_mul_f32 v10, v10, v95
    v_mul_f32 v11, v11, v95
AT_nors_6:
    ds_read_b128 v[64:67], v80 offset:10240
    ds_read_b128 v[68:71], v81 offset:10240
    s_waitcnt lgkmcnt(2)
    v_mfma_f32_32x32x16_bf16 v[16:31], v[56:59], v[48:51], 0
    v_exp_f32 v32, v32
    v_exp_f32 v33, v33
    v_exp_f32 v34, v34
    v_exp_f32 v35, v35
    v_exp_f32 v36, v36
    v_exp_f32 v37, v37
    v_mfma_f32_32x32x16_bf16 v[16:31], v[60:63], v[52:55], v[16:31]
    v_exp_f32 v38, v38
    v_exp_f32 v39, v39
    v_exp_f32 v40, v40
    v_exp_f32 v41, v41
    v_exp_f32 v42, v42
    v_exp_f32 v43, v43
    v_cvt_pk_bf16_f32 v72, v32, v33
    v_cvt_pk_bf16_f32 v73, v34, v35
    v_cvt_pk_bf16_f32 v74, v36, v37
    ds_read_b128 v[56:59], v80 offset:6144
    ds_read_b128 v[60:63], v81 offset:6144
    v_exp_f32 v44, v44
    v_exp_f32 v45, v45
    v_exp_f32 v46, v46
    v_exp_f32 v47, v47
    v_cvt_pk_bf16_f32 v75, v38, v39
    v_cvt_pk_bf16_f32 v76, v40, v41
    v_cvt_pk_bf16_f32 v77, v42, v43
    v_cvt_pk_bf16_f32 v78, v44, v45
    v_cvt_pk_bf16_f32 v79, v46, v47
    s_nop 0
    s_waitcnt lgkmcnt(2)
    v_mfma_f32_32x32x16_bf16 v[0:15], v[64:67], v[72:75], v[0:15]
    v_max3_f32 v94, v16, v17, v18
    v_max3_f32 v95, v19, v20, v21
    v_max3_f32 v94, v94, v22, v23
    v_max3_f32 v95, v95, v24, v25
    v_max3_f32 v94, v94, v26, v27
    v_max3_f32 v95, v95, v28, v29
    v_mfma_f32_32x32x16_bf16 v[0:15], v[68:71], v[76:79], v[0:15]
    v_max3_f32 v94, v94, v30, v31
    v_max_f32 v94, v94, v95
    v_cmp_gt_f32 vcc, v94, v90
    s_cbranch_vccz AT_nors_8
    v_mov_b32 v95, v94
    s_nop 1
    v_permlane32_swap_b32 v94, v95
    s_nop 1
    v_max_f32 v94, v94, v95
    v_max_f32 v94, v94, v85
    v_mov_b32 v85, 0
    v_mov_b32 v90, 0x41000000
    v_add_f32 v84, v84, v94
    v_min_f32 v95, 0, v94
    v_sub_f32 v95, v95, v94
    v_exp_f32 v95, v95
    v_sub_f32 v16, v16, v94
    v_sub_f32 v17, v17, v94
    v_sub_f32 v18, v18, v94
    v_sub_f32 v19, v19, v94
    v_sub_f32 v20, v20, v94
    v_sub_f32 v21, v21, v94
    v_sub_f32 v22, v22, v94
    v_sub_f32 v23, v23, v94
    v_sub_f32 v24, v24, v94
    v_sub_f32 v25, v25, v94
    v_sub_f32 v26, v26, v94
    v_sub_f32 v27, v27, v94
    v_sub_f32 v28, v28, v94
    v_sub_f32 v29, v29, v94
    v_sub_f32 v30, v30, v94
    v_sub_f32 v31, v31, v94
    v_sub_f32 v96, 0, v84
    v_cvt_pk_bf16_f32 v97, v96, v96
    v_and_b32 v97, 0xffff0000, v97
    v_sub_f32 v96, v96, v97
    v_cvt_pk_bf16_f32 v98, v96, v96
    v_and_b32 v98, 0xffff0000, v98
    v_sub_f32 v96, v96, v98
    v_cvt_pk_bf16_f32 v96, v96, v96
    v_and_b32 v96, 0xffff, v96
    v_lshrrev_b32 v97, 16, v97
    v_or_b32 v97, v97, v98
    v_cndmask_b32 v54, 0, v97, s[48:49]
    v_cndmask_b32 v55, 0, v96, s[48:49]
    s_nop 15
    v_mul_f32 v0, v0, v95
    v_mul_f32 v1, v1, v95
    v_mul_f32 v2, v2, v95
    v_mul_f32 v3, v3, v95
    v_mul_f32 v4, v4, v95
    v_mul_f32 v5, v5, v95
    v_mul_f32 v6, v6, v95
    v_mul_f32 v7, v7, v95
    v_mul_f32 v8, v8, v95
    v_mul_f32 v9, v9, v95
    v_mul_f32 v10, v10, v95
    v_mul_f32 v11, v11, v95
AT_nors_8:
    ds_read_b128 v[64:67], v80 offset:12288
    ds_read_b128 v[68:71], v81 offset:12288
    s_waitcnt lgkmcnt(2)
    v_mfma_f32_32x32x16_bf16 v[32:47], v[56:59], v[48:51], 0
    v_exp_f32 v16, v16
    v_exp_f32 v17, v17
    v_exp_f32 v18, v18
    v_exp_f32 v19, v19
    v_exp_f32 v20, v20
    v_exp_f32 v21, v21
    v_mfma_f32_32x32x16_bf16 v[32:47], v[60:63], v[52:55], v[32:47]
    v_exp_f32 v22, v22
    v_exp_f32 v23, v23
    v_exp_f32 v24, v24
    v_exp_f32 v25, v25
    v_exp_f32 v26, v26
    v_exp_f32 v27, v27
    v_cvt_pk_bf16_f32 v72, v16, v17
    v_cvt_pk_bf16_f32 v73, v18, v19
    v_cvt_pk_bf16_f32 v74, v20, v21
    ds_read_b128 v[56:59], v82 offset:0
    ds_read_b128 v[60:63], v83 offset:0
    v_exp_f32 v28, v28
    v_exp_f32 v29, v29
    v_exp_f32 v30, v30
    v_exp_f32 v31, v31
    v_cvt_pk_bf16_f32 v75, v22, v23
    v_cvt_pk_bf16_f32 v76, v24, v25
    v_cvt_pk_bf16_f32 v77, v26, v27
    v_cvt_pk_bf16_f32 v78, v28, v29
    v_cvt_pk_bf16_f32 v79, v30, v31
    s_nop 0
    s_waitcnt lgkmcnt(2)
    v_mfma_f32_32x32x16_bf16 v[0:15], v[64:67], v[72:75], v[0:15]
    v_max3_f32 v94, v32, v33, v34
    v_max3_f32 v95, v35, v36, v37
    v_max3_f32 v94, v94, v38, v39
    v_max3_f32 v95, v95, v40, v41
    v_max3_f32 v94, v94, v42, v43
    v_max3_f32 v95, v95, v44, v45
    v_mfma_f32_32x32x16_bf16 v[0:15], v[68:71], v[76:79], v[0:15]
    v_max3_f32 v94, v94, v46, v47
    v_max_f32 v94, v94, v95
    v_cmp_gt_f32 vcc, v94, v90
    s_cbranch_vccz AT_nors_9
    v_mov_b32 v95, v94
    s_nop 1
    v_permlane32_swap_b32 v94, v95
    s_nop 1
    v_max_f32 v94, v94, v95
    v_max_f32 v94, v94, v85
    v_mov_b32 v85, 0
    v_mov_b32 v90, 0x41000000
    v_add_f32 v84, v84, v94
    v_min_f32 v95, 0, v94
    v_sub_f32 v95, v95, v94
    v_exp_f32 v95, v95
    v_sub_f32 v32, v32, v94
    v_sub_f32 v33, v33, v94
    v_sub_f32 v34, v34, v94
    v_sub_f32 v35, v35, v94
    v_sub_f32 v36, v36, v94
    v_sub_f32 v37, v37, v94
    v_sub_f32 v38, v38, v94
    v_sub_f32 v39, v39, v94
    v_sub_f32 v40, v40, v94
    v_sub_f32 v41, v41, v94
    v_sub_f32 v42, v42, v94
    v_sub_f32 v43, v43, v94
    v_sub_f32 v44, v44, v94
    v_sub_f32 v45, v45, v94
    v_sub_f32 v46, v46, v94
    v_sub_f32 v47, v47, v94
    v_sub_f32 v96, 0, v84
    v_cvt_pk_bf16_f32 v97, v96, v96
    v_and_b32 v97, 0xffff0000, v97
    v_sub_f32 v96, v96, v97
    v_cvt_pk_bf16_f32 v98, v96, v96
    v_and_b32 v98, 0xffff0000, v98
    v_sub_f32 v96, v96, v98
    v_cvt_pk_bf16_f32 v96, v96, v96
    v_and_b32 v96, 0xffff, v96
    v_lshrrev_b32 v97, 16, v97
    v_or_b32 v97, v97, v98
    v_cndmask_b32 v54, 0, v97, s[48:49]
    v_cndmask_b32 v55, 0, v96, s[48:49]
    s_nop 15
    v_mul_f32 v0, v0, v95
    v_mul_f32 v1, v1, v95
    v_mul_f32 v2, v2, v95
    v_mul_f32 v3, v3, v95
    v_mul_f32 v4, v4, v95
    v_mul_f32 v5, v5, v95
    v_mul_f32 v6, v6, v95
    v_mul_f32 v7, v7, v95
    v_mul_f32 v8, v8, v95
    v_mul_f32 v9, v9, v95
    v_mul_f32 v10, v10, v95
    v_mul_f32 v11, v11, v95
AT_nors_9:
    ds_read_b128 v[64:67], v80 offset:14336
    ds_read_b128 v[68:71], v81 offset:14336
    s_waitcnt lgkmcnt(2)
    v_mfma_f32_32x32x16_bf16 v[16:31], v[56:59], v[48:51], 0
    v_exp_f32 v32, v32
    v_exp_f32 v33, v33
    v_exp_f32 v34, v34
    v_exp_f32 v35, v35
    v_exp_f32 v36, v36
    v_exp_f32 v37, v37
    v_mfma_f32_32x32x16_bf16 v[16:31], v[60:63], v[52:55], v[16:31]
    v_exp_f32 v38, v38
    v_exp_f32 v39, v39
    v_exp_f32 v40, v40
    v_exp_f32 v41, v41
    v_exp_f32 v42, v42
    v_exp_f32 v43, v43
    v_cvt_pk_bf16_f32 v72, v32, v33
    v_cvt_pk_bf16_f32 v73, v34, v35
    v_cvt_pk_bf16_f32 v74, v36, v37
    ds_read_b128 v[56:59], v82 offset:2048
    ds_read_b128 v[60:63], v83 offset:2048
    v_exp_f32 v44, v44
    v_exp_f32 v45, v45
    v_exp_f32 v46, v46
    v_exp_f32 v47, v47
    v_cvt_pk_bf16_f32 v75, v38, v39
    v_cvt_pk_bf16_f32 v76, v40, v41
    v_cvt_pk_bf16_f32 v77, v42, v43
    v_cvt_pk_bf16_f32 v78, v44, v45
    v_cvt_pk_bf16_f32 v79, v46, v47
    s_nop 0
    s_mov_b32 s43, s44
    s_mov_b32 s44, s45
    s_mov_b32 s45, s46
    s_mov_b32 s46, s43
    v_mov_b32 v80, v82
    v_mov_b32 v81, v83
    v_add_u32 v82, s45, v88
    v_add_u32 v83, s45, v89
    s_add_u32 s40, s40, 1
    s_cmp_lt_u32 s40, 16
    s_cbranch_scc1 AT_loop
    s_waitcnt lgkmcnt(0)
    v_mfma_f32_32x32x16_bf16 v[0:15], v[64:67], v[72:75], v[0:15]
    v_mfma_f32_32x32x16_bf16 v[0:15], v[68:71], v[76:79], v[0:15]
    s_nop 15
    s_nop 3
    v_mov_b32 v94, v8
    v_mov_b32 v95, v8
    s_nop 1
    v_permlane32_swap_b32 v94, v95
    s_nop 1
    v_cndmask_b32 v94, v8, v95, s[48:49]
    v_rcp_f32 v94, v94
    s_nop 0
    v_mul_f32 v0, v0, v94
    v_mul_f32 v1, v1, v94
    v_mul_f32 v2, v2, v94
    v_mul_f32 v3, v3, v94
    v_mul_f32 v4, v4, v94
    v_mul_f32 v5, v5, v94
    v_mul_f32 v6, v6, v94
    v_mul_f32 v7, v7, v94
    v_mul_f32 v8, v8, v94
    v_mul_f32 v9, v9, v94
    v_mul_f32 v10, v10, v94
    v_mul_f32 v11, v11, v94
    v_and_b32 v95, 31, v87
    v_add_u32 v95, s36, v95
    v_mul_u32_u24 v95, 1280, v95
    s_mul_i32 s37, s34, 40
    v_lshrrev_b32 v96, 5, v87
    v_lshlrev_b32 v96, 3, v96
    v_add3_u32 v95, v95, v96, s37
    v_cvt_pk_bf16_f32 v96, v0, v1
    v_cvt_pk_bf16_f32 v97, v2, v3
    buffer_store_dwordx2 v[96:97], v95, s[20:23], 0 offen offset:0
    v_cvt_pk_bf16_f32 v96, v4, v5
    v_cvt_pk_bf16_f32 v97, v6, v7
    buffer_store_dwordx2 v[96:97], v95, s[20:23], 0 offen offset:16
    v_cvt_pk_bf16_f32 v96, v8, v9
    v_cvt_pk_bf16_f32 v97, v10, v11
    s_mov_b64 exec, s[48:49]
    buffer_store_dwordx2 v[96:97], v95, s[20:23], 0 offen offset:32
    s_branch AT_done
AT_gemm:
    s_load_dwordx2 s[4:5], s[0:1], 48
    s_load_dwordx2 s[6:7], s[0:1], 72
    s_sub_u32 s2, s2, 256
    s_and_b32 s34, s2, 15
    s_lshr_b32 s35, s2, 4
    s_mul_i32 s58, s35, 52
    s_lshr_b32 s58, s58, 8
    s_mul_i32 s33, s58, 5
    s_sub_u32 s35, s35, s33
    v_mov_b32 v64, v0
    v_and_b32 v66, 63, v0
    v_lshrrev_b32 v67, 6, v0
    s_nop 0
    v_readfirstlane_b32 s30, v67
    s_nop 3
    s_lshr_b32 s31, s30, 1
    s_and_b32 s32, s30, 1
    v_and_b32 v68, 31, v66
    s_mul_i32 s33, s31, 32
    v_add_u32 v68, s33, v68
    v_lshrrev_b32 v69, 5, v66
    v_bfe_u32 v70, v66, 2, 2
    v_xor_b32 v69, v69, v70
    v_lshlrev_b32 v69, 4, v69
    v_lshl_add_u32 v56, v68, 6, v69
    v_xor_b32 v57, 32, v56
    v_lshrrev_b32 v68, 5, v66
    v_lshlrev_b32 v68, 3, v68
    v_bfe_u32 v69, v66, 2, 2
    v_add_u32 v68, v68, v69
    v_mul_u32_u24 v68, 256, v68
    s_lshl_b32 s33, s32, 1
    v_xor_b32 v69, s33, v69
    v_lshl_add_u32 v68, v69, 6, v68
    v_bfe_u32 v69, v66, 4, 1
    v_lshl_add_u32 v68, v69, 5, v68
    v_and_b32 v69, 3, v66
    v_lshl_add_u32 v68, v69, 3, v68
    v_add_u32 v58, 8192, v68
    v_xor_b32 v59, 64, v58
    s_mul_i32 s28, s30, 1024
    s_mul_i32 s24, s30, 1
    s_add_u32 s24, s24, 0
    s_lshl_b32 s36, s34, 7
    s_lshl_b32 s37, s35, 8
    s_waitcnt lgkmcnt(0)
    s_add_u32 s16, s6, 16777216
    s_addc_u32 s17, s7, 0
    s_mul_i32 s33, s58, 1152
    s_add_u32 s16, s16, s33
    s_addc_u32 s17, s17, 0
    s_mul_i32 s33, s58, 737280
    s_add_u32 s4, s4, s33
    s_addc_u32 s5, s5, 0
    s_mov_b32 s40, 64
    s_mov_b32 s41, 0
    s_mov_b32 s42, 40960
    s_mov_b32 s43, 0
    v_lshrrev_b32 v68, 2, v66
    s_mul_i32 s33, s30, 16
    s_add_u32 s33, s33, s36
    v_add_u32 v68, s33, v68
    s_mov_b32 s33, 3456
    v_mul_lo_u32 v68, v68, s33
    v_and_b32 v69, 3, v66
    v_bfe_u32 v70, v66, 4, 2
    v_xor_b32 v69, v69, v70
    v_lshl_add_u32 v68, v69, 4, v68
    v_mov_b32 v61, s17
    v_add_co_u32 v60, vcc, s16, v68
    s_nop 1
    v_addc_co_u32 v61, vcc, 0, v61, vcc
    v_lshrrev_b32 v68, 4, v66
    v_bfe_u32 v69, v66, 2, 2
    v_xor_b32 v69, v69, v68
    s_lshl_b32 s33, s24, 2
    v_add_u32 v68, s33, v68
    v_and_b32 v70, 3, v66
    s_mov_b32 s33, 1280
    v_mul_lo_u32 v68, v68, s33
    v_lshl_add_u32 v68, v69, 6, v68
    v_lshl_add_u32 v68, v70, 4, v68
    v_add_u32 v68, s37, v68
    v_mov_b32 v63, s5
    v_add_co_u32 v62, vcc, s4, v68
    s_nop 1
    v_addc_co_u32 v63, vcc, 0, v63, vcc
    s_lshl_b32 s24, s24, 10
    s_add_u32 s24, s24, 8192
    v_mov_b32 v0, 0
    v_mov_b32 v1, 0
    v_mov_b32 v2, 0
    v_mov_b32 v3, 0
    v_mov_b32 v4, 0
    v_mov_b32 v5, 0
    v_mov_b32 v6, 0
    v_mov_b32 v7, 0
    v_mov_b32 v8, 0
    v_mov_b32 v9, 0
    v_mov_b32 v10, 0
    v_mov_b32 v11, 0
    v_mov_b32 v12, 0
    v_mov_b32 v13, 0
    v_mov_b32 v14, 0
    v_mov_b32 v15, 0
    v_mov_b32 v16, 0
    v_mov_b32 v17, 0
    v_mov_b32 v18, 0
    v_mov_b32 v19, 0
    v_mov_b32 v20, 0
    v_mov_b32 v21, 0
    v_mov_b32 v22, 0
    v_mov_b32 v23, 0
    v_mov_b32 v24, 0
    v_mov_b32 v25, 0
    v_mov_b32 v26, 0
    v_mov_b32 v27, 0
    v_mov_b32 v28, 0
    v_mov_b32 v29, 0
    v_mov_b32 v30, 0
    v_mov_b32 v31, 0
    s_add_u32 m0, s28, 0
    s_nop 0
    global_load_lds_dwordx4 v[60:61], off
    v_lshl_add_u64 v[60:61], v[60:61], 0, s[40:41]
    s_add_u32 m0, s24, 0
    s_nop 0
    global_load_lds_dwordx4 v[62:63], off
    v_lshl_add_u64 v[62:63], v[62:63], 0, s[42:43]
    s_add_u32 m0, s28, 16384
    s_nop 0
    global_load_lds_dwordx4 v[60:61], off
    v_lshl_add_u64 v[60:61], v[60:61], 0, s[40:41]
    s_add_u32 m0, s24, 16384
    s_nop 0
    global_load_lds_dwordx4 v[62:63], off
    v_lshl_add_u64 v[62:63], v[62:63], 0, s[42:43]
    s_add_u32 m0, s28, 32768
    s_nop 0
    global_load_lds_dwordx4 v[60:61], off
    v_lshl_add_u64 v[60:61], v[60:61], 0, s[40:41]
    s_add_u32 m0, s24, 32768
    s_nop 0
    global_load_lds_dwordx4 v[62:63], off
    v_lshl_add_u64 v[62:63], v[62:63], 0, s[42:43]
    s_waitcnt vmcnt(4)
    s_barrier
    ds_read_b128 v[32:35], v56 offset:0
    ds_read_b64_tr_b16 v[40:41], v58 offset:0
    ds_read_b64_tr_b16 v[42:43], v58 offset:1024
    ds_read_b64_tr_b16 v[44:45], v59 offset:0
    ds_read_b64_tr_b16 v[46:47], v59 offset:1024
    ds_read_b128 v[36:39], v57 offset:0
    ds_read_b64_tr_b16 v[48:49], v58 offset:4096
    ds_read_b64_tr_b16 v[50:51], v58 offset:5120
    ds_read_b64_tr_b16 v[52:53], v59 offset:4096
    ds_read_b64_tr_b16 v[54:55], v59 offset:5120
    s_add_u32 m0, s28, 49152
    s_nop 0
    global_load_lds_dwordx4 v[60:61], off
    v_lshl_add_u64 v[60:61], v[60:61], 0, s[40:41]
    s_add_u32 m0, s24, 49152
    s_nop 0
    global_load_lds_dwordx4 v[62:63], off
    v_lshl_add_u64 v[62:63], v[62:63], 0, s[42:43]
    s_waitcnt lgkmcnt(5)
    v_mfma_f32_32x32x16_bf16 v[0:15], v[40:43], v[32:35], v[0:15]
    v_mfma_f32_32x32x16_bf16 v[16:31], v[44:47], v[32:35], v[16:31]
    s_waitcnt lgkmcnt(0)
    v_mfma_f32_32x32x16_bf16 v[0:15], v[48:51], v[36:39], v[0:15]
    v_mfma_f32_32x32x16_bf16 v[16:31], v[52:55], v[36:39], v[16:31]
    s_waitcnt vmcnt(4)
    s_barrier
    ds_read_b128 v[32:35], v56 offset:16384
    ds_read_b64_tr_b16 v[40:41], v58 offset:16384
    ds_read_b64_tr_b16 v[42:43], v58 offset:17408
    ds_read_b64_tr_b16 v[44:45], v59 offset:16384
    ds_read_b64_tr_b16 v[46:47], v59 offset:17408
    ds_read_b128 v[36:39], v57 offset:16384
    ds_read_b64_tr_b16 v[48:49], v58 offset:20480
    ds_read_b64_tr_b16 v[50:51], v58 offset:21504
    ds_read_b64_tr_b16 v[52:53], v59 offset:20480
    ds_read_b64_tr_b16 v[54:55], v59 offset:21504
    s_add_u32 m0, s28, 0
    s_nop 0
    global_load_lds_dwordx4 v[60:61], off
    v_lshl_add_u64 v[60:61], v[60:61], 0, s[40:41]
    s_add_u32 m0, s24, 0
    s_nop 0
    global_load_lds_dwordx4 v[62:63], off
    v_lshl_add_u64 v[62:63], v[62:63], 0, s[42:43]
    s_waitcnt lgkmcnt(5)
    v_mfma_f32_32x32x16_bf16 v[0:15], v[40:43], v[32:35], v[0:15]
    v_mfma_f32_32x32x16_bf16 v[16:31], v[44:47], v[32:35], v[16:31]
    s_waitcnt lgkmcnt(0)
    v_mfma_f32_32x32x16_bf16 v[0:15], v[48:51], v[36:39], v[0:15]
    v_mfma_f32_32x32x16_bf16 v[16:31], v[52:55], v[36:39], v[16:31]
    s_waitcnt vmcnt(4)
    s_barrier
    ds_read_b128 v[32:35], v56 offset:32768
    ds_read_b64_tr_b16 v[40:41], v58 offset:32768
    ds_read_b64_tr_b16 v[42:43], v58 offset:33792
    ds_read_b64_tr_b16 v[44:45], v59 offset:32768
    ds_read_b64_tr_b16 v[46:47], v59 offset:33792
    ds_read_b128 v[36:39], v57 offset:32768
    ds_read_b64_tr_b16 v[48:49], v58 offset:36864
    ds_read_b64_tr_b16 v[50:51], v58 offset:37888
    ds_read_b64_tr_b16 v[52:53], v59 offset:36864
    ds_read_b64_tr_b16 v[54:55], v59 offset:37888
    s_add_u32 m0, s28, 16384
    s_nop 0
    global_load_lds_dwordx4 v[60:61], off
    v_lshl_add_u64 v[60:61], v[60:61], 0, s[40:41]
    s_add_u32 m0, s24, 16384
    s_nop 0
    global_load_lds_dwordx4 v[62:63], off
    v_lshl_add_u64 v[62:63], v[62:63], 0, s[42:43]
    s_waitcnt lgkmcnt(5)
    v_mfma_f32_32x32x16_bf16 v[0:15], v[40:43], v[32:35], v[0:15]
    v_mfma_f32_32x32x16_bf16 v[16:31], v[44:47], v[32:35], v[16:31]
    s_waitcnt lgkmcnt(0)
    v_mfma_f32_32x32x16_bf16 v[0:15], v[48:51], v[36:39], v[0:15]
    v_mfma_f32_32x32x16_bf16 v[16:31], v[52:55], v[36:39], v[16:31]
    s_waitcnt vmcnt(4)
    s_barrier
    ds_read_b128 v[32:35], v56 offset:49152
    ds_read_b64_tr_b16 v[40:41], v58 offset:49152
    ds_read_b64_tr_b16 v[42:43], v58 offset:50176
    ds_read_b64_tr_b16 v[44:45], v59 offset:49152
    ds_read_b64_tr_b16 v[46:47], v59 offset:50176
    ds_read_b128 v[36:39], v57 offset:49152
    ds_read_b64_tr_b16 v[48:49], v58 offset:53248
    ds_read_b64_tr_b16 v[50:51], v58 offset:54272
    ds_read_b64_tr_b16 v[52:53], v59 offset:53248
    ds_read_b64_tr_b16 v[54:55], v59 offset:54272
    s_add_u32 m0, s28, 32768
    s_nop 0
    global_load_lds_dwordx4 v[60:61], off
    v_lshl_add_u64 v[60:61], v[60:61], 0, s[40:41]
    s_add_u32 m0, s24, 32768
    s_nop 0
    global_load_lds_dwordx4 v[62:63], off
    v_lshl_add_u64 v[62:63], v[62:63], 0, s[42:43]
    s_waitcnt lgkmcnt(5)
    v_mfma_f32_32x32x16_bf16 v[0:15], v[40:43], v[32:35], v[0:15]
    v_mfma_f32_32x32x16_bf16 v[16:31], v[44:47], v[32:35], v[16:31]
    s_waitcnt lgkmcnt(0)
    v_mfma_f32_32x32x16_bf16 v[0:15], v[48:51], v[36:39], v[0:15]
    v_mfma_f32_32x32x16_bf16 v[16:31], v[52:55], v[36:39], v[16:31]
    s_waitcnt vmcnt(4)
    s_barrier
    ds_read_b128 v[32:35], v56 offset:0
    ds_read_b64_tr_b16 v[40:41], v58 offset:0
    ds_read_b64_tr_b16 v[42:43], v58 offset:1024
    ds_read_b64_tr_b16 v[44:45], v59 offset:0
    ds_read_b64_tr_b16 v[46:47], v59 offset:1024
    ds_read_b128 v[36:39], v57 offset:0
    ds_read_b64_tr_b16 v[48:49], v58 offset:4096
    ds_read_b64_tr_b16 v[50:51], v58 offset:5120
    ds_read_b64_tr_b16 v[52:53], v59 offset:4096
    ds_read_b64_tr_b16 v[54:55], v59 offset:5120
    s_add_u32 m0, s28, 49152
    s_nop 0
    global_load_lds_dwordx4 v[60:61], off
    v_lshl_add_u64 v[60:61], v[60:61], 0, s[40:41]
    s_add_u32 m0, s24, 49152
    s_nop 0
    global_load_lds_dwordx4 v[62:63], off
    v_lshl_add_u64 v[62:63], v[62:63], 0, s[42:43]
    s_waitcnt lgkmcnt(5)
    v_mfma_f32_32x32x16_bf16 v[0:15], v[40:43], v[32:35], v[0:15]
    v_mfma_f32_32x32x16_bf16 v[16:31], v[44:47], v[32:35], v[16:31]
    s_waitcnt lgkmcnt(0)
    v_mfma_f32_32x32x16_bf16 v[0:15], v[48:51], v[36:39], v[0:15]
    v_mfma_f32_32x32x16_bf16 v[16:31], v[52:55], v[36:39], v[16:31]
    s_waitcnt vmcnt(4)
    s_barrier
    ds_read_b128 v[32:35], v56 offset:16384
    ds_read_b64_tr_b16 v[40:41], v58 offset:16384
    ds_read_b64_tr_b16 v[42:43], v58 offset:17408
    ds_read_b64_tr_b16 v[44:45], v59 offset:16384
    ds_read_b64_tr_b16 v[46:47], v59 offset:17408
    ds_read_b128 v[36:39], v57 offset:16384
    ds_read_b64_tr_b16 v[48:49], v58 offset:20480
    ds_read_b64_tr_b16 v[50:51], v58 offset:21504
    ds_read_b64_tr_b16 v[52:53], v59 offset:20480
    ds_read_b64_tr_b16 v[54:55], v59 offset:21504
    s_add_u32 m0, s28, 0
    s_nop 0
    global_load_lds_dwordx4 v[60:61], off
    v_lshl_add_u64 v[60:61], v[60:61], 0, s[40:41]
    s_add_u32 m0, s24, 0
    s_nop 0
    global_load_lds_dwordx4 v[62:63], off
    v_lshl_add_u64 v[62:63], v[62:63], 0, s[42:43]
    s_waitcnt lgkmcnt(5)
    v_mfma_f32_32x32x16_bf16 v[0:15], v[40:43], v[32:35], v[0:15]
    v_mfma_f32_32x32x16_bf16 v[16:31], v[44:47], v[32:35], v[16:31]
    s_waitcnt lgkmcnt(0)
    v_mfma_f32_32x32x16_bf16 v[0:15], v[48:51], v[36:39], v[0:15]
    v_mfma_f32_32x32x16_bf16 v[16:31], v[52:55], v[36:39], v[16:31]
    s_waitcnt vmcnt(4)
    s_barrier
    ds_read_b128 v[32:35], v56 offset:32768
    ds_read_b64_tr_b16 v[40:41], v58 offset:32768
    ds_read_b64_tr_b16 v[42:43], v58 offset:33792
    ds_read_b64_tr_b16 v[44:45], v59 offset:32768
    ds_read_b64_tr_b16 v[46:47], v59 offset:33792
    ds_read_b128 v[36:39], v57 offset:32768
    ds_read_b64_tr_b16 v[48:49], v58 offset:36864
    ds_read_b64_tr_b16 v[50:51], v58 offset:37888
    ds_read_b64_tr_b16 v[52:53], v59 offset:36864
    ds_read_b64_tr_b16 v[54:55], v59 offset:37888
    s_add_u32 m0, s28, 16384
    s_nop 0
    global_load_lds_dwordx4 v[60:61], off
    v_lshl_add_u64 v[60:61], v[60:61], 0, s[40:41]
    s_add_u32 m0, s24, 16384
    s_nop 0
    global_load_lds_dwordx4 v[62:63], off
    v_lshl_add_u64 v[62:63], v[62:63], 0, s[42:43]
    s_waitcnt lgkmcnt(5)
    v_mfma_f32_32x32x16_bf16 v[0:15], v[40:43], v[32:35], v[0:15]
    v_mfma_f32_32x32x16_bf16 v[16:31], v[44:47], v[32:35], v[16:31]
    s_waitcnt lgkmcnt(0)
    v_mfma_f32_32x32x16_bf16 v[0:15], v[48:51], v[36:39], v[0:15]
    v_mfma_f32_32x32x16_bf16 v[16:31], v[52:55], v[36:39], v[16:31]
    s_waitcnt vmcnt(4)
    s_barrier
    ds_read_b128 v[32:35], v56 offset:49152
    ds_read_b64_tr_b16 v[40:41], v58 offset:49152
    ds_read_b64_tr_b16 v[42:43], v58 offset:50176
    ds_read_b64_tr_b16 v[44:45], v59 offset:49152
    ds_read_b64_tr_b16 v[46:47], v59 offset:50176
    ds_read_b128 v[36:39], v57 offset:49152
    ds_read_b64_tr_b16 v[48:49], v58 offset:53248
    ds_read_b64_tr_b16 v[50:51], v58 offset:54272
    ds_read_b64_tr_b16 v[52:53], v59 offset:53248
    ds_read_b64_tr_b16 v[54:55], v59 offset:54272
    s_add_u32 m0, s28, 32768
    s_nop 0
    global_load_lds_dwordx4 v[60:61], off
    v_lshl_add_u64 v[60:61], v[60:61], 0, s[40:41]
    s_add_u32 m0, s24, 32768
    s_nop 0
    global_load_lds_dwordx4 v[62:63], off
    v_lshl_add_u64 v[62:63], v[62:63], 0, s[42:43]
    s_waitcnt lgkmcnt(5)
    v_mfma_f32_32x32x16_bf16 v[0:15], v[40:43], v[32:35], v[0:15]
    v_mfma_f32_32x32x16_bf16 v[16:31], v[44:47], v[32:35], v[16:31]
    s_waitcnt lgkmcnt(0)
    v_mfma_f32_32x32x16_bf16 v[0:15], v[48:51], v[36:39], v[0:15]
    v_mfma_f32_32x32x16_bf16 v[16:31], v[52:55], v[36:39], v[16:31]
    s_waitcnt vmcnt(4)
    s_barrier
    ds_read_b128 v[32:35], v56 offset:0
    ds_read_b64_tr_b16 v[40:41], v58 offset:0
    ds_read_b64_tr_b16 v[42:43], v58 offset:1024
    ds_read_b64_tr_b16 v[44:45], v59 offset:0
    ds_read_b64_tr_b16 v[46:47], v59 offset:1024
    ds_read_b128 v[36:39], v57 offset:0
    ds_read_b64_tr_b16 v[48:49], v58 offset:4096
    ds_read_b64_tr_b16 v[50:51], v58 offset:5120
    ds_read_b64_tr_b16 v[52:53], v59 offset:4096
    ds_read_b64_tr_b16 v[54:55], v59 offset:5120
    s_add_u32 m0, s28, 49152
    s_nop 0
    global_load_lds_dwordx4 v[60:61], off
    v_lshl_add_u64 v[60:61], v[60:61], 0, s[40:41]
    s_add_u32 m0, s24, 49152
    s_nop 0
    global_load_lds_dwordx4 v[62:63], off
    v_lshl_add_u64 v[62:63], v[62:63], 0, s[42:43]
    s_waitcnt lgkmcnt(5)
    v_mfma_f32_32x32x16_bf16 v[0:15], v[40:43], v[32:35], v[0:15]
    v_mfma_f32_32x32x16_bf16 v[16:31], v[44:47], v[32:35], v[16:31]
    s_waitcnt lgkmcnt(0)
    v_mfma_f32_32x32x16_bf16 v[0:15], v[48:51], v[36:39], v[0:15]
    v_mfma_f32_32x32x16_bf16 v[16:31], v[52:55], v[36:39], v[16:31]
    s_waitcnt vmcnt(4)
    s_barrier
    ds_read_b128 v[32:35], v56 offset:16384
    ds_read_b64_tr_b16 v[40:41], v58 offset:16384
    ds_read_b64_tr_b16 v[42:43], v58 offset:17408
    ds_read_b64_tr_b16 v[44:45], v59 offset:16384
    ds_read_b64_tr_b16 v[46:47], v59 offset:17408
    ds_read_b128 v[36:39], v57 offset:16384
    ds_read_b64_tr_b16 v[48:49], v58 offset:20480
    ds_read_b64_tr_b16 v[50:51], v58 offset:21504
    ds_read_b64_tr_b16 v[52:53], v59 offset:20480
    ds_read_b64_tr_b16 v[54:55], v59 offset:21504
    s_add_u32 m0, s28, 0
    s_nop 0
    global_load_lds_dwordx4 v[60:61], off
    v_lshl_add_u64 v[60:61], v[60:61], 0, s[40:41]
    s_add_u32 m0, s24, 0
    s_nop 0
    global_load_lds_dwordx4 v[62:63], off
    v_lshl_add_u64 v[62:63], v[62:63], 0, s[42:43]
    s_waitcnt lgkmcnt(5)
    v_mfma_f32_32x32x16_bf16 v[0:15], v[40:43], v[32:35], v[0:15]
    v_mfma_f32_32x32x16_bf16 v[16:31], v[44:47], v[32:35], v[16:31]
    s_waitcnt lgkmcnt(0)
    v_mfma_f32_32x32x16_bf16 v[0:15], v[48:51], v[36:39], v[0:15]
    v_mfma_f32_32x32x16_bf16 v[16:31], v[52:55], v[36:39], v[16:31]
    s_waitcnt vmcnt(4)
    s_barrier
    ds_read_b128 v[32:35], v56 offset:32768
    ds_read_b64_tr_b16 v[40:41], v58 offset:32768
    ds_read_b64_tr_b16 v[42:43], v58 offset:33792
    ds_read_b64_tr_b16 v[44:45], v59 offset:32768
    ds_read_b64_tr_b16 v[46:47], v59 offset:33792
    ds_read_b128 v[36:39], v57 offset:32768
    ds_read_b64_tr_b16 v[48:49], v58 offset:36864
    ds_read_b64_tr_b16 v[50:51], v58 offset:37888
    ds_read_b64_tr_b16 v[52:53], v59 offset:36864
    ds_read_b64_tr_b16 v[54:55], v59 offset:37888
    s_add_u32 m0, s28, 16384
    s_nop 0
    global_load_lds_dwordx4 v[60:61], off
    v_lshl_add_u64 v[60:61], v[60:61], 0, s[40:41]
    s_add_u32 m0, s24, 16384
    s_nop 0
    global_load_lds_dwordx4 v[62:63], off
    v_lshl_add_u64 v[62:63], v[62:63], 0, s[42:43]
    s_waitcnt lgkmcnt(5)
    v_mfma_f32_32x32x16_bf16 v[0:15], v[40:43], v[32:35], v[0:15]
    v_mfma_f32_32x32x16_bf16 v[16:31], v[44:47], v[32:35], v[16:31]
    s_waitcnt lgkmcnt(0)
    v_mfma_f32_32x32x16_bf16 v[0:15], v[48:51], v[36:39], v[0:15]
    v_mfma_f32_32x32x16_bf16 v[16:31], v[52:55], v[36:39], v[16:31]
    s_waitcnt vmcnt(4)
    s_barrier
    ds_read_b128 v[32:35], v56 offset:49152
    ds_read_b64_tr_b16 v[40:41], v58 offset:49152
    ds_read_b64_tr_b16 v[42:43], v58 offset:50176
    ds_read_b64_tr_b16 v[44:45], v59 offset:49152
    ds_read_b64_tr_b16 v[46:47], v59 offset:50176
    ds_read_b128 v[36:39], v57 offset:49152
    ds_read_b64_tr_b16 v[48:49], v58 offset:53248
    ds_read_b64_tr_b16 v[50:51], v58 offset:54272
    ds_read_b64_tr_b16 v[52:53], v59 offset:53248
    ds_read_b64_tr_b16 v[54:55], v59 offset:54272
    s_add_u32 m0, s28, 32768
    s_nop 0
    global_load_lds_dwordx4 v[60:61], off
    v_lshl_add_u64 v[60:61], v[60:61], 0, s[40:41]
    s_add_u32 m0, s24, 32768
    s_nop 0
    global_load_lds_dwordx4 v[62:63], off
    v_lshl_add_u64 v[62:63], v[62:63], 0, s[42:43]
    s_waitcnt lgkmcnt(5)
    v_mfma_f32_32x32x16_bf16 v[0:15], v[40:43], v[32:35], v[0:15]
    v_mfma_f32_32x32x16_bf16 v[16:31], v[44:47], v[32:35], v[16:31]
    s_waitcnt lgkmcnt(0)
    v_mfma_f32_32x32x16_bf16 v[0:15], v[48:51], v[36:39], v[0:15]
    v_mfma_f32_32x32x16_bf16 v[16:31], v[52:55], v[36:39], v[16:31]
    s_waitcnt vmcnt(4)
    s_barrier
    ds_read_b128 v[32:35], v56 offset:0
    ds_read_b64_tr_b16 v[40:41], v58 offset:0
    ds_read_b64_tr_b16 v[42:43], v58 offset:1024
    ds_read_b64_tr_b16 v[44:45], v59 offset:0
    ds_read_b64_tr_b16 v[46:47], v59 offset:1024
    ds_read_b128 v[36:39], v57 offset:0
    ds_read_b64_tr_b16 v[48:49], v58 offset:4096
    ds_read_b64_tr_b16 v[50:51], v58 offset:5120
    ds_read_b64_tr_b16 v[52:53], v59 offset:4096
    ds_read_b64_tr_b16 v[54:55], v59 offset:5120
    s_add_u32 m0, s28, 49152
    s_nop 0
    global_load_lds_dwordx4 v[60:61], off
    v_lshl_add_u64 v[60:61], v[60:61], 0, s[40:41]
    s_add_u32 m0, s24, 49152
    s_nop 0
    global_load_lds_dwordx4 v[62:63], off
    v_lshl_add_u64 v[62:63], v[62:63], 0, s[42:43]
    s_waitcnt lgkmcnt(5)
    v_mfma_f32_32x32x16_bf16 v[0:15], v[40:43], v[32:35], v[0:15]
    v_mfma_f32_32x32x16_bf16 v[16:31], v[44:47], v[32:35], v[16:31]
    s_waitcnt lgkmcnt(0)
    v_mfma_f32_32x32x16_bf16 v[0:15], v[48:51], v[36:39], v[0:15]
    v_mfma_f32_32x32x16_bf16 v[16:31], v[52:55], v[36:39], v[16:31]
    s_waitcnt vmcnt(4)
    s_barrier
    ds_read_b128 v[32:35], v56 offset:16384
    ds_read_b64_tr_b16 v[40:41], v58 offset:16384
    ds_read_b64_tr_b16 v[42:43], v58 offset:17408
    ds_read_b64_tr_b16 v[44:45], v59 offset:16384
    ds_read_b64_tr_b16 v[46:47], v59 offset:17408
    ds_read_b128 v[36:39], v57 offset:16384
    ds_read_b64_tr_b16 v[48:49], v58 offset:20480
    ds_read_b64_tr_b16 v[50:51], v58 offset:21504
    ds_read_b64_tr_b16 v[52:53], v59 offset:20480
    ds_read_b64_tr_b16 v[54:55], v59 offset:21504
    s_add_u32 m0, s28, 0
    s_nop 0
    global_load_lds_dwordx4 v[60:61], off
    v_lshl_add_u64 v[60:61], v[60:61], 0, s[40:41]
    s_add_u32 m0, s24, 0
    s_nop 0
    global_load_lds_dwordx4 v[62:63], off
    v_lshl_add_u64 v[62:63], v[62:63], 0, s[42:43]
    s_waitcnt lgkmcnt(5)
    v_mfma_f32_32x32x16_bf16 v[0:15], v[40:43], v[32:35], v[0:15]
    v_mfma_f32_32x32x16_bf16 v[16:31], v[44:47], v[32:35], v[16:31]
    s_waitcnt lgkmcnt(0)
    v_mfma_f32_32x32x16_bf16 v[0:15], v[48:51], v[36:39], v[0:15]
    v_mfma_f32_32x32x16_bf16 v[16:31], v[52:55], v[36:39], v[16:31]
    s_waitcnt vmcnt(4)
    s_barrier
    ds_read_b128 v[32:35], v56 offset:32768
    ds_read_b64_tr_b16 v[40:41], v58 offset:32768
    ds_read_b64_tr_b16 v[42:43], v58 offset:33792
    ds_read_b64_tr_b16 v[44:45], v59 offset:32768
    ds_read_b64_tr_b16 v[46:47], v59 offset:33792
    ds_read_b128 v[36:39], v57 offset:32768
    ds_read_b64_tr_b16 v[48:49], v58 offset:36864
    ds_read_b64_tr_b16 v[50:51], v58 offset:37888
    ds_read_b64_tr_b16 v[52:53], v59 offset:36864
    ds_read_b64_tr_b16 v[54:55], v59 offset:37888
    s_add_u32 m0, s28, 16384
    s_nop 0
    global_load_lds_dwordx4 v[60:61], off
    v_lshl_add_u64 v[60:61], v[60:61], 0, s[40:41]
    s_add_u32 m0, s24, 16384
    s_nop 0
    global_load_lds_dwordx4 v[62:63], off
    v_lshl_add_u64 v[62:63], v[62:63], 0, s[42:43]
    s_waitcnt lgkmcnt(5)
    v_mfma_f32_32x32x16_bf16 v[0:15], v[40:43], v[32:35], v[0:15]
    v_mfma_f32_32x32x16_bf16 v[16:31], v[44:47], v[32:35], v[16:31]
    s_waitcnt lgkmcnt(0)
    v_mfma_f32_32x32x16_bf16 v[0:15], v[48:51], v[36:39], v[0:15]
    v_mfma_f32_32x32x16_bf16 v[16:31], v[52:55], v[36:39], v[16:31]
    s_waitcnt vmcnt(4)
    s_barrier
    ds_read_b128 v[32:35], v56 offset:49152
    ds_read_b64_tr_b16 v[40:41], v58 offset:49152
    ds_read_b64_tr_b16 v[42:43], v58 offset:50176
    ds_read_b64_tr_b16 v[44:45], v59 offset:49152
    ds_read_b64_tr_b16 v[46:47], v59 offset:50176
    ds_read_b128 v[36:39], v57 offset:49152
    ds_read_b64_tr_b16 v[48:49], v58 offset:53248
    ds_read_b64_tr_b16 v[50:51], v58 offset:54272
    ds_read_b64_tr_b16 v[52:53], v59 offset:53248
    ds_read_b64_tr_b16 v[54:55], v59 offset:54272
    s_waitcnt lgkmcnt(5)
    v_mfma_f32_32x32x16_bf16 v[0:15], v[40:43], v[32:35], v[0:15]
    v_mfma_f32_32x32x16_bf16 v[16:31], v[44:47], v[32:35], v[16:31]
    s_waitcnt lgkmcnt(0)
    v_mfma_f32_32x32x16_bf16 v[0:15], v[48:51], v[36:39], v[0:15]
    v_mfma_f32_32x32x16_bf16 v[16:31], v[52:55], v[36:39], v[16:31]
    s_waitcnt vmcnt(2)
    s_barrier
    ds_read_b128 v[32:35], v56 offset:0
    ds_read_b64_tr_b16 v[40:41], v58 offset:0
    ds_read_b64_tr_b16 v[42:43], v58 offset:1024
    ds_read_b64_tr_b16 v[44:45], v59 offset:0
    ds_read_b64_tr_b16 v[46:47], v59 offset:1024
    ds_read_b128 v[36:39], v57 offset:0
    ds_read_b64_tr_b16 v[48:49], v58 offset:4096
    ds_read_b64_tr_b16 v[50:51], v58 offset:5120
    ds_read_b64_tr_b16 v[52:53], v59 offset:4096
    ds_read_b64_tr_b16 v[54:55], v59 offset:5120
    s_waitcnt lgkmcnt(5)
    v_mfma_f32_32x32x16_bf16 v[0:15], v[40:43], v[32:35], v[0:15]
    v_mfma_f32_32x32x16_bf16 v[16:31], v[44:47], v[32:35], v[16:31]
    s_waitcnt lgkmcnt(0)
    v_mfma_f32_32x32x16_bf16 v[0:15], v[48:51], v[36:39], v[0:15]
    v_mfma_f32_32x32x16_bf16 v[16:31], v[52:55], v[36:39], v[16:31]
    s_waitcnt vmcnt(0)
    s_barrier
    ds_read_b128 v[32:35], v56 offset:16384
    ds_read_b64_tr_b16 v[40:41], v58 offset:16384
    ds_read_b64_tr_b16 v[42:43], v58 offset:17408
    ds_read_b64_tr_b16 v[44:45], v59 offset:16384
    ds_read_b64_tr_b16 v[46:47], v59 offset:17408
    ds_read_b128 v[36:39], v57 offset:16384
    ds_read_b64_tr_b16 v[48:49], v58 offset:20480
    ds_read_b64_tr_b16 v[50:51], v58 offset:21504
    ds_read_b64_tr_b16 v[52:53], v59 offset:20480
    ds_read_b64_tr_b16 v[54:55], v59 offset:21504
    s_waitcnt lgkmcnt(5)
    v_mfma_f32_32x32x16_bf16 v[0:15], v[40:43], v[32:35], v[0:15]
    v_mfma_f32_32x32x16_bf16 v[16:31], v[44:47], v[32:35], v[16:31]
    s_waitcnt lgkmcnt(0)
    v_mfma_f32_32x32x16_bf16 v[0:15], v[48:51], v[36:39], v[0:15]
    v_mfma_f32_32x32x16_bf16 v[16:31], v[52:55], v[36:39], v[16:31]
    s_barrier
    s_nop 15
    v_and_b32 v68, 31, v66
    s_lshl_b32 s39, s31, 5
    v_add_u32 v68, s39, v68
    v_mul_u32_u24 v68, 528, v68
    s_lshl_b32 s39, s32, 8
    v_lshrrev_b32 v69, 5, v66
    v_lshlrev_b32 v69, 4, v69
    v_add3_u32 v68, v68, v69, s39
    ds_write_b128 v68, v[0:3] offset:0
    ds_write_b128 v68, v[4:7] offset:32
    ds_write_b128 v68, v[8:11] offset:64
    ds_write_b128 v68, v[12:15] offset:96
    ds_write_b128 v68, v[16:19] offset:128
    ds_write_b128 v68, v[20:23] offset:160
    ds_write_b128 v68, v[24:27] offset:192
    ds_write_b128 v68, v[28:31] offset:224
    s_add_u32 s44, s6, 33554432
    s_addc_u32 s45, s7, 0
    s_mul_i32 s33, s58, 5242880
    s_add_u32 s44, s44, s33
    s_addc_u32 s45, s45, 0
    s_mov_b32 s46, 5242880
    s_mov_b32 s47, 0x00020000
    v_lshrrev_b32 v68, 5, v64
    v_and_b32 v69, 31, v64
    v_lshlrev_b32 v69, 4, v69
    v_mul_u32_u24 v70, 528, v68
    v_add_u32 v70, v70, v69
    v_add_u32 v68, s36, v68
    v_mul_u32_u24 v68, 2560, v68
    s_lshl_b32 s37, s37, 1
    v_add3_u32 v68, v68, v69, s37
    s_waitcnt lgkmcnt(0)
    s_barrier
    ds_read_b128 v[0:3], v70 offset:0
    ds_read_b128 v[4:7], v70 offset:8448
    ds_read_b128 v[8:11], v70 offset:16896
    ds_read_b128 v[12:15], v70 offset:25344
    ds_read_b128 v[16:19], v70 offset:33792
    ds_read_b128 v[20:23], v70 offset:42240
    ds_read_b128 v[24:27], v70 offset:50688
    ds_read_b128 v[28:31], v70 offset:59136
    s_mov_b32 s39, 0
    s_waitcnt lgkmcnt(7)
    buffer_store_dwordx4 v[0:3], v68, s[44:47], s39 offen
    s_mov_b32 s39, 40960
    s_waitcnt lgkmcnt(6)
    buffer_store_dwordx4 v[4:7], v68, s[44:47], s39 offen
    s_mov_b32 s39, 81920
    s_waitcnt lgkmcnt(5)
    buffer_store_dwordx4 v[8:11], v68, s[44:47], s39 offen
    s_mov_b32 s39, 122880
    s_waitcnt lgkmcnt(4)
    buffer_store_dwordx4 v[12:15], v68, s[44:47], s39 offen
    s_mov_b32 s39, 163840
    s_waitcnt lgkmcnt(3)
    buffer_store_dwordx4 v[16:19], v68, s[44:47], s39 offen
    s_mov_b32 s39, 204800
    s_waitcnt lgkmcnt(2)
    buffer_store_dwordx4 v[20:23], v68, s[44:47], s39 offen
    s_mov_b32 s39, 245760
    s_waitcnt lgkmcnt(1)
    buffer_store_dwordx4 v[24:27], v68, s[44:47], s39 offen
    s_mov_b32 s39, 286720
    s_waitcnt lgkmcnt(0)
    buffer_store_dwordx4 v[28:31], v68, s[44:47], s39 offen
AT_done:
    s_endpgm
.globl gemm2_kernel
.p2align 8
.type gemm2_kernel,@function
gemm2_kernel:
    s_cmp_ge_u32 s2, 160
    s_cbranch_scc1 G2_done
    s_load_dwordx2 s[4:5], s[0:1], 16
    s_load_dwordx2 s[8:9], s[0:1], 48
    s_load_dwordx2 s[10:11], s[0:1], 0
    s_load_dwordx2 s[12:13], s[0:1], 56
    s_load_dwordx2 s[6:7], s[0:1], 72
    s_and_b32 s34, s2, 7
    s_lshr_b32 s35, s2, 3
    s_mul_i32 s33, s34, 4
    s_and_b32 s34, s35, 3
    s_add_u32 s34, s34, s33
    s_lshr_b32 s35, s35, 2
    v_mov_b32 v66, v0
    v_and_b32 v68, 63, v0
    v_lshrrev_b32 v69, 6, v0
    s_nop 0
    v_readfirstlane_b32 s30, v69
    s_nop 3
    s_lshr_b32 s31, s30, 1
    s_and_b32 s32, s30, 1
    v_and_b32 v70, 31, v68
    s_mul_i32 s33, s31, 32
    v_add_u32 v70, s33, v70
    v_lshrrev_b32 v71, 5, v68
    v_bfe_u32 v72, v68, 2, 2
    v_xor_b32 v71, v71, v72
    v_lshlrev_b32 v71, 4, v71
    v_lshl_add_u32 v56, v70, 6, v71
    v_xor_b32 v57, 32, v56
    v_lshrrev_b32 v70, 5, v68
    v_lshlrev_b32 v70, 3, v70
    v_bfe_u32 v71, v68, 2, 2
    v_add_u32 v70, v70, v71
    v_mul_u32_u24 v70, 256, v70
    s_lshl_b32 s33, s32, 1
    v_xor_b32 v71, s33, v71
    v_lshl_add_u32 v70, v71, 6, v70
    v_bfe_u32 v71, v68, 4, 1
    v_lshl_add_u32 v70, v71, 5, v70
    v_and_b32 v71, 3, v68
    v_lshl_add_u32 v70, v71, 3, v70
    v_add_u32 v58, 4096, v70
    v_xor_b32 v59, 64, v58
    s_mul_i32 s28, s30, 1024
    s_mul_i32 s24, s30, 2
    s_add_u32 s24, s24, 0
    s_mul_i32 s25, s30, 2
    s_add_u32 s25, s25, 1
    s_mul_i32 s36, s34, 64
    s_mul_i32 s37, s35, 256
    s_waitcnt lgkmcnt(0)
    s_add_u32 s14, s6, 25165824
    s_addc_u32 s15, s7, 0
    s_add_u32 s16, s6, 16777216
    s_addc_u32 s17, s7, 0
    s_mov_b32 s40, 64
    s_mov_b32 s41, 0
    s_mov_b32 s42, 40960
    s_mov_b32 s43, 0
    v_lshrrev_b32 v70, 2, v68
    s_mul_i32 s33, s30, 16
    s_add_u32 s33, s33, s36
    v_add_u32 v70, s33, v70
    s_mov_b32 s33, 1280
    v_mul_lo_u32 v70, v70, s33
    v_and_b32 v71, 3, v68
    v_bfe_u32 v72, v68, 4, 2
    v_xor_b32 v71, v71, v72
    v_lshl_add_u32 v70, v71, 4, v70
    v_mov_b32 v61, s15
    v_add_co_u32 v60, vcc, s14, v70
    s_nop 1
    v_addc_co_u32 v61, vcc, 0, v61, vcc
    v_lshrrev_b32 v70, 4, v68
    v_bfe_u32 v71, v68, 2, 2
    v_xor_b32 v71, v71, v70
    s_lshl_b32 s33, s24, 2
    v_add_u32 v70, s33, v70
    v_and_b32 v72, 3, v68
    s_mov_b32 s33, 1280
    v_mul_lo_u32 v70, v70, s33
    v_lshl_add_u32 v70, v71, 6, v70
    v_lshl_add_u32 v70, v72, 4, v70
    v_add_u32 v70, s37, v70
    v_mov_b32 v63, s5
    v_add_co_u32 v62, vcc, s4, v70
    s_nop 1
    v_addc_co_u32 v63, vcc, 0, v63, vcc
    v_lshrrev_b32 v70, 4, v68
    v_bfe_u32 v71, v68, 2, 2
    v_xor_b32 v71, v71, v70
    s_lshl_b32 s33, s25, 2
    v_add_u32 v70, s33, v70
    v_and_b32 v72, 3, v68
    s_mov_b32 s33, 1280
    v_mul_lo_u32 v70, v70, s33
    v_lshl_add_u32 v70, v71, 6, v70
    v_lshl_add_u32 v70, v72, 4, v70
    v_add_u32 v70, s37, v70
    v_mov_b32 v65, s5
    v_add_co_u32 v64, vcc, s4, v70
    s_nop 1
    v_addc_co_u32 v65, vcc, 0, v65, vcc
    s_lshl_b32 s24, s24, 10
    s_add_u32 s24, s24, 4096
    s_lshl_b32 s25, s25, 10
    s_add_u32 s25, s25, 4096
    v_mov_b32 v0, 0
    v_mov_b32 v1, 0
    v_mov_b32 v2, 0
    v_mov_b32 v3, 0
    v_mov_b32 v4, 0
    v_mov_b32 v5, 0
    v_mov_b32 v6, 0
    v_mov_b32 v7, 0
    v_mov_b32 v8, 0
    v_mov_b32 v9, 0
    v_mov_b32 v10, 0
    v_mov_b32 v11, 0
    v_mov_b32 v12, 0
    v_mov_b32 v13, 0
    v_mov_b32 v14, 0
    v_mov_b32 v15, 0
    v_mov_b32 v16, 0
    v_mov_b32 v17, 0
    v_mov_b32 v18, 0
    v_mov_b32 v19, 0
    v_mov_b32 v20, 0
    v_mov_b32 v21, 0
    v_mov_b32 v22, 0
    v_mov_b32 v23, 0
    v_mov_b32 v24, 0
    v_mov_b32 v25, 0
    v_mov_b32 v26, 0
    v_mov_b32 v27, 0
    v_mov_b32 v28, 0
    v_mov_b32 v29, 0
    v_mov_b32 v30, 0
    v_mov_b32 v31, 0
    s_add_u32 m0, s28, 0
    s_nop 0
    global_load_lds_dwordx4 v[60:61], off
    v_lshl_add_u64 v[60:61], v[60:61], 0, s[40:41]
    s_add_u32 m0, s24, 0
    s_nop 0
    global_load_lds_dwordx4 v[62:63], off
    v_lshl_add_u64 v[62:63], v[62:63], 0, s[42:43]
    s_add_u32 m0, s25, 0
    s_nop 0
    global_load_lds_dwordx4 v[64:65], off
    v_lshl_add_u64 v[64:65], v[64:65], 0, s[42:43]
    s_add_u32 m0, s28, 12288
    s_nop 0
    global_load_lds_dwordx4 v[60:61], off
    v_lshl_add_u64 v[60:61], v[60:61], 0, s[40:41]
    s_add_u32 m0, s24, 12288
    s_nop 0
    global_load_lds_dwordx4 v[62:63], off
    v_lshl_add_u64 v[62:63], v[62:63], 0, s[42:43]
    s_add_u32 m0, s25, 12288
    s_nop 0
    global_load_lds_dwordx4 v[64:65], off
    v_lshl_add_u64 v[64:65], v[64:65], 0, s[42:43]
    s_add_u32 m0, s28, 24576
    s_nop 0
    global_load_lds_dwordx4 v[60:61], off
    v_lshl_add_u64 v[60:61], v[60:61], 0, s[40:41]
    s_add_u32 m0, s24, 24576
    s_nop 0
    global_load_lds_dwordx4 v[62:63], off
    v_lshl_add_u64 v[62:63], v[62:63], 0, s[42:43]
    s_add_u32 m0, s25, 24576
    s_nop 0
    global_load_lds_dwordx4 v[64:65], off
    v_lshl_add_u64 v[64:65], v[64:65], 0, s[42:43]
    s_waitcnt vmcnt(6)
    s_barrier
    ds_read_b128 v[32:35], v56 offset:0
    ds_read_b64_tr_b16 v[40:41], v58 offset:0
    ds_read_b64_tr_b16 v[42:43], v58 offset:1024
    ds_read_b64_tr_b16 v[44:45], v59 offset:0
    ds_read_b64_tr_b16 v[46:47], v59 offset:1024
    ds_read_b128 v[36:39], v57 offset:0
    ds_read_b64_tr_b16 v[48:49], v58 offset:4096
    ds_read_b64_tr_b16 v[50:51], v58 offset:5120
    ds_read_b64_tr_b16 v[52:53], v59 offset:4096
    ds_read_b64_tr_b16 v[54:55], v59 offset:5120
    s_add_u32 m0, s28, 36864
    s_nop 0
    global_load_lds_dwordx4 v[60:61], off
    v_lshl_add_u64 v[60:61], v[60:61], 0, s[40:41]
    s_add_u32 m0, s24, 36864
    s_nop 0
    global_load_lds_dwordx4 v[62:63], off
    v_lshl_add_u64 v[62:63], v[62:63], 0, s[42:43]
    s_add_u32 m0, s25, 36864
    s_nop 0
    global_load_lds_dwordx4 v[64:65], off
    v_lshl_add_u64 v[64:65], v[64:65], 0, s[42:43]
    s_waitcnt lgkmcnt(5)
    v_mfma_f32_32x32x16_bf16 v[0:15], v[40:43], v[32:35], v[0:15]
    v_mfma_f32_32x32x16_bf16 v[16:31], v[44:47], v[32:35], v[16:31]
    s_waitcnt lgkmcnt(0)
    v_mfma_f32_32x32x16_bf16 v[0:15], v[48:51], v[36:39], v[0:15]
    v_mfma_f32_32x32x16_bf16 v[16:31], v[52:55], v[36:39], v[16:31]
    s_waitcnt vmcnt(6)
    s_barrier
    ds_read_b128 v[32:35], v56 offset:12288
    ds_read_b64_tr_b16 v[40:41], v58 offset:12288
    ds_read_b64_tr_b16 v[42:43], v58 offset:13312
    ds_read_b64_tr_b16 v[44:45], v59 offset:12288
    ds_read_b64_tr_b16 v[46:47], v59 offset:13312
    ds_read_b128 v[36:39], v57 offset:12288
    ds_read_b64_tr_b16 v[48:49], v58 offset:16384
    ds_read_b64_tr_b16 v[50:51], v58 offset:17408
    ds_read_b64_tr_b16 v[52:53], v59 offset:16384
    ds_read_b64_tr_b16 v[54:55], v59 offset:17408
    s_add_u32 m0, s28, 0
    s_nop 0
    global_load_lds_dwordx4 v[60:61], off
    v_lshl_add_u64 v[60:61], v[60:61], 0, s[40:41]
    s_add_u32 m0, s24, 0
    s_nop 0
    global_load_lds_dwordx4 v[62:63], off
    v_lshl_add_u64 v[62:63], v[62:63], 0, s[42:43]
    s_add_u32 m0, s25, 0
    s_nop 0
    global_load_lds_dwordx4 v[64:65], off
    v_lshl_add_u64 v[64:65], v[64:65], 0, s[42:43]
    s_waitcnt lgkmcnt(5)
    v_mfma_f32_32x32x16_bf16 v[0:15], v[40:43], v[32:35], v[0:15]
    v_mfma_f32_32x32x16_bf16 v[16:31], v[44:47], v[32:35], v[16:31]
    s_waitcnt lgkmcnt(0)
    v_mfma_f32_32x32x16_bf16 v[0:15], v[48:51], v[36:39], v[0:15]
    v_mfma_f32_32x32x16_bf16 v[16:31], v[52:55], v[36:39], v[16:31]
    s_waitcnt vmcnt(6)
    s_barrier
    ds_read_b128 v[32:35], v56 offset:24576
    ds_read_b64_tr_b16 v[40:41], v58 offset:24576
    ds_read_b64_tr_b16 v[42:43], v58 offset:25600
    ds_read_b64_tr_b16 v[44:45], v59 offset:24576
    ds_read_b64_tr_b16 v[46:47], v59 offset:25600
    ds_read_b128 v[36:39], v57 offset:24576
    ds_read_b64_tr_b16 v[48:49], v58 offset:28672
    ds_read_b64_tr_b16 v[50:51], v58 offset:29696
    ds_read_b64_tr_b16 v[52:53], v59 offset:28672
    ds_read_b64_tr_b16 v[54:55], v59 offset:29696
    s_add_u32 m0, s28, 12288
    s_nop 0
    global_load_lds_dwordx4 v[60:61], off
    v_lshl_add_u64 v[60:61], v[60:61], 0, s[40:41]
    s_add_u32 m0, s24, 12288
    s_nop 0
    global_load_lds_dwordx4 v[62:63], off
    v_lshl_add_u64 v[62:63], v[62:63], 0, s[42:43]
    s_add_u32 m0, s25, 12288
    s_nop 0
    global_load_lds_dwordx4 v[64:65], off
    v_lshl_add_u64 v[64:65], v[64:65], 0, s[42:43]
    s_waitcnt lgkmcnt(5)
    v_mfma_f32_32x32x16_bf16 v[0:15], v[40:43], v[32:35], v[0:15]
    v_mfma_f32_32x32x16_bf16 v[16:31], v[44:47], v[32:35], v[16:31]
    s_waitcnt lgkmcnt(0)
    v_mfma_f32_32x32x16_bf16 v[0:15], v[48:51], v[36:39], v[0:15]
    v_mfma_f32_32x32x16_bf16 v[16:31], v[52:55], v[36:39], v[16:31]
    s_waitcnt vmcnt(6)
    s_barrier
    ds_read_b128 v[32:35], v56 offset:36864
    ds_read_b64_tr_b16 v[40:41], v58 offset:36864
    ds_read_b64_tr_b16 v[42:43], v58 offset:37888
    ds_read_b64_tr_b16 v[44:45], v59 offset:36864
    ds_read_b64_tr_b16 v[46:47], v59 offset:37888
    ds_read_b128 v[36:39], v57 offset:36864
    ds_read_b64_tr_b16 v[48:49], v58 offset:40960
    ds_read_b64_tr_b16 v[50:51], v58 offset:41984
    ds_read_b64_tr_b16 v[52:53], v59 offset:40960
    ds_read_b64_tr_b16 v[54:55], v59 offset:41984
    s_add_u32 m0, s28, 24576
    s_nop 0
    global_load_lds_dwordx4 v[60:61], off
    v_lshl_add_u64 v[60:61], v[60:61], 0, s[40:41]
    s_add_u32 m0, s24, 24576
    s_nop 0
    global_load_lds_dwordx4 v[62:63], off
    v_lshl_add_u64 v[62:63], v[62:63], 0, s[42:43]
    s_add_u32 m0, s25, 24576
    s_nop 0
    global_load_lds_dwordx4 v[64:65], off
    v_lshl_add_u64 v[64:65], v[64:65], 0, s[42:43]
    s_waitcnt lgkmcnt(5)
    v_mfma_f32_32x32x16_bf16 v[0:15], v[40:43], v[32:35], v[0:15]
    v_mfma_f32_32x32x16_bf16 v[16:31], v[44:47], v[32:35], v[16:31]
    s_waitcnt lgkmcnt(0)
    v_mfma_f32_32x32x16_bf16 v[0:15], v[48:51], v[36:39], v[0:15]
    v_mfma_f32_32x32x16_bf16 v[16:31], v[52:55], v[36:39], v[16:31]
    s_waitcnt vmcnt(6)
    s_barrier
    ds_read_b128 v[32:35], v56 offset:0
    ds_read_b64_tr_b16 v[40:41], v58 offset:0
    ds_read_b64_tr_b16 v[42:43], v58 offset:1024
    ds_read_b64_tr_b16 v[44:45], v59 offset:0
    ds_read_b64_tr_b16 v[46:47], v59 offset:1024
    ds_read_b128 v[36:39], v57 offset:0
    ds_read_b64_tr_b16 v[48:49], v58 offset:4096
    ds_read_b64_tr_b16 v[50:51], v58 offset:5120
    ds_read_b64_tr_b16 v[52:53], v59 offset:4096
    ds_read_b64_tr_b16 v[54:55], v59 offset:5120
    s_add_u32 m0, s28, 36864
    s_nop 0
    global_load_lds_dwordx4 v[60:61], off
    v_lshl_add_u64 v[60:61], v[60:61], 0, s[40:41]
    s_add_u32 m0, s24, 36864
    s_nop 0
    global_load_lds_dwordx4 v[62:63], off
    v_lshl_add_u64 v[62:63], v[62:63], 0, s[42:43]
    s_add_u32 m0, s25, 36864
    s_nop 0
    global_load_lds_dwordx4 v[64:65], off
    v_lshl_add_u64 v[64:65], v[64:65], 0, s[42:43]
    s_waitcnt lgkmcnt(5)
    v_mfma_f32_32x32x16_bf16 v[0:15], v[40:43], v[32:35], v[0:15]
    v_mfma_f32_32x32x16_bf16 v[16:31], v[44:47], v[32:35], v[16:31]
    s_waitcnt lgkmcnt(0)
    v_mfma_f32_32x32x16_bf16 v[0:15], v[48:51], v[36:39], v[0:15]
    v_mfma_f32_32x32x16_bf16 v[16:31], v[52:55], v[36:39], v[16:31]
    s_waitcnt vmcnt(6)
    s_barrier
    ds_read_b128 v[32:35], v56 offset:12288
    ds_read_b64_tr_b16 v[40:41], v58 offset:12288
    ds_read_b64_tr_b16 v[42:43], v58 offset:13312
    ds_read_b64_tr_b16 v[44:45], v59 offset:12288
    ds_read_b64_tr_b16 v[46:47], v59 offset:13312
    ds_read_b128 v[36:39], v57 offset:12288
    ds_read_b64_tr_b16 v[48:49], v58 offset:16384
    ds_read_b64_tr_b16 v[50:51], v58 offset:17408
    ds_read_b64_tr_b16 v[52:53], v59 offset:16384
    ds_read_b64_tr_b16 v[54:55], v59 offset:17408
    s_add_u32 m0, s28, 0
    s_nop 0
    global_load_lds_dwordx4 v[60:61], off
    v_lshl_add_u64 v[60:61], v[60:61], 0, s[40:41]
    s_add_u32 m0, s24, 0
    s_nop 0
    global_load_lds_dwordx4 v[62:63], off
    v_lshl_add_u64 v[62:63], v[62:63], 0, s[42:43]
    s_add_u32 m0, s25, 0
    s_nop 0
    global_load_lds_dwordx4 v[64:65], off
    v_lshl_add_u64 v[64:65], v[64:65], 0, s[42:43]
    s_waitcnt lgkmcnt(5)
    v_mfma_f32_32x32x16_bf16 v[0:15], v[40:43], v[32:35], v[0:15]
    v_mfma_f32_32x32x16_bf16 v[16:31], v[44:47], v[32:35], v[16:31]
    s_waitcnt lgkmcnt(0)
    v_mfma_f32_32x32x16_bf16 v[0:15], v[48:51], v[36:39], v[0:15]
    v_mfma_f32_32x32x16_bf16 v[16:31], v[52:55], v[36:39], v[16:31]
    s_waitcnt vmcnt(6)
    s_barrier
    ds_read_b128 v[32:35], v56 offset:24576
    ds_read_b64_tr_b16 v[40:41], v58 offset:24576
    ds_read_b64_tr_b16 v[42:43], v58 offset:25600
    ds_read_b64_tr_b16 v[44:45], v59 offset:24576
    ds_read_b64_tr_b16 v[46:47], v59 offset:25600
    ds_read_b128 v[36:39], v57 offset:24576
    ds_read_b64_tr_b16 v[48:49], v58 offset:28672
    ds_read_b64_tr_b16 v[50:51], v58 offset:29696
    ds_read_b64_tr_b16 v[52:53], v59 offset:28672
    ds_read_b64_tr_b16 v[54:55], v59 offset:29696
    s_add_u32 m0, s28, 12288
    s_nop 0
    global_load_lds_dwordx4 v[60:61], off
    v_lshl_add_u64 v[60:61], v[60:61], 0, s[40:41]
    s_add_u32 m0, s24, 12288
    s_nop 0
    global_load_lds_dwordx4 v[62:63], off
    v_lshl_add_u64 v[62:63], v[62:63], 0, s[42:43]
    s_add_u32 m0, s25, 12288
    s_nop 0
    global_load_lds_dwordx4 v[64:65], off
    v_lshl_add_u64 v[64:65], v[64:65], 0, s[42:43]
    s_waitcnt lgkmcnt(5)
    v_mfma_f32_32x32x16_bf16 v[0:15], v[40:43], v[32:35], v[0:15]
    v_mfma_f32_32x32x16_bf16 v[16:31], v[44:47], v[32:35], v[16:31]
    s_waitcnt lgkmcnt(0)
    v_mfma_f32_32x32x16_bf16 v[0:15], v[48:51], v[36:39], v[0:15]
    v_mfma_f32_32x32x16_bf16 v[16:31], v[52:55], v[36:39], v[16:31]
    s_waitcnt vmcnt(6)
    s_barrier
    ds_read_b128 v[32:35], v56 offset:36864
    ds_read_b64_tr_b16 v[40:41], v58 offset:36864
    ds_read_b64_tr_b16 v[42:43], v58 offset:37888
    ds_read_b64_tr_b16 v[44:45], v59 offset:36864
    ds_read_b64_tr_b16 v[46:47], v59 offset:37888
    ds_read_b128 v[36:39], v57 offset:36864
    ds_read_b64_tr_b16 v[48:49], v58 offset:40960
    ds_read_b64_tr_b16 v[50:51], v58 offset:41984
    ds_read_b64_tr_b16 v[52:53], v59 offset:40960
    ds_read_b64_tr_b16 v[54:55], v59 offset:41984
    s_add_u32 m0, s28, 24576
    s_nop 0
    global_load_lds_dwordx4 v[60:61], off
    v_lshl_add_u64 v[60:61], v[60:61], 0, s[40:41]
    s_add_u32 m0, s24, 24576
    s_nop 0
    global_load_lds_dwordx4 v[62:63], off
    v_lshl_add_u64 v[62:63], v[62:63], 0, s[42:43]
    s_add_u32 m0, s25, 24576
    s_nop 0
    global_load_lds_dwordx4 v[64:65], off
    v_lshl_add_u64 v[64:65], v[64:65], 0, s[42:43]
    s_waitcnt lgkmcnt(5)
    v_mfma_f32_32x32x16_bf16 v[0:15], v[40:43], v[32:35], v[0:15]
    v_mfma_f32_32x32x16_bf16 v[16:31], v[44:47], v[32:35], v[16:31]
    s_waitcnt lgkmcnt(0)
    v_mfma_f32_32x32x16_bf16 v[0:15], v[48:51], v[36:39], v[0:15]
    v_mfma_f32_32x32x16_bf16 v[16:31], v[52:55], v[36:39], v[16:31]
    s_waitcnt vmcnt(6)
    s_barrier
    ds_read_b128 v[32:35], v56 offset:0
    ds_read_b64_tr_b16 v[40:41], v58 offset:0
    ds_read_b64_tr_b16 v[42:43], v58 offset:1024
    ds_read_b64_tr_b16 v[44:45], v59 offset:0
    ds_read_b64_tr_b16 v[46:47], v59 offset:1024
    ds_read_b128 v[36:39], v57 offset:0
    ds_read_b64_tr_b16 v[48:49], v58 offset:4096
    ds_read_b64_tr_b16 v[50:51], v58 offset:5120
    ds_read_b64_tr_b16 v[52:53], v59 offset:4096
    ds_read_b64_tr_b16 v[54:55], v59 offset:5120
    s_add_u32 m0, s28, 36864
    s_nop 0
    global_load_lds_dwordx4 v[60:61], off
    v_lshl_add_u64 v[60:61], v[60:61], 0, s[40:41]
    s_add_u32 m0, s24, 36864
    s_nop 0
    global_load_lds_dwordx4 v[62:63], off
    v_lshl_add_u64 v[62:63], v[62:63], 0, s[42:43]
    s_add_u32 m0, s25, 36864
    s_nop 0
    global_load_lds_dwordx4 v[64:65], off
    v_lshl_add_u64 v[64:65], v[64:65], 0, s[42:43]
    s_waitcnt lgkmcnt(5)
    v_mfma_f32_32x32x16_bf16 v[0:15], v[40:43], v[32:35], v[0:15]
    v_mfma_f32_32x32x16_bf16 v[16:31], v[44:47], v[32:35], v[16:31]
    s_waitcnt lgkmcnt(0)
    v_mfma_f32_32x32x16_bf16 v[0:15], v[48:51], v[36:39], v[0:15]
    v_mfma_f32_32x32x16_bf16 v[16:31], v[52:55], v[36:39], v[16:31]
    s_waitcnt vmcnt(6)
    s_barrier
    ds_read_b128 v[32:35], v56 offset:12288
    ds_read_b64_tr_b16 v[40:41], v58 offset:12288
    ds_read_b64_tr_b16 v[42:43], v58 offset:13312
    ds_read_b64_tr_b16 v[44:45], v59 offset:12288
    ds_read_b64_tr_b16 v[46:47], v59 offset:13312
    ds_read_b128 v[36:39], v57 offset:12288
    ds_read_b64_tr_b16 v[48:49], v58 offset:16384
    ds_read_b64_tr_b16 v[50:51], v58 offset:17408
    ds_read_b64_tr_b16 v[52:53], v59 offset:16384
    ds_read_b64_tr_b16 v[54:55], v59 offset:17408
    s_add_u32 m0, s28, 0
    s_nop 0
    global_load_lds_dwordx4 v[60:61], off
    v_lshl_add_u64 v[60:61], v[60:61], 0, s[40:41]
    s_add_u32 m0, s24, 0
    s_nop 0
    global_load_lds_dwordx4 v[62:63], off
    v_lshl_add_u64 v[62:63], v[62:63], 0, s[42:43]
    s_add_u32 m0, s25, 0
    s_nop 0
    global_load_lds_dwordx4 v[64:65], off
    v_lshl_add_u64 v[64:65], v[64:65], 0, s[42:43]
    s_waitcnt lgkmcnt(5)
    v_mfma_f32_32x32x16_bf16 v[0:15], v[40:43], v[32:35], v[0:15]
    v_mfma_f32_32x32x16_bf16 v[16:31], v[44:47], v[32:35], v[16:31]
    s_waitcnt lgkmcnt(0)
    v_mfma_f32_32x32x16_bf16 v[0:15], v[48:51], v[36:39], v[0:15]
    v_mfma_f32_32x32x16_bf16 v[16:31], v[52:55], v[36:39], v[16:31]
    s_waitcnt vmcnt(6)
    s_barrier
    ds_read_b128 v[32:35], v56 offset:24576
    ds_read_b64_tr_b16 v[40:41], v58 offset:24576
    ds_read_b64_tr_b16 v[42:43], v58 offset:25600
    ds_read_b64_tr_b16 v[44:45], v59 offset:24576
    ds_read_b64_tr_b16 v[46:47], v59 offset:25600
    ds_read_b128 v[36:39], v57 offset:24576
    ds_read_b64_tr_b16 v[48:49], v58 offset:28672
    ds_read_b64_tr_b16 v[50:51], v58 offset:29696
    ds_read_b64_tr_b16 v[52:53], v59 offset:28672
    ds_read_b64_tr_b16 v[54:55], v59 offset:29696
    s_add_u32 m0, s28, 12288
    s_nop 0
    global_load_lds_dwordx4 v[60:61], off
    v_lshl_add_u64 v[60:61], v[60:61], 0, s[40:41]
    s_add_u32 m0, s24, 12288
    s_nop 0
    global_load_lds_dwordx4 v[62:63], off
    v_lshl_add_u64 v[62:63], v[62:63], 0, s[42:43]
    s_add_u32 m0, s25, 12288
    s_nop 0
    global_load_lds_dwordx4 v[64:65], off
    v_lshl_add_u64 v[64:65], v[64:65], 0, s[42:43]
    s_waitcnt lgkmcnt(5)
    v_mfma_f32_32x32x16_bf16 v[0:15], v[40:43], v[32:35], v[0:15]
    v_mfma_f32_32x32x16_bf16 v[16:31], v[44:47], v[32:35], v[16:31]
    s_waitcnt lgkmcnt(0)
    v_mfma_f32_32x32x16_bf16 v[0:15], v[48:51], v[36:39], v[0:15]
    v_mfma_f32_32x32x16_bf16 v[16:31], v[52:55], v[36:39], v[16:31]
    s_waitcnt vmcnt(6)
    s_barrier
    ds_read_b128 v[32:35], v56 offset:36864
    ds_read_b64_tr_b16 v[40:41], v58 offset:36864
    ds_read_b64_tr_b16 v[42:43], v58 offset:37888
    ds_read_b64_tr_b16 v[44:45], v59 offset:36864
    ds_read_b64_tr_b16 v[46:47], v59 offset:37888
    ds_read_b128 v[36:39], v57 offset:36864
    ds_read_b64_tr_b16 v[48:49], v58 offset:40960
    ds_read_b64_tr_b16 v[50:51], v58 offset:41984
    ds_read_b64_tr_b16 v[52:53], v59 offset:40960
    ds_read_b64_tr_b16 v[54:55], v59 offset:41984
    s_add_u32 m0, s28, 24576
    s_nop 0
    global_load_lds_dwordx4 v[60:61], off
    v_lshl_add_u64 v[60:61], v[60:61], 0, s[40:41]
    s_add_u32 m0, s24, 24576
    s_nop 0
    global_load_lds_dwordx4 v[62:63], off
    v_lshl_add_u64 v[62:63], v[62:63], 0, s[42:43]
    s_add_u32 m0, s25, 24576
    s_nop 0
    global_load_lds_dwordx4 v[64:65], off
    v_lshl_add_u64 v[64:65], v[64:65], 0, s[42:43]
    s_waitcnt lgkmcnt(5)
    v_mfma_f32_32x32x16_bf16 v[0:15], v[40:43], v[32:35], v[0:15]
    v_mfma_f32_32x32x16_bf16 v[16:31], v[44:47], v[32:35], v[16:31]
    s_waitcnt lgkmcnt(0)
    v_mfma_f32_32x32x16_bf16 v[0:15], v[48:51], v[36:39], v[0:15]
    v_mfma_f32_32x32x16_bf16 v[16:31], v[52:55], v[36:39], v[16:31]
    s_waitcnt vmcnt(6)
    s_barrier
    ds_read_b128 v[32:35], v56 offset:0
    ds_read_b64_tr_b16 v[40:41], v58 offset:0
    ds_read_b64_tr_b16 v[42:43], v58 offset:1024
    ds_read_b64_tr_b16 v[44:45], v59 offset:0
    ds_read_b64_tr_b16 v[46:47], v59 offset:1024
    ds_read_b128 v[36:39], v57 offset:0
    ds_read_b64_tr_b16 v[48:49], v58 offset:4096
    ds_read_b64_tr_b16 v[50:51], v58 offset:5120
    ds_read_b64_tr_b16 v[52:53], v59 offset:4096
    ds_read_b64_tr_b16 v[54:55], v59 offset:5120
    s_add_u32 m0, s28, 36864
    s_nop 0
    global_load_lds_dwordx4 v[60:61], off
    v_lshl_add_u64 v[60:61], v[60:61], 0, s[40:41]
    s_add_u32 m0, s24, 36864
    s_nop 0
    global_load_lds_dwordx4 v[62:63], off
    v_lshl_add_u64 v[62:63], v[62:63], 0, s[42:43]
    s_add_u32 m0, s25, 36864
    s_nop 0
    global_load_lds_dwordx4 v[64:65], off
    v_lshl_add_u64 v[64:65], v[64:65], 0, s[42:43]
    s_waitcnt lgkmcnt(5)
    v_mfma_f32_32x32x16_bf16 v[0:15], v[40:43], v[32:35], v[0:15]
    v_mfma_f32_32x32x16_bf16 v[16:31], v[44:47], v[32:35], v[16:31]
    s_waitcnt lgkmcnt(0)
    v_mfma_f32_32x32x16_bf16 v[0:15], v[48:51], v[36:39], v[0:15]
    v_mfma_f32_32x32x16_bf16 v[16:31], v[52:55], v[36:39], v[16:31]
    s_waitcnt vmcnt(6)
    s_barrier
    ds_read_b128 v[32:35], v56 offset:12288
    ds_read_b64_tr_b16 v[40:41], v58 offset:12288
    ds_read_b64_tr_b16 v[42:43], v58 offset:13312
    ds_read_b64_tr_b16 v[44:45], v59 offset:12288
    ds_read_b64_tr_b16 v[46:47], v59 offset:13312
    ds_read_b128 v[36:39], v57 offset:12288
    ds_read_b64_tr_b16 v[48:49], v58 offset:16384
    ds_read_b64_tr_b16 v[50:51], v58 offset:17408
    ds_read_b64_tr_b16 v[52:53], v59 offset:16384
    ds_read_b64_tr_b16 v[54:55], v59 offset:17408
    s_add_u32 m0, s28, 0
    s_nop 0
    global_load_lds_dwordx4 v[60:61], off
    v_lshl_add_u64 v[60:61], v[60:61], 0, s[40:41]
    s_add_u32 m0, s24, 0
    s_nop 0
    global_load_lds_dwordx4 v[62:63], off
    v_lshl_add_u64 v[62:63], v[62:63], 0, s[42:43]
    s_add_u32 m0, s25, 0
    s_nop 0
    global_load_lds_dwordx4 v[64:65], off
    v_lshl_add_u64 v[64:65], v[64:65], 0, s[42:43]
    s_waitcnt lgkmcnt(5)
    v_mfma_f32_32x32x16_bf16 v[0:15], v[40:43], v[32:35], v[0:15]
    v_mfma_f32_32x32x16_bf16 v[16:31], v[44:47], v[32:35], v[16:31]
    s_waitcnt lgkmcnt(0)
    v_mfma_f32_32x32x16_bf16 v[0:15], v[48:51], v[36:39], v[0:15]
    v_mfma_f32_32x32x16_bf16 v[16:31], v[52:55], v[36:39], v[16:31]
    s_waitcnt vmcnt(6)
    s_barrier
    ds_read_b128 v[32:35], v56 offset:24576
    ds_read_b64_tr_b16 v[40:41], v58 offset:24576
    ds_read_b64_tr_b16 v[42:43], v58 offset:25600
    ds_read_b64_tr_b16 v[44:45], v59 offset:24576
    ds_read_b64_tr_b16 v[46:47], v59 offset:25600
    ds_read_b128 v[36:39], v57 offset:24576
    ds_read_b64_tr_b16 v[48:49], v58 offset:28672
    ds_read_b64_tr_b16 v[50:51], v58 offset:29696
    ds_read_b64_tr_b16 v[52:53], v59 offset:28672
    ds_read_b64_tr_b16 v[54:55], v59 offset:29696
    s_add_u32 m0, s28, 12288
    s_nop 0
    global_load_lds_dwordx4 v[60:61], off
    v_lshl_add_u64 v[60:61], v[60:61], 0, s[40:41]
    s_add_u32 m0, s24, 12288
    s_nop 0
    global_load_lds_dwordx4 v[62:63], off
    v_lshl_add_u64 v[62:63], v[62:63], 0, s[42:43]
    s_add_u32 m0, s25, 12288
    s_nop 0
    global_load_lds_dwordx4 v[64:65], off
    v_lshl_add_u64 v[64:65], v[64:65], 0, s[42:43]
    s_waitcnt lgkmcnt(5)
    v_mfma_f32_32x32x16_bf16 v[0:15], v[40:43], v[32:35], v[0:15]
    v_mfma_f32_32x32x16_bf16 v[16:31], v[44:47], v[32:35], v[16:31]
    s_waitcnt lgkmcnt(0)
    v_mfma_f32_32x32x16_bf16 v[0:15], v[48:51], v[36:39], v[0:15]
    v_mfma_f32_32x32x16_bf16 v[16:31], v[52:55], v[36:39], v[16:31]
    s_waitcnt vmcnt(6)
    s_barrier
    ds_read_b128 v[32:35], v56 offset:36864
    ds_read_b64_tr_b16 v[40:41], v58 offset:36864
    ds_read_b64_tr_b16 v[42:43], v58 offset:37888
    ds_read_b64_tr_b16 v[44:45], v59 offset:36864
    ds_read_b64_tr_b16 v[46:47], v59 offset:37888
    ds_read_b128 v[36:39], v57 offset:36864
    ds_read_b64_tr_b16 v[48:49], v58 offset:40960
    ds_read_b64_tr_b16 v[50:51], v58 offset:41984
    ds_read_b64_tr_b16 v[52:53], v59 offset:40960
    ds_read_b64_tr_b16 v[54:55], v59 offset:41984
    s_add_u32 m0, s28, 24576
    s_nop 0
    global_load_lds_dwordx4 v[60:61], off
    v_lshl_add_u64 v[60:61], v[60:61], 0, s[40:41]
    s_add_u32 m0, s24, 24576
    s_nop 0
    global_load_lds_dwordx4 v[62:63], off
    v_lshl_add_u64 v[62:63], v[62:63], 0, s[42:43]
    s_add_u32 m0, s25, 24576
    s_nop 0
    global_load_lds_dwordx4 v[64:65], off
    v_lshl_add_u64 v[64:65], v[64:65], 0, s[42:43]
    s_waitcnt lgkmcnt(5)
    v_mfma_f32_32x32x16_bf16 v[0:15], v[40:43], v[32:35], v[0:15]
    v_mfma_f32_32x32x16_bf16 v[16:31], v[44:47], v[32:35], v[16:31]
    s_waitcnt lgkmcnt(0)
    v_mfma_f32_32x32x16_bf16 v[0:15], v[48:51], v[36:39], v[0:15]
    v_mfma_f32_32x32x16_bf16 v[16:31], v[52:55], v[36:39], v[16:31]
    s_waitcnt vmcnt(6)
    s_barrier
    ds_read_b128 v[32:35], v56 offset:0
    ds_read_b64_tr_b16 v[40:41], v58 offset:0
    ds_read_b64_tr_b16 v[42:43], v58 offset:1024
    ds_read_b64_tr_b16 v[44:45], v59 offset:0
    ds_read_b64_tr_b16 v[46:47], v59 offset:1024
    ds_read_b128 v[36:39], v57 offset:0
    ds_read_b64_tr_b16 v[48:49], v58 offset:4096
    ds_read_b64_tr_b16 v[50:51], v58 offset:5120
    ds_read_b64_tr_b16 v[52:53], v59 offset:4096
    ds_read_b64_tr_b16 v[54:55], v59 offset:5120
    s_add_u32 m0, s28, 36864
    s_nop 0
    global_load_lds_dwordx4 v[60:61], off
    v_lshl_add_u64 v[60:61], v[60:61], 0, s[40:41]
    s_add_u32 m0, s24, 36864
    s_nop 0
    global_load_lds_dwordx4 v[62:63], off
    v_lshl_add_u64 v[62:63], v[62:63], 0, s[42:43]
    s_add_u32 m0, s25, 36864
    s_nop 0
    global_load_lds_dwordx4 v[64:65], off
    v_lshl_add_u64 v[64:65], v[64:65], 0, s[42:43]
    s_waitcnt lgkmcnt(5)
    v_mfma_f32_32x32x16_bf16 v[0:15], v[40:43], v[32:35], v[0:15]
    v_mfma_f32_32x32x16_bf16 v[16:31], v[44:47], v[32:35], v[16:31]
    s_waitcnt lgkmcnt(0)
    v_mfma_f32_32x32x16_bf16 v[0:15], v[48:51], v[36:39], v[0:15]
    v_mfma_f32_32x32x16_bf16 v[16:31], v[52:55], v[36:39], v[16:31]
    s_waitcnt vmcnt(6)
    s_barrier
    ds_read_b128 v[32:35], v56 offset:12288
    ds_read_b64_tr_b16 v[40:41], v58 offset:12288
    ds_read_b64_tr_b16 v[42:43], v58 offset:13312
    ds_read_b64_tr_b16 v[44:45], v59 offset:12288
    ds_read_b64_tr_b16 v[46:47], v59 offset:13312
    ds_read_b128 v[36:39], v57 offset:12288
    ds_read_b64_tr_b16 v[48:49], v58 offset:16384
    ds_read_b64_tr_b16 v[50:51], v58 offset:17408
    ds_read_b64_tr_b16 v[52:53], v59 offset:16384
    ds_read_b64_tr_b16 v[54:55], v59 offset:17408
    s_waitcnt lgkmcnt(5)
    v_mfma_f32_32x32x16_bf16 v[0:15], v[40:43], v[32:35], v[0:15]
    v_mfma_f32_32x32x16_bf16 v[16:31], v[44:47], v[32:35], v[16:31]
    s_waitcnt lgkmcnt(0)
    v_mfma_f32_32x32x16_bf16 v[0:15], v[48:51], v[36:39], v[0:15]
    v_mfma_f32_32x32x16_bf16 v[16:31], v[52:55], v[36:39], v[16:31]
    s_waitcnt vmcnt(3)
    s_barrier
    ds_read_b128 v[32:35], v56 offset:24576
    ds_read_b64_tr_b16 v[40:41], v58 offset:24576
    ds_read_b64_tr_b16 v[42:43], v58 offset:25600
    ds_read_b64_tr_b16 v[44:45], v59 offset:24576
    ds_read_b64_tr_b16 v[46:47], v59 offset:25600
    ds_read_b128 v[36:39], v57 offset:24576
    ds_read_b64_tr_b16 v[48:49], v58 offset:28672
    ds_read_b64_tr_b16 v[50:51], v58 offset:29696
    ds_read_b64_tr_b16 v[52:53], v59 offset:28672
    ds_read_b64_tr_b16 v[54:55], v59 offset:29696
    s_waitcnt lgkmcnt(5)
    v_mfma_f32_32x32x16_bf16 v[0:15], v[40:43], v[32:35], v[0:15]
    v_mfma_f32_32x32x16_bf16 v[16:31], v[44:47], v[32:35], v[16:31]
    s_waitcnt lgkmcnt(0)
    v_mfma_f32_32x32x16_bf16 v[0:15], v[48:51], v[36:39], v[0:15]
    v_mfma_f32_32x32x16_bf16 v[16:31], v[52:55], v[36:39], v[16:31]
    s_waitcnt vmcnt(0)
    s_barrier
    ds_read_b128 v[32:35], v56 offset:36864
    ds_read_b64_tr_b16 v[40:41], v58 offset:36864
    ds_read_b64_tr_b16 v[42:43], v58 offset:37888
    ds_read_b64_tr_b16 v[44:45], v59 offset:36864
    ds_read_b64_tr_b16 v[46:47], v59 offset:37888
    ds_read_b128 v[36:39], v57 offset:36864
    ds_read_b64_tr_b16 v[48:49], v58 offset:40960
    ds_read_b64_tr_b16 v[50:51], v58 offset:41984
    ds_read_b64_tr_b16 v[52:53], v59 offset:40960
    ds_read_b64_tr_b16 v[54:55], v59 offset:41984
    s_waitcnt lgkmcnt(5)
    v_mfma_f32_32x32x16_bf16 v[0:15], v[40:43], v[32:35], v[0:15]
    v_mfma_f32_32x32x16_bf16 v[16:31], v[44:47], v[32:35], v[16:31]
    s_waitcnt lgkmcnt(0)
    v_mfma_f32_32x32x16_bf16 v[0:15], v[48:51], v[36:39], v[0:15]
    v_mfma_f32_32x32x16_bf16 v[16:31], v[52:55], v[36:39], v[16:31]
    s_barrier
    s_nop 15
    v_and_b32 v70, 31, v68
    s_mul_i32 s39, s31, 32
    v_add_u32 v70, s39, v70
    v_mul_u32_u24 v70, 528, v70
    s_mul_i32 s39, s32, 256
    v_lshrrev_b32 v71, 5, v68
    v_lshlrev_b32 v71, 4, v71
    v_add3_u32 v70, v70, v71, s39
    ds_write_b128 v70, v[0:3] offset:0
    ds_write_b128 v70, v[4:7] offset:32
    ds_write_b128 v70, v[8:11] offset:64
    ds_write_b128 v70, v[12:15] offset:96
    ds_write_b128 v70, v[16:19] offset:128
    ds_write_b128 v70, v[20:23] offset:160
    ds_write_b128 v70, v[24:27] offset:192
    ds_write_b128 v70, v[28:31] offset:224
    s_mov_b32 s44, s10
    s_mov_b32 s45, s11
    s_mov_b32 s46, 2621440
    s_mov_b32 s47, 0x00020000
    s_mov_b32 s48, s12
    s_mov_b32 s49, s13
    s_mov_b32 s50, 2621440
    s_mov_b32 s51, 0x00020000
    v_lshrrev_b32 v70, 4, v66
    v_and_b32 v71, 15, v66
    v_lshlrev_b32 v73, 5, v71
    v_mul_u32_u24 v72, 528, v70
    v_add_u32 v72, v72, v73
    v_add_u32 v70, s36, v70
    v_mul_u32_u24 v70, 1280, v70
    v_lshlrev_b32 v71, 4, v71
    v_add3_u32 v70, v70, v71, s37
    s_add_u32 s52, s6, 33554432
    s_addc_u32 s53, s7, 0
    s_mov_b32 s54, 15728640
    s_mov_b32 s55, 0x00020000
    v_lshlrev_b32 v76, 1, v70
    s_mov_b32 s39, 0
    s_mov_b32 s38, 0
    buffer_load_dwordx4 v[48:51], v70, s[44:47], s39 offen
    s_mov_b32 s38, 0
    buffer_load_dwordx4 v[96:99], v76, s[52:55], s38 offen
    buffer_load_dwordx4 v[100:103], v76, s[52:55], s38 offen offset:16
    s_mov_b32 s38, 5242880
    buffer_load_dwordx4 v[104:107], v76, s[52:55], s38 offen
    buffer_load_dwordx4 v[108:111], v76, s[52:55], s38 offen offset:16
    s_mov_b32 s38, 10485760
    buffer_load_dwordx4 v[112:115], v76, s[52:55], s38 offen
    buffer_load_dwordx4 v[116:119], v76, s[52:55], s38 offen offset:16
    s_mov_b32 s39, 20480
    s_mov_b32 s38, 40960
    buffer_load_dwordx4 v[52:55], v70, s[44:47], s39 offen
    s_mov_b32 s38, 40960
    buffer_load_dwordx4 v[120:123], v76, s[52:55], s38 offen
    buffer_load_dwordx4 v[124:127], v76, s[52:55], s38 offen offset:16
    s_mov_b32 s38, 5283840
    buffer_load_dwordx4 v[128:131], v76, s[52:55], s38 offen
    buffer_load_dwordx4 v[132:135], v76, s[52:55], s38 offen offset:16
    s_mov_b32 s38, 10526720
    buffer_load_dwordx4 v[136:139], v76, s[52:55], s38 offen
    buffer_load_dwordx4 v[140:143], v76, s[52:55], s38 offen offset:16
    s_mov_b32 s39, 40960
    s_mov_b32 s38, 81920
    buffer_load_dwordx4 v[56:59], v70, s[44:47], s39 offen
    s_mov_b32 s38, 81920
    buffer_load_dwordx4 v[144:147], v76, s[52:55], s38 offen
    buffer_load_dwordx4 v[148:151], v76, s[52:55], s38 offen offset:16
    s_mov_b32 s38, 5324800
    buffer_load_dwordx4 v[152:155], v76, s[52:55], s38 offen
    buffer_load_dwordx4 v[156:159], v76, s[52:55], s38 offen offset:16
    s_mov_b32 s38, 10567680
    buffer_load_dwordx4 v[160:163], v76, s[52:55], s38 offen
    buffer_load_dwordx4 v[164:167], v76, s[52:55], s38 offen offset:16
    s_mov_b32 s39, 61440
    s_mov_b32 s38, 122880
    buffer_load_dwordx4 v[60:63], v70, s[44:47], s39 offen
    s_mov_b32 s38, 122880
    buffer_load_dwordx4 v[168:171], v76, s[52:55], s38 offen
    buffer_load_dwordx4 v[172:175], v76, s[52:55], s38 offen offset:16
    s_mov_b32 s38, 5365760
    buffer_load_dwordx4 v[176:179], v76, s[52:55], s38 offen
    buffer_load_dwordx4 v[180:183], v76, s[52:55], s38 offen offset:16
    s_mov_b32 s38, 10608640
    buffer_load_dwordx4 v[184:187], v76, s[52:55], s38 offen
    buffer_load_dwordx4 v[188:191], v76, s[52:55], s38 offen offset:16
    s_waitcnt lgkmcnt(0)
    s_barrier
    ds_read_b128 v[0:3], v72 offset:0
    ds_read_b128 v[4:7], v72 offset:16
    ds_read_b128 v[8:11], v72 offset:8448
    ds_read_b128 v[12:15], v72 offset:8464
    ds_read_b128 v[16:19], v72 offset:16896
    ds_read_b128 v[20:23], v72 offset:16912
    ds_read_b128 v[24:27], v72 offset:25344
    ds_read_b128 v[28:31], v72 offset:25360
    s_waitcnt vmcnt(21) lgkmcnt(6)
    v_lshlrev_b32 v74, 16, v48
    v_and_b32 v75, 0xffff0000, v48
    v_add_f32 v0, v0, v96
    v_add_f32 v1, v1, v97
    v_add_f32 v0, v0, v104
    v_add_f32 v1, v1, v105
    v_add_f32 v0, v0, v112
    v_add_f32 v1, v1, v113
    v_add_f32 v74, v74, v0
    v_add_f32 v75, v75, v1
    v_cvt_pk_bf16_f32 v48, v74, v75
    v_lshlrev_b32 v74, 16, v49
    v_and_b32 v75, 0xffff0000, v49
    v_add_f32 v2, v2, v98
    v_add_f32 v3, v3, v99
    v_add_f32 v2, v2, v106
    v_add_f32 v3, v3, v107
    v_add_f32 v2, v2, v114
    v_add_f32 v3, v3, v115
    v_add_f32 v74, v74, v2
    v_add_f32 v75, v75, v3
    v_cvt_pk_bf16_f32 v49, v74, v75
    v_lshlrev_b32 v74, 16, v50
    v_and_b32 v75, 0xffff0000, v50
    v_add_f32 v4, v4, v100
    v_add_f32 v5, v5, v101
    v_add_f32 v4, v4, v108
    v_add_f32 v5, v5, v109
    v_add_f32 v4, v4, v116
    v_add_f32 v5, v5, v117
    v_add_f32 v74, v74, v4
    v_add_f32 v75, v75, v5
    v_cvt_pk_bf16_f32 v50, v74, v75
    v_lshlrev_b32 v74, 16, v51
    v_and_b32 v75, 0xffff0000, v51
    v_add_f32 v6, v6, v102
    v_add_f32 v7, v7, v103
    v_add_f32 v6, v6, v110
    v_add_f32 v7, v7, v111
    v_add_f32 v6, v6, v118
    v_add_f32 v7, v7, v119
    v_add_f32 v74, v74, v6
    v_add_f32 v75, v75, v7
    v_cvt_pk_bf16_f32 v51, v74, v75
    s_mov_b32 s39, 0
    buffer_store_dwordx4 v[48:51], v70, s[48:51], s39 offen
    s_waitcnt vmcnt(15) lgkmcnt(4)
    v_lshlrev_b32 v74, 16, v52
    v_and_b32 v75, 0xffff0000, v52
    v_add_f32 v8, v8, v120
    v_add_f32 v9, v9, v121
    v_add_f32 v8, v8, v128
    v_add_f32 v9, v9, v129
    v_add_f32 v8, v8, v136
    v_add_f32 v9, v9, v137
    v_add_f32 v74, v74, v8
    v_add_f32 v75, v75, v9
    v_cvt_pk_bf16_f32 v52, v74, v75
    v_lshlrev_b32 v74, 16, v53
    v_and_b32 v75, 0xffff0000, v53
    v_add_f32 v10, v10, v122
    v_add_f32 v11, v11, v123
    v_add_f32 v10, v10, v130
    v_add_f32 v11, v11, v131
    v_add_f32 v10, v10, v138
    v_add_f32 v11, v11, v139
    v_add_f32 v74, v74, v10
    v_add_f32 v75, v75, v11
    v_cvt_pk_bf16_f32 v53, v74, v75
    v_lshlrev_b32 v74, 16, v54
    v_and_b32 v75, 0xffff0000, v54
    v_add_f32 v12, v12, v124
    v_add_f32 v13, v13, v125
    v_add_f32 v12, v12, v132
    v_add_f32 v13, v13, v133
    v_add_f32 v12, v12, v140
    v_add_f32 v13, v13, v141
    v_add_f32 v74, v74, v12
    v_add_f32 v75, v75, v13
    v_cvt_pk_bf16_f32 v54, v74, v75
    v_lshlrev_b32 v74, 16, v55
    v_and_b32 v75, 0xffff0000, v55
    v_add_f32 v14, v14, v126
    v_add_f32 v15, v15, v127
    v_add_f32 v14, v14, v134
    v_add_f32 v15, v15, v135
    v_add_f32 v14, v14, v142
    v_add_f32 v15, v15, v143
    v_add_f32 v74, v74, v14
    v_add_f32 v75, v75, v15
    v_cvt_pk_bf16_f32 v55, v74, v75
    s_mov_b32 s39, 20480
    buffer_store_dwordx4 v[52:55], v70, s[48:51], s39 offen
    s_waitcnt vmcnt(9) lgkmcnt(2)
    v_lshlrev_b32 v74, 16, v56
    v_and_b32 v75, 0xffff0000, v56
    v_add_f32 v16, v16, v144
    v_add_f32 v17, v17, v145
    v_add_f32 v16, v16, v152
    v_add_f32 v17, v17, v153
    v_add_f32 v16, v16, v160
    v_add_f32 v17, v17, v161
    v_add_f32 v74, v74, v16
    v_add_f32 v75, v75, v17
    v_cvt_pk_bf16_f32 v56, v74, v75
    v_lshlrev_b32 v74, 16, v57
    v_and_b32 v75, 0xffff0000, v57
    v_add_f32 v18, v18, v146
    v_add_f32 v19, v19, v147
    v_add_f32 v18, v18, v154
    v_add_f32 v19, v19, v155
    v_add_f32 v18, v18, v162
    v_add_f32 v19, v19, v163
    v_add_f32 v74, v74, v18
    v_add_f32 v75, v75, v19
    v_cvt_pk_bf16_f32 v57, v74, v75
    v_lshlrev_b32 v74, 16, v58
    v_and_b32 v75, 0xffff0000, v58
    v_add_f32 v20, v20, v148
    v_add_f32 v21, v21, v149
    v_add_f32 v20, v20, v156
    v_add_f32 v21, v21, v157
    v_add_f32 v20, v20, v164
    v_add_f32 v21, v21, v165
    v_add_f32 v74, v74, v20
    v_add_f32 v75, v75, v21
    v_cvt_pk_bf16_f32 v58, v74, v75
    v_lshlrev_b32 v74, 16, v59
    v_and_b32 v75, 0xffff0000, v59
    v_add_f32 v22, v22, v150
    v_add_f32 v23, v23, v151
    v_add_f32 v22, v22, v158
    v_add_f32 v23, v23, v159
    v_add_f32 v22, v22, v166
    v_add_f32 v23, v23, v167
    v_add_f32 v74, v74, v22
    v_add_f32 v75, v75, v23
    v_cvt_pk_bf16_f32 v59, v74, v75
    s_mov_b32 s39, 40960
    buffer_store_dwordx4 v[56:59], v70, s[48:51], s39 offen
    s_waitcnt vmcnt(3) lgkmcnt(0)
    v_lshlrev_b32 v74, 16, v60
    v_and_b32 v75, 0xffff0000, v60
    v_add_f32 v24, v24, v168
    v_add_f32 v25, v25, v169
    v_add_f32 v24, v24, v176
    v_add_f32 v25, v25, v177
    v_add_f32 v24, v24, v184
    v_add_f32 v25, v25, v185
    v_add_f32 v74, v74, v24
    v_add_f32 v75, v75, v25
    v_cvt_pk_bf16_f32 v60, v74, v75
    v_lshlrev_b32 v74, 16, v61
    v_and_b32 v75, 0xffff0000, v61
    v_add_f32 v26, v26, v170
    v_add_f32 v27, v27, v171
    v_add_f32 v26, v26, v178
    v_add_f32 v27, v27, v179
    v_add_f32 v26, v26, v186
    v_add_f32 v27, v27, v187
    v_add_f32 v74, v74, v26
    v_add_f32 v75, v75, v27
    v_cvt_pk_bf16_f32 v61, v74, v75
    v_lshlrev_b32 v74, 16, v62
    v_and_b32 v75, 0xffff0000, v62
    v_add_f32 v28, v28, v172
    v_add_f32 v29, v29, v173
    v_add_f32 v28, v28, v180
    v_add_f32 v29, v29, v181
    v_add_f32 v28, v28, v188
    v_add_f32 v29, v29, v189
    v_add_f32 v74, v74, v28
    v_add_f32 v75, v75, v29
    v_cvt_pk_bf16_f32 v62, v74, v75
    v_lshlrev_b32 v74, 16, v63
    v_and_b32 v75, 0xffff0000, v63
    v_add_f32 v30, v30, v174
    v_add_f32 v31, v31, v175
    v_add_f32 v30, v30, v182
    v_add_f32 v31, v31, v183
    v_add_f32 v30, v30, v190
    v_add_f32 v31, v31, v191
    v_add_f32 v74, v74, v30
    v_add_f32 v75, v75, v31
    v_cvt_pk_bf16_f32 v63, v74, v75
    s_mov_b32 s39, 61440
    buffer_store_dwordx4 v[60:63], v70, s[48:51], s39 offen
G2_done:
    s_endpgm
.section .rodata,"a"
.p2align 6
.amdhsa_kernel ln_kernel
  .amdhsa_next_free_vgpr 32
  .amdhsa_next_free_sgpr 96
  .amdhsa_accum_offset 32
  .amdhsa_group_segment_fixed_size 0
  .amdhsa_kernarg_size 80
  .amdhsa_user_sgpr_count 2
  .amdhsa_user_sgpr_kernarg_segment_ptr 1
  .amdhsa_system_sgpr_workgroup_id_x 1
.end_amdhsa_kernel
.section .rodata,"a"
.p2align 6
.amdhsa_kernel gemm1_kernel
  .amdhsa_next_free_vgpr 162
  .amdhsa_next_free_sgpr 96
  .amdhsa_accum_offset 164
  .amdhsa_group_segment_fixed_size 0
  .amdhsa_kernarg_size 80
  .amdhsa_user_sgpr_count 2
  .amdhsa_user_sgpr_kernarg_segment_ptr 1
  .amdhsa_system_sgpr_workgroup_id_x 1
.end_amdhsa_kernel
.section .rodata,"a"
.p2align 6
.amdhsa_kernel attn_kernel
  .amdhsa_next_free_vgpr 104
  .amdhsa_next_free_sgpr 96
  .amdhsa_accum_offset 104
  .amdhsa_group_segment_fixed_size 0
  .amdhsa_kernarg_size 80
  .amdhsa_user_sgpr_count 2
  .amdhsa_user_sgpr_kernarg_segment_ptr 1
  .amdhsa_system_sgpr_workgroup_id_x 1
.end_amdhsa_kernel
.section .rodata,"a"
.p2align 6
.amdhsa_kernel gemm2_kernel
  .amdhsa_next_free_vgpr 192
  .amdhsa_next_free_sgpr 96
  .amdhsa_accum_offset 192
  .amdhsa_group_segment_fixed_size 0
  .amdhsa_kernarg_size 80
  .amdhsa_user_sgpr_count 2
  .amdhsa_user_sgpr_kernarg_segment_ptr 1
  .amdhsa_system_sgpr_workgroup_id_x 1
.end_amdhsa_kernel
```
